```python
import torch

def _softmax(x, axis=-1):
    return torch.softmax(x, dim=axis)
def _gelu(x):
    return torch.nn.functional.gelu(x, approximate="tanh")
def _silu(x):
    return torch.nn.functional.silu(x)
def _sigmoid(x):
    return torch.sigmoid(x)
def _layernorm(x, axis=-1, eps=1e-5):
    m = x.mean(dim=axis, keepdim=True)
    v = x.var(dim=axis, keepdim=True, unbiased=False)
    return (x - m) / torch.sqrt(v + eps)
def _scatter_add(tgt, idx, src, axis=0):
    return tgt.clone().index_add_(axis, idx, src)
def _segment_sum(src, seg, n):
    out = torch.zeros((n,) + src.shape[1:], dtype=src.dtype)
    return out.index_add_(0, seg, src)
def _pad(x, pw):
    flat = tuple(v for pair in reversed(pw) for v in pair)
    return torch.nn.functional.pad(x, flat)

kernel_name = 'interleave_layers__mha_block_cached__glu_gated_reglu__decode'

def setup_inputs():

    _w = (lambda a: (lambda t: t.to(torch.bfloat16) if t.is_floating_point() else t)(torch.as_tensor(a)))
    def _A_setup():
        B, Sq, D = 4, 1, 448
        H, Sk, Dh = 16, 4096, 256
        return {
            "x": _w((lambda *s: torch.randn(*s, dtype=torch.bfloat16) * 0.05)(B, Sq, D)),
            "k_cache": _w((lambda *s: torch.randn(*s, dtype=torch.bfloat16) * 0.8)(B, H, Sk, Dh)),
            "v_cache": _w((lambda *s: torch.randn(*s, dtype=torch.bfloat16) * 0.8)(B, H, Sk, Dh)),
            "wq": _w((lambda *s: torch.randn(*s, dtype=torch.bfloat16) * 0.8)(D, H * Dh) * (D ** -0.5)),
            "wo": _w((lambda *s: torch.randn(*s, dtype=torch.bfloat16) * 0.8)(H * Dh, D) * ((H * Dh) ** -0.5)),
        }
    _A_in = _A_setup()

    def _B_setup():
        B, S, D, F = 4, 1, 448, 1792
        return {
            "x": _w((lambda *s: torch.randn(*s, dtype=torch.bfloat16) * 0.05)(B, S, D)),
            "W_gate": _w((lambda *s: torch.randn(*s, dtype=torch.bfloat16) * 0.2)(D, F) * (2.0 / D) ** 0.5),
            "W_up": _w((lambda *s: torch.randn(*s, dtype=torch.bfloat16) * 0.2)(D, F) * (2.0 / D) ** 0.5),
            "W_down": _w((lambda *s: torch.randn(*s, dtype=torch.bfloat16) * 0.2)(F, D) * (1.0 / F) ** 0.5),
        }
    _B_in = _B_setup()

    return {
        "A_x": _A_in["x"],
        "A_k_cache": _A_in["k_cache"],
        "A_v_cache": _A_in["v_cache"],
        "A_wq": _A_in["wq"],
        "A_wo": _A_in["wo"],
        "B_x": _B_in["x"],
        "B_W_gate": _B_in["W_gate"],
        "B_W_up": _B_in["W_up"],
        "B_W_down": _B_in["W_down"],
    }

def reference(A_x, A_k_cache, A_v_cache, A_wq, A_wo, B_x, B_W_gate, B_W_up, B_W_down):
    def _A_ref(x, k_cache, v_cache, wq, wo):
        B, Sq, D = x.shape
        H, Dh = 16, 256
        q = (lambda x, *d: x.permute(*d))((x @ wq).reshape(B, Sq, H, Dh), 0, 2, 1, 3)
        scores = torch.einsum("bhqd,bhkd->bhqk", q, k_cache) * (Dh ** -0.5)
        p = _softmax(scores, axis=-1)
        o = torch.einsum("bhqk,bhkd->bhqd", p, v_cache)
        return (lambda x, *d: x.permute(*d))(o, 0, 2, 1, 3).reshape(B, Sq, H * Dh) @ wo

    def _B_ref(x, W_gate, W_up, W_down):
        gate = torch.einsum("bsd,df->bsf", x, W_gate)
        up = torch.einsum("bsd,df->bsf", x, W_up)
        gate = gate * (lambda x, dt: x.to(dt))(gate > 0, gate.dtype)
        h = gate * up
        return torch.einsum("bsf,fd->bsd", h, W_down)

    x = A_x
    x = x + _A_ref(_layernorm(x, axis=-1), A_k_cache, A_v_cache, A_wq, A_wo)
    x = x + _B_ref(_layernorm(x, axis=-1), B_W_gate, B_W_up, B_W_down)
    x = x + _A_ref(_layernorm(x, axis=-1), A_k_cache, A_v_cache, A_wq, A_wo)
    x = x + _B_ref(_layernorm(x, axis=-1), B_W_gate, B_W_up, B_W_down)
    return x
```

```asm
; @launch grid=(256,1,1) block=(256,1,1) lds=163840
.amdgcn_target "amdgcn-amd-amdhsa--gfx950"
.text
.globl interleave_layers__mha_block_cached__glu_gated_reglu__decode_kernel
.p2align 8
.type interleave_layers__mha_block_cached__glu_gated_reglu__decode_kernel,@function
interleave_layers__mha_block_cached__glu_gated_reglu__decode_kernel:
  s_cmp_ge_u32 s2, 256
  s_cbranch_scc1 L_end2
  s_load_dwordx16 s[64:79], s[0:1], 0
  s_load_dwordx8 s[80:87], s[0:1], 64
  s_getreg_b32 s36, hwreg(HW_REG_XCC_ID, 0, 3)
  s_getreg_b32 s38, hwreg(HW_REG_HW_ID, 8, 4)
  s_getreg_b32 s37, hwreg(HW_REG_HW_ID, 13, 2)
  v_lshrrev_b32 v1, 6, v0
  v_and_b32 v0, 63, v0
  v_readfirstlane_b32 s3, v1
  s_mov_b32 s52, 400000
  s_mov_b64 s[6:7], 0
  s_bitcmp0_b32 s37, 0
  s_cselect_b32 s39, 8, 0
  s_cmp_eq_u32 s38, s39
  s_cbranch_scc1 L_odd
L_even:
  s_and_b32 s38, s38, 7
  s_lshl3_add_u32 s2, s37, s38
L_role:
  s_mov_b32 s101, s2
  s_and_b32 s100, s36, 3
  s_lshl_b32 s100, s100, 6
  s_lshr_b32 s38, s36, 2
  s_lshl3_add_u32 s100, s38, s100
  s_getpc_b64 s[38:39]
L_pc:
  s_lshl_b32 s37, s2, 2
  s_add_u32 s37, s37, s3
  s_lshl_b32 s37, s37, 10
  s_cmp_ge_u32 s37, L_end-L_pc
  s_cbranch_scc1 L_nopf
  v_lshl_add_u32 v2, v0, 4, s37
  v_min_u32 v2, L_end-L_pc-16, v2
  global_load_dwordx4 v[60:63], v2, s[38:39]
L_nopf:
  s_getreg_b32 s38, hwreg(HW_REG_XCC_ID, 0, 4)
  s_cmp_eq_u32 s38, s36
  s_cselect_b32 s5, 1, 0x101
  s_lshr_b32 s38, s2, 4
  s_lshl1_add_u32 s36, s36, s38
  s_and_b32 s37, s2, 7
  s_bfe_u32 s38, s2, 0x10003
  s_cmp_eq_u32 s37, 7
  s_cbranch_scc1 L_chain
  s_mul_i32 s38, s38, 7
  s_add_u32 s37, s37, s38
  s_lshl_b32 s39, s37, 2
  s_add_u32 s39, s39, s3
  s_lshl_b32 s38, s39, 13
  s_lshl_b32 s44, s36, 21
  s_add_u32 s40, s44, s38
  s_add_u32 s43, s40, 1376256
  v_bfe_u32 v1, v0, 0, 1
  v_lshlrev_b32 v1, 4, v1
  v_bfe_u32 v18, v0, 4, 2
  v_lshl_add_u32 v1, v18, 5, v1
  v_bfe_u32 v18, v0, 2, 1
  v_lshl_add_u32 v1, v18, 10, v1
  v_bfe_u32 v18, v0, 1, 1
  v_lshl_add_u32 v1, v18, 11, v1
  v_bfe_u32 v18, v0, 3, 1
  v_lshl_add_u32 v1, v18, 12, v1
  s_lshl_b32 s38, 1, s101
  v_mov_b32 v22, s100
  v_mov_b32 v23, s38
  s_or_b32 s38, s3, s7
  s_waitcnt lgkmcnt(0)
  s_cbranch_scc1 L_cl_1
  s_mov_b64 exec, 1
  global_atomic_or v24, v22, v23, s[84:85] sc0 sc1
  s_mov_b64 exec, -1
L_cl_1:
  s_lshl2_add_u32 s32, s37, s3
  s_mov_b64 s[28:29], s[70:71]
  s_mov_b32 s30, 0x380000
  s_mov_b32 s31, 0x20000
  s_mul_i32 s38, s36, 512
  s_mul_i32 s33, s32, 49152
  s_add_u32 s38, s38, s33
  s_add_u32 s38, s38, 917504
  v_lshrrev_b32 v18, 2, v0
  v_mul_u32_u24 v18, 8192, v18
  v_and_b32 v19, 3, v0
  v_lshl_add_u32 v18, v19, 7, v18
  s_mov_b32 exec_lo, 0xffffff
  s_mov_b32 exec_hi, 0x0
  buffer_load_dword v17, v18, s[28:31], s38 offen
  s_mov_b64 exec, -1
  s_mov_b64 s[8:9], s[66:67]
  s_mov_b32 s10, 0x8000000
  s_mov_b32 s11, 0x20000
  buffer_load_dwordx4 a[0:3], v1, s[8:11], s43 offen offset:0 nt
  buffer_load_dwordx4 a[4:7], v1, s[8:11], s43 offen offset:128 nt
  buffer_load_dwordx4 a[8:11], v1, s[8:11], s43 offen offset:256 nt
  buffer_load_dwordx4 a[12:15], v1, s[8:11], s43 offen offset:384 nt
  buffer_load_dwordx4 a[16:19], v1, s[8:11], s43 offen offset:512 nt
  buffer_load_dwordx4 a[20:23], v1, s[8:11], s43 offen offset:640 nt
  buffer_load_dwordx4 a[24:27], v1, s[8:11], s43 offen offset:768 nt
  buffer_load_dwordx4 a[28:31], v1, s[8:11], s43 offen offset:896 nt
  s_lshl_b32 s47, s36, 15
  s_lshl_b32 s38, s37, 9
  s_add_u32 s47, s47, s38
  s_add_u32 s47, s47, 0x800000
  s_mul_i32 s48, s37, -504
  s_add_u32 s48, s48, 7168
  v_lshlrev_b32 v4, 4, v0
  s_add_u32 s41, s40, 458752
  s_add_u32 s42, s40, 917504
  s_mov_b64 s[88:89], s[66:67]
  s_mov_b32 s90, 0x0
  s_mov_b32 s91, 0x20000
  s_mov_b64 s[92:93], s[68:69]
  s_mov_b32 s94, 0x0
  s_mov_b32 s95, 0x20000
  s_mul_i32 s38, s39, 9
  s_min_u32 s51, s37, 8
  s_add_u32 s38, s38, s51
  s_cmp_lt_u32 s37, 8
  s_cselect_b32 s22, s3, 0
  s_cmp_eq_u32 s22, 3
  s_cselect_b32 s22, 10, 9
  s_mov_b32 s23, s22
  s_lshl_b32 s38, s38, 9
  s_add_u32 s44, s44, 1835008
  s_add_u32 s44, s44, s38
  s_lshl_b32 s38, s22, 9
  s_add_u32 s90, s44, s38
  s_mov_b32 s94, s90
  s_mov_b64 s[12:13], s[68:69]
  s_mov_b32 s14, 0x8000000
  s_mov_b32 s15, 0x20000
  s_mov_b64 s[16:17], s[86:87]
  s_mov_b32 s18, 0x20000000
  s_mov_b32 s19, 0x20000
  v_bfe_u32 v2, v0, 0, 3
  v_lshlrev_b32 v2, 4, v2
  v_bfe_u32 v18, v0, 5, 1
  v_lshl_add_u32 v2, v18, 9, v2
  v_bfe_u32 v18, v0, 4, 1
  v_lshl_add_u32 v2, v18, 11, v2
  v_bfe_u32 v18, v0, 3, 1
  v_lshl_add_u32 v2, v18, 12, v2
  s_mul_i32 s45, s3, 37888
  s_add_u32 s45, s45, 11520
  v_add_u32 v3, s45, v4
  v_bfe_u32 v5, v0, 0, 2
  v_lshlrev_b32 v5, 4, v5
  v_bfe_u32 v18, v0, 4, 2
  v_lshl_add_u32 v5, v18, 6, v5
  v_and_b32 v18, 2, v0
  v_cmp_eq_u32 vcc, 2, v18
  v_mov_b32 v6, 0x44444444
  v_mov_b32 v18, 0xeeeeeeee
  v_cndmask_b32 v6, v6, v18, vcc
  v_and_b32 v18, 3, v0
  s_mov_b32 s38, 0x55555555
  v_mul_lo_u32 v7, v18, s38
  v_and_b32 v18, 4, v0
  v_cmp_eq_u32 vcc, 4, v18
  v_mov_b32 v18, 0xffff
  v_mov_b32 v19, 0xffff0000
  v_cndmask_b32 v8, v18, 0, vcc
  v_cndmask_b32 v9, 0, v18, vcc
  v_cndmask_b32 v10, v19, 0, vcc
  v_cndmask_b32 v11, 0, v19, vcc
  v_bfe_u32 v15, v0, 4, 1
  v_bfe_u32 v19, v0, 2, 1
  v_lshl_add_u32 v15, v19, 1, v15
  v_bfe_u32 v19, v0, 1, 1
  v_lshl_add_u32 v15, v19, 2, v15
  v_bfe_u32 v19, v0, 3, 1
  v_lshl_add_u32 v15, v19, 3, v15
  v_bfe_u32 v19, v0, 5, 1
  v_lshl_add_u32 v15, v19, 4, v15
  s_lshl_b32 s46, s3, 4
  s_add_u32 s46, s46, s36
  s_lshl_b32 s46, s46, 9
  s_mov_b32 s49, 0
  s_mov_b32 s51, 0x3db8aa3b
  s_mov_b32 s50, 0x42000000
  s_mov_b32 s53, 8192
  s_lshl_b32 s54, s3, 10
  s_lshl_b32 s55, s3, 3
  s_lshl_b32 s56, s36, 9
  s_add_u32 s56, s56, 0x6000
  v_mov_b32 v18, 0
  v_mov_b32 v19, 0
  ds_write_b64 v18, v[18:19] offset:10304
  s_lshl_b32 s57, s3, 8
  s_add_u32 s57, s57, 10496
  s_mov_b32 s58, 0
  s_lshl_b32 s4, s5, 23
  s_and_b32 s4, s4, 0x80000000
  s_mov_b32 s59, 0
  s_or_b32 s38, s6, s7
  s_cselect_b32 s59, 1, s59
  s_lshr_b32 s20, s36, 1
  s_lshl2_add_u32 s20, s20, s3
  s_lshl_b32 s20, s20, 8
  s_add_u32 s20, s20, 0x9c000
  s_and_b32 s38, s36, 1
  s_mul_i32 s21, s38, 14
  s_add_u32 s21, s21, s37
  s_lshl_b32 s24, s38, 21
  s_lshl_b32 s38, s37, 15
  s_add_u32 s24, s24, s38
  s_lshl3_add_u32 s25, s21, s20
  s_mov_b32 s35, 0
  s_mul_i32 s21, s21, 27
  s_mov_b32 s26, s59
  buffer_load_dwordx4 a[32:35], v1, s[88:91], s44 offen offset:0 nt
  buffer_load_dwordx4 a[36:39], v1, s[88:91], s44 offen offset:128 nt
  buffer_load_dwordx4 a[40:43], v1, s[88:91], s44 offen offset:256 nt
  buffer_load_dwordx4 a[44:47], v1, s[88:91], s44 offen offset:384 nt
  buffer_load_dwordx4 a[48:51], v1, s[88:91], s44 offen offset:512 nt
  buffer_load_dwordx4 a[52:55], v1, s[88:91], s44 offen offset:640 nt
  buffer_load_dwordx4 a[56:59], v1, s[88:91], s44 offen offset:768 nt
  buffer_load_dwordx4 a[60:63], v1, s[88:91], s44 offen offset:896 nt
L_A0:
  s_add_u32 s38, s35, 2
  v_mov_b32 v18, s38
  s_mov_b64 exec, 1
  buffer_store_dword v18, off, s[16:19], s25
  s_mov_b64 exec, -1
  s_cmp_gt_u32 s59, 1
  s_cbranch_scc1 L_lv_3
  s_cmp_gt_u32 s59, 0
  s_cbranch_scc1 L_lv_2
  s_waitcnt vmcnt(6)
L_lv_2:
  s_waitcnt vmcnt(9)
L_lv_3:
  s_waitcnt vmcnt(12)
  buffer_load_dwordx4 v[64:67], v1, s[8:11], s40 offen offset:0 nt
  s_cmp_gt_u32 s59, 1
  s_cbranch_scc1 L_lv_5
  s_cmp_gt_u32 s59, 0
  s_cbranch_scc1 L_lv_4
  s_waitcnt vmcnt(6)
L_lv_4:
  s_waitcnt vmcnt(9)
L_lv_5:
  s_waitcnt vmcnt(12)
  buffer_load_dwordx4 v[68:71], v1, s[8:11], s40 offen offset:128 nt
  s_cmp_gt_u32 s59, 1
  s_cbranch_scc1 L_lv_7
  s_cmp_gt_u32 s59, 0
  s_cbranch_scc1 L_lv_6
  s_waitcnt vmcnt(6)
L_lv_6:
  s_waitcnt vmcnt(9)
L_lv_7:
  s_waitcnt vmcnt(12)
  buffer_load_dwordx4 v[72:75], v1, s[8:11], s40 offen offset:256 nt
  s_cmp_gt_u32 s59, 1
  s_cbranch_scc1 L_lv_9
  s_cmp_gt_u32 s59, 0
  s_cbranch_scc1 L_lv_8
  s_waitcnt vmcnt(6)
L_lv_8:
  s_waitcnt vmcnt(9)
L_lv_9:
  s_waitcnt vmcnt(12)
  buffer_load_dwordx4 v[76:79], v1, s[8:11], s40 offen offset:384 nt
  s_cmp_gt_u32 s59, 1
  s_cbranch_scc1 L_lv_11
  s_cmp_gt_u32 s59, 0
  s_cbranch_scc1 L_lv_10
  s_waitcnt vmcnt(6)
L_lv_10:
  s_waitcnt vmcnt(9)
L_lv_11:
  s_waitcnt vmcnt(12)
  buffer_load_dwordx4 v[80:83], v1, s[8:11], s40 offen offset:512 nt
  s_cmp_lg_u32 s49, 0
  s_cbranch_scc1 L_it0_12
  s_waitcnt vmcnt(8)
  v_mov_b32 v20, 0
  s_cmp_lg_u32 s3, 0
  s_cbranch_scc1 L_rs_13
  s_movk_i32 s38, 0x100
  s_cmp_lg_u32 s7, 0
  s_cbranch_scc1 L_rw_14
  v_readfirstlane_b32 s39, v24
  s_bitcmp1_b32 s39, s101
  s_cbranch_scc0 L_rw_14
  s_call_b64 s[96:97], L_lost
L_rw_14:
  v_mov_b32 v21, s38
  ds_write_b32 v20, v21 offset:4096
  s_waitcnt lgkmcnt(0)
L_rs_13:
  s_barrier
  ds_read_b32 v21, v20 offset:4096
  s_waitcnt lgkmcnt(0)
  v_readfirstlane_b32 s38, v21
  s_cmp_lg_u32 s38, 0x100
  s_cbranch_scc1 L_redo
  s_lshl2_add_u32 s32, s37, s3
  s_mov_b64 s[28:29], s[72:73]
  s_mov_b32 s30, 0x380000
  s_mov_b32 s31, 0x20000
  s_mul_i32 s38, s36, 229376
  s_mul_i32 s33, s32, 4096
  s_add_u32 s38, s38, s33
  s_add_u32 s38, s38, 0
  v_lshlrev_b32 v18, 7, v0
  s_mov_b32 exec_lo, 0xffffffff
  s_mov_b32 exec_hi, 0x0
  buffer_load_dword v17, v18, s[28:31], s38 offen
  s_mov_b64 exec, -1
L_it0_12:
  s_add_u32 s38, s35, 3
  v_mov_b32 v18, s38
  s_mov_b64 exec, 1
  buffer_store_dword v18, off, s[16:19], s25
  s_mov_b64 exec, -1
  s_cmp_gt_u32 s59, 1
  s_cbranch_scc1 L_lv_16
  s_cmp_gt_u32 s59, 0
  s_cbranch_scc1 L_lv_15
  s_waitcnt vmcnt(7)
L_lv_15:
  s_waitcnt vmcnt(10)
L_lv_16:
  s_waitcnt vmcnt(13)
  buffer_load_dwordx4 v[84:87], v1, s[8:11], s40 offen offset:640 nt
  s_cmp_gt_u32 s59, 1
  s_cbranch_scc1 L_lv_18
  s_cmp_gt_u32 s59, 0
  s_cbranch_scc1 L_lv_17
  s_waitcnt vmcnt(6)
L_lv_17:
  s_waitcnt vmcnt(10)
L_lv_18:
  s_waitcnt vmcnt(13)
  buffer_load_dwordx4 v[88:91], v1, s[8:11], s40 offen offset:768 nt
  s_cmp_gt_u32 s59, 1
  s_cbranch_scc1 L_lv_20
  s_cmp_gt_u32 s59, 0
  s_cbranch_scc1 L_lv_19
  s_waitcnt vmcnt(6)
L_lv_19:
  s_waitcnt vmcnt(10)
L_lv_20:
  s_waitcnt vmcnt(13)
  buffer_load_dwordx4 v[92:95], v1, s[8:11], s40 offen offset:896 nt
  s_cmp_gt_u32 s59, 1
  s_cbranch_scc1 L_lv_22
  s_cmp_gt_u32 s59, 0
  s_cbranch_scc1 L_lv_21
  s_waitcnt vmcnt(6)
L_lv_21:
  s_waitcnt vmcnt(10)
L_lv_22:
  s_waitcnt vmcnt(13)
  buffer_load_dwordx4 v[96:99], v1, s[8:11], s41 offen offset:0 nt
  s_cmp_gt_u32 s59, 1
  s_cbranch_scc1 L_lv_24
  s_cmp_gt_u32 s59, 0
  s_cbranch_scc1 L_lv_23
  s_waitcnt vmcnt(6)
L_lv_23:
  s_waitcnt vmcnt(9)
L_lv_24:
  s_waitcnt vmcnt(13)
  buffer_load_dwordx4 v[100:103], v1, s[8:11], s41 offen offset:128 nt
  s_cmp_gt_u32 s59, 1
  s_cbranch_scc1 L_lv_26
  s_cmp_gt_u32 s59, 0
  s_cbranch_scc1 L_lv_25
  s_waitcnt vmcnt(6)
L_lv_25:
  s_waitcnt vmcnt(9)
L_lv_26:
  s_waitcnt vmcnt(13)
  buffer_load_dwordx4 v[104:107], v1, s[8:11], s41 offen offset:256 nt
  s_cmp_gt_u32 s59, 1
  s_cbranch_scc1 L_lv_28
  s_cmp_gt_u32 s59, 0
  s_cbranch_scc1 L_lv_27
  s_waitcnt vmcnt(5)
L_lv_27:
  s_waitcnt vmcnt(9)
L_lv_28:
  s_waitcnt vmcnt(13)
  buffer_load_dwordx4 v[108:111], v1, s[8:11], s41 offen offset:384 nt
  s_cmp_gt_u32 s59, 1
  s_cbranch_scc1 L_lv_30
  s_cmp_gt_u32 s59, 0
  s_cbranch_scc1 L_lv_29
  s_waitcnt vmcnt(5)
L_lv_29:
  s_waitcnt vmcnt(9)
L_lv_30:
  s_waitcnt vmcnt(12)
  buffer_load_dwordx4 v[112:115], v1, s[8:11], s41 offen offset:512 nt
  s_add_u32 s38, s35, 4
  v_mov_b32 v18, s38
  s_mov_b64 exec, 1
  buffer_store_dword v18, off, s[16:19], s25
  s_mov_b64 exec, -1
  s_cmp_gt_u32 s59, 1
  s_cbranch_scc1 L_lv_32
  s_cmp_gt_u32 s59, 0
  s_cbranch_scc1 L_lv_31
  s_waitcnt vmcnt(6)
L_lv_31:
  s_waitcnt vmcnt(10)
L_lv_32:
  s_waitcnt vmcnt(13)
  buffer_load_dwordx4 v[116:119], v1, s[8:11], s41 offen offset:640 nt
  s_cmp_gt_u32 s59, 1
  s_cbranch_scc1 L_lv_34
  s_cmp_gt_u32 s59, 0
  s_cbranch_scc1 L_lv_33
  s_waitcnt vmcnt(6)
L_lv_33:
  s_waitcnt vmcnt(9)
L_lv_34:
  s_waitcnt vmcnt(13)
  buffer_load_dwordx4 v[120:123], v1, s[8:11], s41 offen offset:768 nt
  s_cmp_lg_u32 s49, 0
  s_cbranch_scc1 L_it0_35
  s_lshl2_add_u32 s32, s37, s3
  s_mov_b64 s[28:29], s[80:81]
  s_mov_b32 s30, 0x188000
  s_mov_b32 s31, 0x20000
  s_mul_i32 s38, s36, 114688
  s_mul_i32 s33, s32, 2048
  s_add_u32 s38, s38, s33
  s_add_u32 s38, s38, 0
  v_lshlrev_b32 v18, 7, v0
  s_mov_b32 exec_lo, 0xffff
  s_mov_b32 exec_hi, 0x0
  buffer_load_dword v17, v18, s[28:31], s38 offen
  s_mov_b64 exec, -1
L_it0_35:
  s_cmp_gt_u32 s59, 1
  s_cbranch_scc1 L_lv_37
  s_cmp_gt_u32 s59, 0
  s_cbranch_scc1 L_lv_36
  s_waitcnt vmcnt(6)
L_lv_36:
  s_waitcnt vmcnt(9)
L_lv_37:
  s_waitcnt vmcnt(13)
  buffer_load_dwordx4 v[124:127], v1, s[8:11], s41 offen offset:896 nt
  s_mov_b32 s59, s26
  s_cmp_gt_u32 s59, 1
  s_cbranch_scc1 L_lv_39
  s_cmp_gt_u32 s59, 0
  s_cbranch_scc1 L_lv_38
  s_waitcnt vmcnt(6)
L_lv_38:
  s_waitcnt vmcnt(9)
L_lv_39:
  s_waitcnt vmcnt(13)
  buffer_load_dwordx4 v[128:131], v1, s[8:11], s42 offen offset:0 nt
  s_cmp_gt_u32 s59, 1
  s_cbranch_scc1 L_lv_41
  s_cmp_gt_u32 s59, 0
  s_cbranch_scc1 L_lv_40
  s_waitcnt vmcnt(6)
L_lv_40:
  s_waitcnt vmcnt(9)
L_lv_41:
  s_waitcnt vmcnt(12)
  buffer_load_dwordx4 v[132:135], v1, s[8:11], s42 offen offset:128 nt
  s_cmp_gt_u32 s59, 1
  s_cbranch_scc1 L_lv_43
  s_cmp_gt_u32 s59, 0
  s_cbranch_scc1 L_lv_42
  s_waitcnt vmcnt(6)
L_lv_42:
  s_waitcnt vmcnt(9)
L_lv_43:
  s_waitcnt vmcnt(12)
  buffer_load_dwordx4 v[136:139], v1, s[8:11], s42 offen offset:256 nt
  s_cmp_gt_u32 s59, 1
  s_cbranch_scc1 L_lv_45
  s_cmp_gt_u32 s59, 0
  s_cbranch_scc1 L_lv_44
  s_waitcnt vmcnt(5)
L_lv_44:
  s_waitcnt vmcnt(9)
L_lv_45:
  s_waitcnt vmcnt(12)
  buffer_load_dwordx4 v[140:143], v1, s[8:11], s42 offen offset:384 nt
  s_cmp_gt_u32 s59, 1
  s_cbranch_scc1 L_lv_47
  s_cmp_gt_u32 s59, 0
  s_cbranch_scc1 L_lv_46
  s_waitcnt vmcnt(5)
L_lv_46:
  s_waitcnt vmcnt(9)
L_lv_47:
  s_waitcnt vmcnt(12)
  buffer_load_dwordx4 v[144:147], v1, s[8:11], s42 offen offset:512 nt
  s_add_u32 s38, s35, 5
  v_mov_b32 v18, s38
  s_mov_b64 exec, 1
  buffer_store_dword v18, off, s[16:19], s25
  s_mov_b64 exec, -1
  s_cmp_gt_u32 s59, 1
  s_cbranch_scc1 L_lv_49
  s_cmp_gt_u32 s59, 0
  s_cbranch_scc1 L_lv_48
  s_waitcnt vmcnt(6)
L_lv_48:
  s_waitcnt vmcnt(10)
L_lv_49:
  s_waitcnt vmcnt(13)
  buffer_load_dwordx4 v[148:151], v1, s[8:11], s42 offen offset:640 nt
  s_cmp_gt_u32 s59, 1
  s_cbranch_scc1 L_lv_51
  s_cmp_gt_u32 s59, 0
  s_cbranch_scc1 L_lv_50
  s_waitcnt vmcnt(6)
L_lv_50:
  s_waitcnt vmcnt(9)
L_lv_51:
  s_waitcnt vmcnt(13)
  buffer_load_dwordx4 v[152:155], v1, s[8:11], s42 offen offset:768 nt
  s_cmp_gt_u32 s59, 1
  s_cbranch_scc1 L_lv_53
  s_cmp_gt_u32 s59, 0
  s_cbranch_scc1 L_lv_52
  s_waitcnt vmcnt(6)
L_lv_52:
  s_waitcnt vmcnt(9)
L_lv_53:
  s_waitcnt vmcnt(13)
  buffer_load_dwordx4 v[156:159], v1, s[8:11], s42 offen offset:896 nt
  s_cmp_gt_u32 s59, 1
  s_cbranch_scc1 L_lv_55
  s_cmp_gt_u32 s59, 0
  s_cbranch_scc1 L_lv_54
  s_waitcnt vmcnt(6)
L_lv_54:
  s_waitcnt vmcnt(9)
L_lv_55:
  s_waitcnt vmcnt(13)
  buffer_load_dwordx4 a[64:67], v2, s[12:15], s40 offen offset:0 nt
  s_cmp_gt_u32 s59, 1
  s_cbranch_scc1 L_lv_57
  s_cmp_gt_u32 s59, 0
  s_cbranch_scc1 L_lv_56
  s_waitcnt vmcnt(6)
L_lv_56:
  s_waitcnt vmcnt(9)
L_lv_57:
  s_waitcnt vmcnt(12)
  buffer_load_dwordx4 a[72:75], v2, s[12:15], s40 offen offset:128 nt
  s_cmp_gt_u32 s59, 1
  s_cbranch_scc1 L_lv_59
  s_cmp_gt_u32 s59, 0
  s_cbranch_scc1 L_lv_58
  s_waitcnt vmcnt(6)
L_lv_58:
  s_waitcnt vmcnt(9)
L_lv_59:
  s_waitcnt vmcnt(12)
  buffer_load_dwordx4 a[80:83], v2, s[12:15], s40 offen offset:256 nt
  s_cmp_gt_u32 s59, 1
  s_cbranch_scc1 L_lv_61
  s_cmp_gt_u32 s59, 0
  s_cbranch_scc1 L_lv_60
  s_waitcnt vmcnt(5)
L_lv_60:
  s_waitcnt vmcnt(9)
L_lv_61:
  s_waitcnt vmcnt(12)
  buffer_load_dwordx4 a[88:91], v2, s[12:15], s40 offen offset:384 nt
  s_cmp_gt_u32 s59, 1
  s_cbranch_scc1 L_lv_63
  s_cmp_gt_u32 s59, 0
  s_cbranch_scc1 L_lv_62
  s_waitcnt vmcnt(5)
L_lv_62:
  s_waitcnt vmcnt(9)
L_lv_63:
  s_waitcnt vmcnt(12)
  buffer_load_dwordx4 a[96:99], v2, s[12:15], s40 offen offset:1024 nt
  s_add_u32 s38, s35, 6
  v_mov_b32 v18, s38
  s_mov_b64 exec, 1
  buffer_store_dword v18, off, s[16:19], s25
  s_mov_b64 exec, -1
  s_cmp_gt_u32 s59, 1
  s_cbranch_scc1 L_lv_65
  s_cmp_gt_u32 s59, 0
  s_cbranch_scc1 L_lv_64
  s_waitcnt vmcnt(6)
L_lv_64:
  s_waitcnt vmcnt(10)
L_lv_65:
  s_waitcnt vmcnt(13)
  buffer_load_dwordx4 a[104:107], v2, s[12:15], s40 offen offset:1152 nt
  s_cmp_gt_u32 s59, 1
  s_cbranch_scc1 L_lv_67
  s_cmp_gt_u32 s59, 0
  s_cbranch_scc1 L_lv_66
  s_waitcnt vmcnt(6)
L_lv_66:
  s_waitcnt vmcnt(9)
L_lv_67:
  s_waitcnt vmcnt(13)
  buffer_load_dwordx4 a[112:115], v2, s[12:15], s40 offen offset:1280 nt
  s_cmp_gt_u32 s59, 1
  s_cbranch_scc1 L_lv_69
  s_cmp_gt_u32 s59, 0
  s_cbranch_scc1 L_lv_68
  s_waitcnt vmcnt(6)
L_lv_68:
  s_waitcnt vmcnt(9)
L_lv_69:
  s_waitcnt vmcnt(13)
  buffer_load_dwordx4 a[120:123], v2, s[12:15], s40 offen offset:1408 nt
  s_waitcnt vmcnt(9)
  s_cmp_eq_u32 s49, 0
  s_cbranch_scc1 L_st0
  v_add_u32 v18, s53, v5
  ds_read_b128 v[24:27], v18
  ds_read_b128 v[28:31], v18 offset:256
  v_mov_b64 v[32:33], 0
  v_mov_b64 v[34:35], 0
  v_mov_b64 v[36:37], 0
  v_mov_b64 v[38:39], 0
  v_mov_b64 v[40:41], 0
  v_mov_b64 v[42:43], 0
  v_mov_b64 v[44:45], 0
  v_mov_b64 v[46:47], 0
  s_waitcnt lgkmcnt(0)
  v_smfmac_f32_16x16x64_bf16 v[32:35], v[24:27], v[64:71], v6
  v_smfmac_f32_16x16x64_bf16 v[32:35], v[28:31], v[72:79], v6
  v_smfmac_f32_16x16x64_bf16 v[36:39], v[24:27], v[80:87], v6
  v_smfmac_f32_16x16x64_bf16 v[36:39], v[28:31], v[88:95], v6
  s_cmp_gt_u32 s59, 0
  s_nop 0
  s_cbranch_scc1 L_lv_70
  s_waitcnt vmcnt(6)
L_lv_70:
  buffer_load_dwordx4 a[68:71], v2, s[12:15], s41 offen offset:0 nt
  v_smfmac_f32_16x16x64_bf16 v[40:43], v[24:27], v[96:103], v6
  v_smfmac_f32_16x16x64_bf16 v[40:43], v[28:31], v[104:111], v6
  v_smfmac_f32_16x16x64_bf16 v[44:47], v[24:27], v[112:119], v6
  v_add_f32 v19, v33, v35
  v_add_f32 v18, v32, v34
  v_smfmac_f32_16x16x64_bf16 v[44:47], v[28:31], v[120:127], v6
  s_nop 0
  v_add_f32_dpp v12, v19, v18 quad_perm:[1,1,3,3] row_mask:0x1 bank_mask:0xf
  v_smfmac_f32_16x16x64_bf16 v[32:35], v[24:27], v[128:135], v6
  v_add_f32 v21, v37, v39
  v_add_f32 v20, v36, v38
  v_smfmac_f32_16x16x64_bf16 v[32:35], v[28:31], v[136:143], v6
  s_nop 0
  v_add_f32_dpp v12, v21, v20 quad_perm:[1,1,3,3] row_mask:0x2 bank_mask:0xf
  v_smfmac_f32_16x16x64_bf16 v[36:39], v[24:27], v[144:151], v6
  v_add_f32 v19, v41, v43
  v_add_f32 v18, v40, v42
  v_smfmac_f32_16x16x64_bf16 v[36:39], v[28:31], v[152:159], v6
  s_nop 0
  v_add_f32_dpp v12, v19, v18 quad_perm:[1,1,3,3] row_mask:0x4 bank_mask:0xf
  v_smfmac_f32_16x16x64_bf16 v[40:43], v[24:27], a[0:7], v6
  v_add_f32 v21, v45, v47
  v_add_f32 v20, v44, v46
  v_smfmac_f32_16x16x64_bf16 v[40:43], v[28:31], a[8:15], v6
  s_nop 0
  v_add_f32_dpp v12, v21, v20 quad_perm:[1,1,3,3] row_mask:0x8 bank_mask:0xf
  s_cmp_gt_u32 s59, 1
  s_cbranch_scc1 L_lv_72
  s_cmp_gt_u32 s59, 0
  s_cbranch_scc1 L_lv_71
  s_waitcnt vmcnt(6)
L_lv_71:
  s_waitcnt vmcnt(9)
L_lv_72:
  buffer_load_dwordx4 a[76:79], v2, s[12:15], s41 offen offset:128 nt
  v_smfmac_f32_16x16x64_bf16 v[44:47], v[24:27], a[16:23], v6
  v_add_f32 v19, v33, v35
  v_add_f32 v18, v32, v34
  v_smfmac_f32_16x16x64_bf16 v[44:47], v[28:31], a[24:31], v6
  s_nop 0
  v_add_f32_dpp v13, v19, v18 quad_perm:[1,1,3,3] row_mask:0x1 bank_mask:0xf
  v_smfmac_f32_16x16x64_bf16 v[32:35], v[24:27], a[32:39], v6
  v_add_f32 v21, v37, v39
  v_add_f32 v20, v36, v38
  v_smfmac_f32_16x16x64_bf16 v[32:35], v[28:31], a[40:47], v6
  s_nop 0
  v_add_f32_dpp v13, v21, v20 quad_perm:[1,1,3,3] row_mask:0x2 bank_mask:0xf
  v_smfmac_f32_16x16x64_bf16 v[36:39], v[24:27], a[48:55], v6
  v_add_f32 v19, v41, v43
  v_add_f32 v18, v40, v42
  v_smfmac_f32_16x16x64_bf16 v[36:39], v[28:31], a[56:63], v6
  s_nop 0
  v_add_f32_dpp v13, v19, v18 quad_perm:[1,1,3,3] row_mask:0x4 bank_mask:0xf
  v_cmp_gt_u32 vcc, s22, v15
  v_mov_b32 v23, 0xff800000
  v_add_f32 v21, v45, v47
  v_add_f32 v20, v44, v46
  s_nop 1
  v_add_f32_dpp v13, v21, v20 quad_perm:[1,1,3,3] row_mask:0x8 bank_mask:0xf
  v_add_f32 v19, v33, v35
  v_add_f32 v18, v32, v34
  s_nop 1
  v_add_f32_dpp v14, v19, v18 quad_perm:[1,1,3,3] row_mask:0x1 bank_mask:0xf
  v_add_f32 v21, v37, v39
  v_add_f32 v20, v36, v38
  s_nop 1
  v_add_f32_dpp v14, v21, v20 quad_perm:[1,1,3,3] row_mask:0x2 bank_mask:0xf
  v_sub_f32 v14, v14, v13
  v_sub_f32 v13, v13, v12
  v_cndmask_b32 v14, v23, v14, vcc
  v_max3_f32 v16, v12, v13, v14
  s_nop 1
  v_max_f32_dpp v16, v16, v16 quad_perm:[2,3,0,1] row_mask:0xf bank_mask:0xf
  s_nop 1
  v_max_f32_dpp v16, v16, v16 row_ror:4 row_mask:0xf bank_mask:0xf
  s_nop 1
  v_max_f32_dpp v18, v16, v16 row_ror:8 row_mask:0xf bank_mask:0xf
  v_max_f32_dpp v16, v16, v16 row_ror:8 row_mask:0xf bank_mask:0xf
  s_nop 1
  v_permlane16_swap_b32 v16, v18
  v_max_f32 v19, v16, v18
  v_max_f32 v16, v16, v18
  s_nop 1
  v_permlane32_swap_b32 v16, v19
  v_max_f32 v16, v16, v19
  v_mul_f32 v16, s51, v16
  v_cmp_lt_f32 vcc, s50, abs(v16)
  s_nop 1
  v_cndmask_b32 v16, 0, v16, vcc
  v_fma_f32 v12, v12, s51, -v16
  v_fma_f32 v14, v14, s51, -v16
  v_fma_f32 v13, v13, s51, -v16
  v_exp_f32 v12, v12
  v_exp_f32 v14, v14
  v_exp_f32 v13, v13
  s_cmp_gt_u32 s59, 1
  s_cbranch_scc1 L_lv_74
  s_cmp_gt_u32 s59, 0
  s_cbranch_scc1 L_lv_73
  s_waitcnt vmcnt(6)
L_lv_73:
  s_waitcnt vmcnt(9)
L_lv_74:
  buffer_load_dwordx4 a[84:87], v2, s[12:15], s41 offen offset:256 nt
  v_add_f32 v17, v12, v13
  v_mov_b32_dpp v18, v12 quad_perm:[0,0,0,0] row_mask:0xf bank_mask:0xf
  v_add_f32 v17, v14, v17
  v_mov_b32_dpp v19, v12 quad_perm:[2,2,2,2] row_mask:0xf bank_mask:0xf
  s_nop 0
  v_add_f32_dpp v17, v17, v17 quad_perm:[2,3,0,1] row_mask:0xf bank_mask:0xf
  v_cvt_pk_bf16_f32 v20, v18, v19
  s_nop 0
  v_add_f32_dpp v17, v17, v17 row_ror:4 row_mask:0xf bank_mask:0xf
  v_mov_b32_dpp v18, v14 quad_perm:[0,0,0,0] row_mask:0xf bank_mask:0xf
  s_nop 0
  v_add_f32_dpp v17, v17, v17 row_ror:8 row_mask:0xf bank_mask:0xf
  v_mov_b32_dpp v19, v14 quad_perm:[2,2,2,2] row_mask:0xf bank_mask:0xf
  v_mov_b32 v23, v17
  v_cvt_pk_bf16_f32 v22, v18, v19
  s_nop 0
  v_permlane16_swap_b32 v17, v23
  v_mov_b32_dpp v0, v22 row_shl:4 row_mask:0xf bank_mask:0xf
  v_add_f32 v17, v17, v23
  s_nop 0
  v_permlane32_swap_b32 v22, v0
  v_mov_b32 v23, v17
  v_mov_b32_dpp v18, v13 quad_perm:[0,0,0,0] row_mask:0xf bank_mask:0xf
  s_nop 0
  v_permlane32_swap_b32 v17, v23
  v_mov_b32_dpp v19, v13 quad_perm:[2,2,2,2] row_mask:0xf bank_mask:0xf
  v_add_f32 v17, v17, v23
  v_cvt_pk_bf16_f32 v21, v18, v19
  v_lshrrev_b32 v18, 6, v4
  v_lshl_add_u32 v18, v18, 4, s57
  v_mov_b32 v19, s55
  ds_write_b96 v18, v[20:22]
  s_mov_b64 exec, 1
  ds_write_b64 v19, v[16:17] offset:10240
  s_mov_b64 exec, -1
  s_cmp_gt_u32 s59, 1
  s_cbranch_scc1 L_lv_76
  s_cmp_gt_u32 s59, 0
  s_cbranch_scc1 L_lv_75
  s_waitcnt vmcnt(5)
L_lv_75:
  s_waitcnt vmcnt(9)
L_lv_76:
  buffer_load_dwordx4 a[92:95], v2, s[12:15], s41 offen offset:384 nt
L_st0r:
  v_mov_b64 v[32:33], 0
  v_mov_b64 v[34:35], 0
  v_mov_b64 v[36:37], 0
  v_mov_b64 v[38:39], 0
  v_mov_b64 v[40:41], 0
  v_mov_b64 v[42:43], 0
  v_mov_b64 v[44:45], 0
  v_mov_b64 v[46:47], 0
  s_cmp_gt_u32 s59, 1
  s_cbranch_scc1 L_lv_78
  s_cmp_gt_u32 s59, 0
  s_cbranch_scc1 L_lv_77
  s_waitcnt vmcnt(5)
L_lv_77:
  s_waitcnt vmcnt(9)
L_lv_78:
  s_waitcnt vmcnt(12)
  buffer_load_dwordx4 a[100:103], v2, s[12:15], s41 offen offset:1024 nt
  s_add_u32 s38, s35, 7
  v_mov_b32 v18, s38
  s_mov_b64 exec, 1
  buffer_store_dword v18, off, s[16:19], s25
  s_mov_b64 exec, -1
  s_cmp_gt_u32 s59, 1
  s_cbranch_scc1 L_lv_80
  s_cmp_gt_u32 s59, 0
  s_cbranch_scc1 L_lv_79
  s_waitcnt vmcnt(6)
L_lv_79:
  s_waitcnt vmcnt(10)
L_lv_80:
  s_waitcnt vmcnt(13)
  buffer_load_dwordx4 a[108:111], v2, s[12:15], s41 offen offset:1152 nt
  s_cmp_gt_u32 s59, 1
  s_cbranch_scc1 L_lv_82
  s_cmp_gt_u32 s59, 0
  s_cbranch_scc1 L_lv_81
  s_waitcnt vmcnt(6)
L_lv_81:
  s_waitcnt vmcnt(9)
L_lv_82:
  s_waitcnt vmcnt(13)
  buffer_load_dwordx4 a[116:119], v2, s[12:15], s41 offen offset:1280 nt
  s_cmp_gt_u32 s59, 1
  s_cbranch_scc1 L_lv_84
  s_cmp_gt_u32 s59, 0
  s_cbranch_scc1 L_lv_83
  s_waitcnt vmcnt(6)
L_lv_83:
  s_waitcnt vmcnt(9)
L_lv_84:
  s_waitcnt vmcnt(13)
  buffer_load_dwordx4 a[124:127], v2, s[12:15], s41 offen offset:1408 nt
  s_add_u32 m0, s45, 0
  s_cmp_gt_u32 s59, 1
  s_cbranch_scc1 L_lv_86
  s_cmp_gt_u32 s59, 0
  s_cbranch_scc1 L_lv_85
  s_waitcnt vmcnt(6)
L_lv_85:
  s_waitcnt vmcnt(9)
L_lv_86:
  s_waitcnt vmcnt(13)
  buffer_load_dwordx4 v2, s[12:15], s42 offen offset:0 nt lds
  s_add_u32 m0, s45, 896
  s_cmp_gt_u32 s59, 1
  s_cbranch_scc1 L_lv_88
  s_cmp_gt_u32 s59, 0
  s_cbranch_scc1 L_lv_87
  s_waitcnt vmcnt(6)
L_lv_87:
  s_waitcnt vmcnt(9)
L_lv_88:
  s_waitcnt vmcnt(12)
  buffer_load_dwordx4 v2, s[12:15], s42 offen offset:128 nt lds
  s_cmp_lg_u32 s49, 0
  s_cbranch_scc1 L_it0_89
  v_mov_b32 v22, 0
  global_load_dword v23, v22, s[84:85] offset:16 sc1
L_it0_89:
  buffer_load_dwordx4 v[24:27], v5, s[16:19], s46 offen sc1
  buffer_load_dwordx4 v[28:31], v5, s[16:19], s46 offen offset:256 sc1
  s_add_u32 m0, s45, 1792
  s_cmp_gt_u32 s59, 1
  s_cbranch_scc1 L_lv_91
  s_cmp_gt_u32 s59, 0
  s_cbranch_scc1 L_lv_90
  s_waitcnt vmcnt(8)
L_lv_90:
  s_waitcnt vmcnt(11)
L_lv_91:
  s_waitcnt vmcnt(14)
  buffer_load_dwordx4 v2, s[12:15], s42 offen offset:256 nt lds
  s_add_u32 m0, s45, 2688
  s_cmp_gt_u32 s59, 1
  s_cbranch_scc1 L_lv_93
  s_cmp_gt_u32 s59, 0
  s_cbranch_scc1 L_lv_92
  s_waitcnt vmcnt(7)
L_lv_92:
  s_waitcnt vmcnt(11)
L_lv_93:
  s_waitcnt vmcnt(14)
  buffer_load_dwordx4 v2, s[12:15], s42 offen offset:384 nt lds
  s_add_u32 m0, s45, 3072
  s_cmp_gt_u32 s59, 1
  s_cbranch_scc1 L_lv_95
  s_cmp_gt_u32 s59, 0
  s_cbranch_scc1 L_lv_94
  s_waitcnt vmcnt(7)
L_lv_94:
  s_waitcnt vmcnt(11)
L_lv_95:
  s_waitcnt vmcnt(14)
  buffer_load_dwordx4 v2, s[12:15], s42 offen offset:1024 nt lds
  s_add_u32 s38, s35, 8
  v_mov_b32 v18, s38
  s_mov_b64 exec, 1
  buffer_store_dword v18, off, s[16:19], s25
  s_mov_b64 exec, -1
  s_add_u32 m0, s45, 3968
  s_cmp_gt_u32 s59, 1
  s_cbranch_scc1 L_lv_97
  s_cmp_gt_u32 s59, 0
  s_cbranch_scc1 L_lv_96
  s_waitcnt vmcnt(8)
L_lv_96:
  s_waitcnt vmcnt(12)
L_lv_97:
  s_waitcnt vmcnt(15)
  buffer_load_dwordx4 v2, s[12:15], s42 offen offset:1152 nt lds
  s_add_u32 m0, s45, 4864
  s_cmp_gt_u32 s59, 1
  s_cbranch_scc1 L_lv_99
  s_cmp_gt_u32 s59, 0
  s_cbranch_scc1 L_lv_98
  s_waitcnt vmcnt(8)
L_lv_98:
  s_waitcnt vmcnt(11)
L_lv_99:
  s_waitcnt vmcnt(15)
  buffer_load_dwordx4 v2, s[12:15], s42 offen offset:1280 nt lds
  s_add_u32 m0, s45, 5760
  s_cmp_gt_u32 s59, 1
  s_cbranch_scc1 L_lv_101
  s_cmp_gt_u32 s59, 0
  s_cbranch_scc1 L_lv_100
  s_waitcnt vmcnt(8)
L_lv_100:
  s_waitcnt vmcnt(11)
L_lv_101:
  s_waitcnt vmcnt(15)
  buffer_load_dwordx4 v2, s[12:15], s42 offen offset:1408 nt lds
  s_add_u32 m0, s45, 8192
  s_cmp_gt_u32 s59, 1
  s_cbranch_scc1 L_lv_103
  s_cmp_gt_u32 s59, 0
  s_cbranch_scc1 L_lv_102
  s_waitcnt vmcnt(6)
L_lv_102:
  s_waitcnt vmcnt(11)
L_lv_103:
  s_waitcnt vmcnt(15)
  buffer_load_dwordx4 v2, s[12:15], s43 offen offset:0 nt lds
  s_waitcnt vmcnt(8)
  s_mov_b32 s58, 0
  v_max3_u32 v18, v24, v25, v26
  v_max3_u32 v18, v18, v27, v28
  v_max3_u32 v18, v18, v29, v30
  v_max3_u32 v18, v18, v31, v31
  v_cmp_eq_u32 vcc, -1, v18
  s_cmp_eq_u32 s49, 0
  s_cbranch_scc1 L_En
  s_cbranch_vccz L_E0
L_En:
  s_add_u32 m0, s45, 9088
  s_cmp_gt_u32 s59, 0
  s_cbranch_scc1 L_lv_104
  s_waitcnt vmcnt(6)
L_lv_104:
  buffer_load_dwordx4 v2, s[12:15], s43 offen offset:128 nt lds
  s_cmp_lg_u32 s49, 0
  s_cbranch_scc1 L_it0_105
  s_waitcnt vmcnt(8)
  s_branch L_cntc_107
L_cnt_106:
  s_sub_u32 s52, s52, 1
  s_cbranch_scc1 L_bail
  global_load_dword v23, v22, s[84:85] offset:16 sc1
  s_waitcnt vmcnt(0)
L_cntc_107:
  v_and_b32 v21, 0xff, v23
  v_cmp_gt_u32 vcc, 32, v21
  s_cbranch_vccnz L_cnt_106
  v_readfirstlane_b32 s27, v23
  s_add_u32 s27, s27, s5
L_it0_105:
  v_lshrrev_b32 v19, 1, v4
  buffer_load_dword v16, v19, s[16:19], s20 offen sc1
  buffer_load_dwordx4 v[24:27], v5, s[16:19], s46 offen sc1
  buffer_load_dwordx4 v[28:31], v5, s[16:19], s46 offen offset:256 sc1
  s_add_u32 m0, s45, 9984
  s_cmp_gt_u32 s59, 0
  s_cbranch_scc1 L_lv_108
  s_waitcnt vmcnt(9)
L_lv_108:
  buffer_load_dwordx4 v2, s[12:15], s43 offen offset:256 nt lds
  s_add_u32 m0, s45, 10880
  s_cmp_gt_u32 s59, 1
  s_cbranch_scc1 L_lv_110
  s_cmp_gt_u32 s59, 0
  s_cbranch_scc1 L_lv_109
  s_waitcnt vmcnt(8)
L_lv_109:
  s_waitcnt vmcnt(12)
L_lv_110:
  buffer_load_dwordx4 v2, s[12:15], s43 offen offset:384 nt lds
  s_add_u32 m0, s45, 11264
  s_cmp_gt_u32 s59, 1
  s_cbranch_scc1 L_lv_112
  s_cmp_gt_u32 s59, 0
  s_cbranch_scc1 L_lv_111
  s_waitcnt vmcnt(8)
L_lv_111:
  s_waitcnt vmcnt(12)
L_lv_112:
  buffer_load_dwordx4 v2, s[12:15], s43 offen offset:1024 nt lds
  s_add_u32 s38, s35, 9
  v_mov_b32 v18, s38
  s_mov_b64 exec, 1
  buffer_store_dword v18, off, s[16:19], s25
  s_mov_b64 exec, -1
  s_add_u32 m0, s45, 12160
  s_cmp_gt_u32 s59, 1
  s_cbranch_scc1 L_lv_114
  s_cmp_gt_u32 s59, 0
  s_cbranch_scc1 L_lv_113
  s_waitcnt vmcnt(9)
L_lv_113:
  s_waitcnt vmcnt(13)
L_lv_114:
  buffer_load_dwordx4 v2, s[12:15], s43 offen offset:1152 nt lds
  buffer_load_dwordx4 v[24:27], v5, s[16:19], s46 offen sc1
  buffer_load_dwordx4 v[28:31], v5, s[16:19], s46 offen offset:256 sc1
  s_add_u32 m0, s45, 13056
  s_cmp_gt_u32 s59, 1
  s_cbranch_scc1 L_lv_116
  s_cmp_gt_u32 s59, 0
  s_cbranch_scc1 L_lv_115
  s_waitcnt vmcnt(11)
L_lv_115:
  s_waitcnt vmcnt(14)
L_lv_116:
  s_waitcnt vmcnt(18)
  buffer_load_dwordx4 v2, s[12:15], s43 offen offset:1280 nt lds
  s_add_u32 m0, s45, 13952
  s_cmp_gt_u32 s59, 1
  s_cbranch_scc1 L_lv_118
  s_cmp_gt_u32 s59, 0
  s_cbranch_scc1 L_lv_117
  s_waitcnt vmcnt(11)
L_lv_117:
  s_waitcnt vmcnt(14)
L_lv_118:
  s_waitcnt vmcnt(18)
  buffer_load_dwordx4 v2, s[12:15], s43 offen offset:1408 nt lds
  s_add_u32 m0, s45, 16384
  s_cmp_gt_u32 s59, 1
  s_cbranch_scc1 L_lv_120
  s_cmp_gt_u32 s59, 0
  s_cbranch_scc1 L_lv_119
  s_waitcnt vmcnt(8)
L_lv_119:
  s_waitcnt vmcnt(14)
L_lv_120:
  s_waitcnt vmcnt(18)
  buffer_load_dwordx4 v2, s[92:95], s44 offen offset:0 nt lds
  s_mov_b32 s59, 1
  s_waitcnt vmcnt(10)
  v_max3_u32 v18, v24, v25, v26
  v_max3_u32 v18, v18, v27, v28
  v_max3_u32 v18, v18, v29, v30
  v_max3_u32 v18, v18, v31, v31
  v_cmp_eq_u32 vcc, -1, v18
  s_cbranch_vccz L_Xok0
  s_movk_i32 s34, 6
  s_movk_i32 s32, 0
  s_call_b64 s[96:97], L_help
  s_waitcnt vmcnt(3)
L_X0:
  v_max3_u32 v18, v24, v25, v26
  v_max3_u32 v18, v18, v27, v28
  v_max3_u32 v18, v18, v29, v30
  v_max3_u32 v18, v18, v31, v31
  v_cmp_eq_u32 vcc, -1, v18
  s_cbranch_vccz L_Xok0
L_Xpoll0:
  s_mov_b32 s59, 1
  s_sub_u32 s52, s52, 1
  s_cbranch_scc1 L_bail
  v_lshrrev_b32 v19, 1, v4
  buffer_load_dword v16, v19, s[16:19], s20 offen sc1
  buffer_load_dwordx4 v[24:27], v5, s[16:19], s46 offen sc1
  buffer_load_dwordx4 v[28:31], v5, s[16:19], s46 offen offset:256 sc1
  s_waitcnt vmcnt(0)
  v_max3_u32 v18, v24, v25, v26
  v_max3_u32 v18, v18, v27, v28
  v_max3_u32 v18, v18, v29, v30
  v_max3_u32 v18, v18, v31, v31
  v_cmp_eq_u32 vcc, -1, v18
  s_cbranch_vccz L_Xok0
  s_movk_i32 s32, 0
  s_call_b64 s[96:97], L_help
  s_branch L_Xpoll0
L_Xok0:
  s_add_u32 s38, s35, 10
  v_mov_b32 v18, s38
  s_mov_b64 exec, 1
  buffer_store_dword v18, off, s[16:19], s25
  s_mov_b64 exec, -1
  s_cmp_eq_u32 s49, 0
  s_cbranch_scc1 L_first
  v_smfmac_f32_16x16x64_bf16 v[32:35], v[24:27], v[160:167], v6
  v_smfmac_f32_16x16x64_bf16 v[32:35], v[28:31], v[168:175], v6
  ds_read_b128 v[160:163], v3 offset:33792
  ds_read_b128 v[164:167], v3 offset:34816
  ds_read_b128 v[168:171], v3 offset:35840
  ds_read_b128 v[172:175], v3 offset:36864
  v_smfmac_f32_16x16x64_bf16 v[36:39], v[24:27], v[176:183], v6
  v_smfmac_f32_16x16x64_bf16 v[36:39], v[28:31], v[184:191], v6
  v_smfmac_f32_16x16x64_bf16 v[40:43], v[24:27], v[192:199], v6
  v_smfmac_f32_16x16x64_bf16 v[40:43], v[28:31], v[200:207], v6
  s_waitcnt lgkmcnt(0)
  s_add_u32 m0, s45, 33792
  s_nop 0
  buffer_load_dwordx4 v2, s[92:95], s44 offen offset:1024 nt lds
  s_add_u32 m0, s45, 35712
  s_nop 0
  buffer_load_dwordx4 v2, s[92:95], s44 offen offset:128 nt lds
  s_add_u32 m0, s45, 35712
  s_nop 0
  buffer_load_dwordx4 v2, s[92:95], s44 offen offset:1152 nt lds
  ds_read_b128 v[192:195], v3 offset:17408
  ds_read_b128 v[196:199], v3 offset:25600
  ds_read_b128 v[200:203], v3 offset:18432
  ds_read_b128 v[204:207], v3 offset:26624
  v_smfmac_f32_16x16x64_bf16 v[44:47], v[24:27], v[208:215], v6
  v_add_f32 v19, v33, v35
  v_add_f32 v18, v32, v34
  v_smfmac_f32_16x16x64_bf16 v[44:47], v[28:31], v[216:223], v6
  s_nop 0
  v_add_f32_dpp v12, v19, v18 quad_perm:[1,1,3,3] row_mask:0x1 bank_mask:0xf
  buffer_load_dwordx4 v[176:179], v2, s[92:95], s44 offen offset:256 nt
  buffer_load_dwordx4 v[180:183], v2, s[92:95], s44 offen offset:1280 nt
  ds_read_b128 v[208:211], v3 offset:19456
  ds_read_b128 v[212:215], v3 offset:27648
  ds_read_b128 v[216:219], v3 offset:20480
  ds_read_b128 v[220:223], v3 offset:28672
  v_smfmac_f32_16x16x64_bf16 v[32:35], v[24:27], v[224:231], v6
  v_add_f32 v21, v37, v39
  v_add_f32 v20, v36, v38
  v_smfmac_f32_16x16x64_bf16 v[32:35], v[28:31], v[232:239], v6
  s_nop 0
  v_add_f32_dpp v12, v21, v20 quad_perm:[1,1,3,3] row_mask:0x2 bank_mask:0xf
  buffer_load_dwordx4 v[184:187], v2, s[92:95], s44 offen offset:384 nt
  buffer_load_dwordx4 v[188:191], v2, s[92:95], s44 offen offset:1408 nt
  ds_read_b128 v[224:227], v3 offset:21504
  ds_read_b128 v[228:231], v3 offset:29696
  v_smfmac_f32_16x16x64_bf16 v[36:39], v[24:27], v[240:247], v6
  v_add_f32 v19, v41, v43
  v_add_f32 v18, v40, v42
  v_smfmac_f32_16x16x64_bf16 v[36:39], v[28:31], v[248:255], v6
  s_nop 0
  v_add_f32_dpp v12, v19, v18 quad_perm:[1,1,3,3] row_mask:0x4 bank_mask:0xf
  ds_read_b128 v[232:235], v3 offset:22528
  ds_read_b128 v[236:239], v3 offset:30720
  v_smfmac_f32_16x16x64_bf16 v[40:43], v[24:27], a[128:135], v6
  v_add_f32 v21, v45, v47
  v_add_f32 v20, v44, v46
  v_smfmac_f32_16x16x64_bf16 v[40:43], v[28:31], a[136:143], v6
  s_nop 0
  v_add_f32_dpp v12, v21, v20 quad_perm:[1,1,3,3] row_mask:0x8 bank_mask:0xf
  ds_read_b128 v[240:243], v3 offset:23552
  ds_read_b128 v[244:247], v3 offset:31744
  v_smfmac_f32_16x16x64_bf16 v[44:47], v[24:27], a[144:151], v6
  v_add_f32 v19, v33, v35
  v_add_f32 v18, v32, v34
  v_smfmac_f32_16x16x64_bf16 v[44:47], v[28:31], a[152:159], v6
  s_nop 0
  v_add_f32_dpp v13, v19, v18 quad_perm:[1,1,3,3] row_mask:0x1 bank_mask:0xf
  ds_read_b128 v[248:251], v3 offset:24576
  ds_read_b128 v[252:255], v3 offset:32768
  v_smfmac_f32_16x16x64_bf16 v[32:35], v[24:27], a[160:167], v6
  v_add_f32 v21, v37, v39
  v_add_f32 v20, v36, v38
  v_smfmac_f32_16x16x64_bf16 v[32:35], v[28:31], a[168:175], v6
  s_nop 0
  v_add_f32_dpp v13, v21, v20 quad_perm:[1,1,3,3] row_mask:0x2 bank_mask:0xf
  v_smfmac_f32_16x16x64_bf16 v[36:39], v[24:27], a[176:183], v6
  v_add_f32 v19, v41, v43
  v_add_f32 v18, v40, v42
  v_smfmac_f32_16x16x64_bf16 v[36:39], v[28:31], a[184:191], v6
  s_nop 0
  v_add_f32_dpp v13, v19, v18 quad_perm:[1,1,3,3] row_mask:0x4 bank_mask:0xf
  s_add_u32 s40, s40, 0x2000000
  s_add_u32 s41, s41, 0x2000000
  s_add_u32 s42, s42, 0x2000000
  s_add_u32 s43, s43, 0x2000000
  s_add_u32 s44, s44, 0x2000000
  s_add_u32 s90, s90, 0x2000000
  s_min_u32 s90, s90, s10
  s_mov_b32 s94, s90
  buffer_load_dwordx4 a[128:131], v1, s[8:11], s43 offen offset:0 nt
  v_cmp_gt_u32 vcc, s23, v15
  v_mov_b32 v23, 0xff800000
  v_add_f32 v21, v45, v47
  v_add_f32 v20, v44, v46
  v_mov_b32 v40, 0
  s_nop 0
  v_add_f32_dpp v13, v21, v20 quad_perm:[1,1,3,3] row_mask:0x8 bank_mask:0xf
  v_mov_b32 v41, 0
  v_mov_b32 v42, 0
  v_mov_b32 v43, 0
  v_add_f32 v19, v33, v35
  v_add_f32 v18, v32, v34
  v_mov_b32 v44, 0
  s_nop 0
  v_add_f32_dpp v14, v19, v18 quad_perm:[1,1,3,3] row_mask:0x1 bank_mask:0xf
  v_mov_b32 v45, 0
  v_mov_b32 v46, 0
  v_add_f32 v21, v37, v39
  v_add_f32 v20, v36, v38
  v_mov_b32 v47, 0
  s_nop 0
  v_add_f32_dpp v14, v21, v20 quad_perm:[1,1,3,3] row_mask:0x2 bank_mask:0xf
  v_sub_f32 v14, v14, v13
  v_sub_f32 v13, v13, v12
  v_cndmask_b32 v14, v23, v14, vcc
  v_max3_f32 v16, v12, v13, v14
  v_mov_b32 v32, 0
  v_mov_b32 v33, 0
  v_max_f32_dpp v16, v16, v16 quad_perm:[2,3,0,1] row_mask:0xf bank_mask:0xf
  v_mov_b32 v34, 0
  v_mov_b32 v35, 0
  v_max_f32_dpp v16, v16, v16 row_ror:4 row_mask:0xf bank_mask:0xf
  v_mov_b32 v36, 0
  v_mov_b32 v37, 0
  v_max_f32_dpp v18, v16, v16 row_ror:8 row_mask:0xf bank_mask:0xf
  v_max_f32_dpp v16, v16, v16 row_ror:8 row_mask:0xf bank_mask:0xf
  v_mov_b32 v38, 0
  v_mov_b32 v39, 0
  v_permlane16_swap_b32 v16, v18
  v_max_f32 v19, v16, v18
  v_max_f32 v16, v16, v18
  s_nop 1
  v_permlane32_swap_b32 v16, v19
  v_max_f32 v16, v16, v19
  v_mul_f32 v16, s51, v16
  v_cmp_lt_f32 vcc, s50, abs(v16)
  s_nop 1
  v_cndmask_b32 v16, 0, v16, vcc
  v_fma_f32 v12, v12, s51, -v16
  v_fma_f32 v14, v14, s51, -v16
  v_fma_f32 v13, v13, s51, -v16
  v_exp_f32 v12, v12
  v_exp_f32 v14, v14
  v_exp_f32 v13, v13
  buffer_load_dwordx4 a[132:135], v1, s[8:11], s43 offen offset:128 nt
  s_cmp_lg_u32 s58, 0
  s_cbranch_scc1 L_eq_121
  s_waitcnt vmcnt(13)
L_eq_121:
  v_mov_b32_dpp v18, v12 quad_perm:[0,0,0,0] row_mask:0xf bank_mask:0xf
  v_mov_b32_dpp v19, v12 quad_perm:[2,2,2,2] row_mask:0xf bank_mask:0xf
  v_cvt_pk_bf16_f32 v20, v18, v19
  v_and_b32 v24, v20, v8
  v_and_b32 v26, v20, v10
  v_and_b32_dpp v25, v20, v9 row_shr:4 row_mask:0xf bank_mask:0xf bound_ctrl:0
  v_and_b32_dpp v27, v20, v11 row_shr:4 row_mask:0xf bank_mask:0xf bound_ctrl:0
  s_nop 1
  v_smfmac_f32_16x16x64_bf16 v[32:35], v[24:27], a[192:199], v7
  v_mov_b32_dpp v18, v14 quad_perm:[0,0,0,0] row_mask:0xf bank_mask:0xf
  v_mov_b32_dpp v19, v14 quad_perm:[2,2,2,2] row_mask:0xf bank_mask:0xf
  v_cvt_pk_bf16_f32 v22, v18, v19
  v_smfmac_f32_16x16x64_bf16 v[36:39], v[24:27], a[200:207], v7
  s_nop 0
  v_mov_b32_dpp v0, v22 row_shl:4 row_mask:0xf bank_mask:0xf
  s_nop 1
  v_permlane32_swap_b32 v22, v0
  v_smfmac_f32_16x16x64_bf16 v[40:43], v[24:27], a[208:215], v7
  v_and_b32 v28, v22, v8
  v_and_b32 v30, v22, v10
  v_smfmac_f32_16x16x64_bf16 v[44:47], v[24:27], a[216:223], v7
  v_and_b32_dpp v29, v22, v9 row_shr:4 row_mask:0xf bank_mask:0xf bound_ctrl:0
  v_and_b32_dpp v31, v22, v11 row_shr:4 row_mask:0xf bank_mask:0xf bound_ctrl:0
  buffer_load_dwordx4 a[136:139], v1, s[8:11], s43 offen offset:256 nt
  s_nop 0
  v_smfmac_f32_16x16x64_bf16 v[32:35], v[28:31], v[160:167], v7
  v_and_b32 v25, v20, v9
  v_add_f32 v17, v12, v13
  v_smfmac_f32_16x16x64_bf16 v[36:39], v[28:31], v[168:175], v7
  v_and_b32 v27, v20, v11
  v_add_f32 v17, v14, v17
  v_smfmac_f32_16x16x64_bf16 v[40:43], v[28:31], v[48:55], v7
  v_and_b32_dpp v24, v20, v8 row_shl:4 row_mask:0xf bank_mask:0xf bound_ctrl:0
  v_add_f32_dpp v17, v17, v17 quad_perm:[2,3,0,1] row_mask:0xf bank_mask:0xf
  v_smfmac_f32_16x16x64_bf16 v[44:47], v[28:31], v[56:63], v7
  v_and_b32_dpp v26, v20, v10 row_shl:4 row_mask:0xf bank_mask:0xf bound_ctrl:0
  v_add_f32_dpp v17, v17, v17 row_ror:4 row_mask:0xf bank_mask:0xf
  s_nop 0
  v_smfmac_f32_16x16x64_bf16 v[32:35], v[24:27], a[224:231], v7
  v_mov_b32_dpp v18, v13 quad_perm:[0,0,0,0] row_mask:0xf bank_mask:0xf
  v_mov_b32_dpp v19, v13 quad_perm:[2,2,2,2] row_mask:0xf bank_mask:0xf
  v_smfmac_f32_16x16x64_bf16 v[36:39], v[24:27], a[232:239], v7
  v_cvt_pk_bf16_f32 v21, v18, v19
  v_and_b32 v28, v21, v8
  v_smfmac_f32_16x16x64_bf16 v[40:43], v[24:27], a[240:247], v7
  v_and_b32 v30, v21, v10
  v_and_b32_dpp v29, v21, v9 row_shr:4 row_mask:0xf bank_mask:0xf bound_ctrl:0
  v_smfmac_f32_16x16x64_bf16 v[44:47], v[24:27], a[248:255], v7
  v_and_b32_dpp v31, v21, v11 row_shr:4 row_mask:0xf bank_mask:0xf bound_ctrl:0
  v_add_f32_dpp v17, v17, v17 row_ror:8 row_mask:0xf bank_mask:0xf
  buffer_load_dwordx4 a[140:143], v1, s[8:11], s43 offen offset:384 nt
  s_waitcnt lgkmcnt(15)
  s_waitcnt lgkmcnt(14)
  v_smfmac_f32_16x16x64_bf16 v[32:35], v[28:31], v[192:199], v7
  v_and_b32 v25, v21, v9
  v_mov_b32 v23, v17
  s_waitcnt lgkmcnt(13)
  s_waitcnt lgkmcnt(12)
  v_smfmac_f32_16x16x64_bf16 v[36:39], v[28:31], v[200:207], v7
  v_and_b32 v27, v21, v11
  v_permlane16_swap_b32 v17, v23
  s_waitcnt lgkmcnt(11)
  s_waitcnt lgkmcnt(10)
  v_smfmac_f32_16x16x64_bf16 v[40:43], v[28:31], v[208:215], v7
  v_and_b32_dpp v24, v21, v8 row_shl:4 row_mask:0xf bank_mask:0xf bound_ctrl:0
  v_add_f32 v17, v17, v23
  s_waitcnt lgkmcnt(9)
  s_waitcnt lgkmcnt(8)
  v_smfmac_f32_16x16x64_bf16 v[44:47], v[28:31], v[216:223], v7
  v_and_b32_dpp v26, v21, v10 row_shl:4 row_mask:0xf bank_mask:0xf bound_ctrl:0
  v_mov_b32 v23, v17
  s_waitcnt lgkmcnt(7)
  s_waitcnt lgkmcnt(6)
  v_smfmac_f32_16x16x64_bf16 v[32:35], v[24:27], v[224:231], v7
  v_permlane32_swap_b32 v17, v23
  v_add_f32 v17, v17, v23
  s_waitcnt lgkmcnt(5)
  s_waitcnt lgkmcnt(4)
  v_smfmac_f32_16x16x64_bf16 v[36:39], v[24:27], v[232:239], v7
  v_add_u32 v18, s54, v4
  v_mov_b32 v19, s55
  s_waitcnt lgkmcnt(3)
  s_waitcnt lgkmcnt(2)
  v_smfmac_f32_16x16x64_bf16 v[40:43], v[24:27], v[240:247], v7
  v_mov_b32 v20, 1
  v_mov_b32 v21, 0
  s_waitcnt lgkmcnt(1)
  s_waitcnt lgkmcnt(0)
  v_smfmac_f32_16x16x64_bf16 v[44:47], v[24:27], v[248:255], v7
  v_mov_b32 v22, s48
  buffer_load_dwordx4 a[144:147], v1, s[8:11], s43 offen offset:512 nt
  v_permlane32_swap_b32 v32, v36
  v_permlane32_swap_b32 v33, v37
  v_permlane32_swap_b32 v34, v38
  v_permlane32_swap_b32 v35, v39
  v_add_f32_dpp v32, v36, v32 row_ror:8 row_mask:0xf bank_mask:0x3
  v_add_f32_dpp v33, v37, v33 row_ror:8 row_mask:0xf bank_mask:0x3
  v_add_f32_dpp v34, v38, v34 row_ror:8 row_mask:0xf bank_mask:0x3
  v_add_f32_dpp v35, v39, v35 row_ror:8 row_mask:0xf bank_mask:0x3
  v_permlane32_swap_b32 v40, v44
  v_permlane32_swap_b32 v41, v45
  v_permlane32_swap_b32 v42, v46
  v_permlane32_swap_b32 v43, v47
  v_add_f32_dpp v32, v40, v44 row_ror:8 row_mask:0xf bank_mask:0xc
  v_add_f32_dpp v33, v41, v45 row_ror:8 row_mask:0xf bank_mask:0xc
  v_add_f32_dpp v34, v42, v46 row_ror:8 row_mask:0xf bank_mask:0xc
  v_add_f32_dpp v35, v43, v47 row_ror:8 row_mask:0xf bank_mask:0xc
  buffer_load_dwordx4 a[148:151], v1, s[8:11], s43 offen offset:640 nt
  ds_write_b128 v18, v[32:35] offset:4096
  s_mov_b64 exec, 1
  ds_write_b64 v19, v[16:17] offset:10272
  ds_add_rtn_u32 v20, v21, v20 offset:10308
  s_mov_b64 exec, -1
  ds_read_b128 v[24:27], v21 offset:10272
  ds_read_b128 v[28:31], v21 offset:10288
  ds_read_b128 v[192:195], v4 offset:4096
  ds_read_b128 v[196:199], v4 offset:5120
  ds_read_b128 v[200:203], v4 offset:6144
  ds_read_b128 v[204:207], v4 offset:7168
  s_add_u32 s38, s47, 1572864
  s_waitcnt lgkmcnt(6)
  v_readfirstlane_b32 s39, v20
  s_and_b32 s39, s39, 3
  s_cmp_eq_u32 s39, 3
  s_cselect_b32 s58, 1, 0
  s_cbranch_scc0 L_nl_122
  s_waitcnt lgkmcnt(4)
  v_or3_b32 v16, v24, v26, v28
  v_add_f32 v17, v25, v27
  v_or_b32 v16, v16, v30
  v_add_f32 v23, v29, v31
  v_cmp_eq_u32 vcc, 0, v16
  v_add_f32 v17, v17, v23
  s_cbranch_vccz L_gen_123
  v_rcp_f32 v20, v17
  s_waitcnt lgkmcnt(2)
  v_pk_add_f32 v[32:33], v[192:193], v[196:197]
  v_pk_add_f32 v[34:35], v[194:195], v[198:199]
  s_waitcnt lgkmcnt(0)
  v_pk_add_f32 v[192:193], v[200:201], v[204:205]
  v_pk_add_f32 v[194:195], v[202:203], v[206:207]
  v_pk_add_f32 v[32:33], v[32:33], v[192:193]
  v_pk_add_f32 v[34:35], v[34:35], v[194:195]
L_join_124:
  s_cmp_eq_u32 s27, 33
  v_lshrrev_b32 v18, 1, v4
  v_pk_mul_f32 v[32:33], v[32:33], v[20:21] op_sel_hi:[1,0]
  v_pk_mul_f32 v[34:35], v[34:35], v[20:21] op_sel_hi:[1,0]
  v_cvt_pk_f16_f32 v32, v32, v33
  v_cvt_pk_f16_f32 v33, v34, v35
  v_min_u32 v32, -2, v32
  v_min_u32 v33, -2, v33
  v_and_b32 v17, -2, v17
  s_cbranch_scc0 L_ls_125
  buffer_store_dwordx2 v[32:33], v18, s[16:19], s38 offen
  s_mov_b64 exec, 1
  buffer_store_dwordx2 v[16:17], v22, s[16:19], s38 offen
  s_mov_b64 exec, -1
L_nl_122:
  s_waitcnt lgkmcnt(0)
L_PV0:
  v_lshrrev_b32 v18, 6, v4
  v_lshl_add_u32 v18, v18, 4, s57
  ds_read_b96 v[20:22], v18
  buffer_load_dwordx4 a[152:155], v1, s[8:11], s43 offen offset:768 nt
  buffer_load_dwordx4 a[156:159], v1, s[8:11], s43 offen offset:896 nt
  v_mov_b64 v[32:33], 0
  v_mov_b64 v[34:35], 0
  v_mov_b64 v[36:37], 0
  v_mov_b64 v[38:39], 0
  v_mov_b64 v[40:41], 0
  v_mov_b64 v[42:43], 0
  v_mov_b64 v[44:45], 0
  v_mov_b64 v[46:47], 0
  s_cmp_lg_u32 s58, 0
  s_cbranch_scc1 L_xs_126
  s_waitcnt vmcnt(17)
L_xs_126:
  s_waitcnt vmcnt(19)
  ds_read_b128 v[192:195], v3 offset:0
  ds_read_b128 v[196:199], v3 offset:8192
  ds_read_b128 v[200:203], v3 offset:1024
  ds_read_b128 v[204:207], v3 offset:9216
  ds_read_b128 v[208:211], v3 offset:2048
  ds_read_b128 v[212:215], v3 offset:10240
  ds_read_b128 v[216:219], v3 offset:3072
  ds_read_b128 v[220:223], v3 offset:11264
  s_waitcnt lgkmcnt(8)
  v_and_b32 v24, v20, v8
  v_and_b32 v26, v20, v10
  v_and_b32_dpp v25, v20, v9 row_shr:4 row_mask:0xf bank_mask:0xf bound_ctrl:0
  v_and_b32_dpp v27, v20, v11 row_shr:4 row_mask:0xf bank_mask:0xf bound_ctrl:0
  s_nop 1
  v_smfmac_f32_16x16x64_bf16 v[32:35], v[24:27], a[64:71], v7
  v_and_b32 v29, v20, v9
  v_smfmac_f32_16x16x64_bf16 v[36:39], v[24:27], a[72:79], v7
  v_and_b32 v31, v20, v11
  v_smfmac_f32_16x16x64_bf16 v[40:43], v[24:27], a[80:87], v7
  v_and_b32_dpp v28, v20, v8 row_shl:4 row_mask:0xf bank_mask:0xf bound_ctrl:0
  v_smfmac_f32_16x16x64_bf16 v[44:47], v[24:27], a[88:95], v7
  v_and_b32_dpp v30, v20, v10 row_shl:4 row_mask:0xf bank_mask:0xf bound_ctrl:0
  ds_read_b128 v[224:227], v3 offset:4096
  ds_read_b128 v[228:231], v3 offset:12288
  ds_read_b128 v[232:235], v3 offset:5120
  ds_read_b128 v[236:239], v3 offset:13312
  ds_read_b128 v[240:243], v3 offset:6144
  ds_read_b128 v[244:247], v3 offset:14336
  ds_read_b128 v[248:251], v3 offset:7168
  ds_read_b128 v[252:255], v3 offset:15360
  buffer_load_dwordx4 a[160:163], v1, s[88:91], s44 offen offset:0 nt
  buffer_load_dwordx4 a[164:167], v1, s[88:91], s44 offen offset:128 nt
  v_smfmac_f32_16x16x64_bf16 v[32:35], v[28:31], a[96:103], v7
  v_and_b32 v24, v21, v8
  v_smfmac_f32_16x16x64_bf16 v[36:39], v[28:31], a[104:111], v7
  v_and_b32 v26, v21, v10
  v_smfmac_f32_16x16x64_bf16 v[40:43], v[28:31], a[112:119], v7
  v_and_b32_dpp v25, v21, v9 row_shr:4 row_mask:0xf bank_mask:0xf bound_ctrl:0
  v_smfmac_f32_16x16x64_bf16 v[44:47], v[28:31], a[120:127], v7
  v_and_b32_dpp v27, v21, v11 row_shr:4 row_mask:0xf bank_mask:0xf bound_ctrl:0
  buffer_load_dwordx4 a[168:171], v1, s[88:91], s44 offen offset:256 nt
  s_waitcnt lgkmcnt(15)
  s_waitcnt lgkmcnt(14)
  v_smfmac_f32_16x16x64_bf16 v[32:35], v[24:27], v[192:199], v7
  v_and_b32 v29, v21, v9
  s_waitcnt lgkmcnt(13)
  s_waitcnt lgkmcnt(12)
  v_smfmac_f32_16x16x64_bf16 v[36:39], v[24:27], v[200:207], v7
  v_and_b32 v31, v21, v11
  s_waitcnt lgkmcnt(11)
  s_waitcnt lgkmcnt(10)
  v_smfmac_f32_16x16x64_bf16 v[40:43], v[24:27], v[208:215], v7
  v_and_b32_dpp v28, v21, v8 row_shl:4 row_mask:0xf bank_mask:0xf bound_ctrl:0
  s_waitcnt lgkmcnt(9)
  s_waitcnt lgkmcnt(8)
  v_smfmac_f32_16x16x64_bf16 v[44:47], v[24:27], v[216:223], v7
  v_and_b32_dpp v30, v21, v10 row_shl:4 row_mask:0xf bank_mask:0xf bound_ctrl:0
  buffer_load_dwordx4 a[172:175], v1, s[88:91], s44 offen offset:384 nt
  buffer_load_dwordx4 a[176:179], v1, s[88:91], s44 offen offset:512 nt
  s_waitcnt lgkmcnt(7)
  s_waitcnt lgkmcnt(6)
  v_smfmac_f32_16x16x64_bf16 v[32:35], v[28:31], v[224:231], v7
  v_and_b32 v24, v22, v8
  s_waitcnt lgkmcnt(5)
  s_waitcnt lgkmcnt(4)
  v_smfmac_f32_16x16x64_bf16 v[36:39], v[28:31], v[232:239], v7
  v_and_b32 v26, v22, v10
  s_waitcnt lgkmcnt(3)
  s_waitcnt lgkmcnt(2)
  v_smfmac_f32_16x16x64_bf16 v[40:43], v[28:31], v[240:247], v7
  v_and_b32_dpp v25, v22, v9 row_shr:4 row_mask:0xf bank_mask:0xf bound_ctrl:0
  s_waitcnt lgkmcnt(1)
  s_waitcnt lgkmcnt(0)
  v_smfmac_f32_16x16x64_bf16 v[44:47], v[28:31], v[248:255], v7
  v_and_b32_dpp v27, v22, v11 row_shr:4 row_mask:0xf bank_mask:0xf bound_ctrl:0
  buffer_load_dwordx4 a[180:183], v1, s[88:91], s44 offen offset:640 nt
  s_cmp_lg_u32 s58, 0
  s_cbranch_scc1 L_xs_127
  s_waitcnt vmcnt(20)
L_xs_127:
  s_waitcnt vmcnt(22)
  ds_read_b128 v[160:163], v3 offset:16384
  ds_read_b128 v[164:167], v3 offset:34816
  s_cmp_lg_u32 s58, 0
  s_cbranch_scc1 L_xs_128
  s_waitcnt vmcnt(18)
L_xs_128:
  s_waitcnt vmcnt(20)
  ds_read_b128 v[168:171], v3 offset:35840
  ds_read_b128 v[172:175], v3 offset:36864
  v_add_u32 v18, s54, v4
  v_mov_b32 v19, s55
  v_mov_b32 v20, 1
  v_mov_b32 v21, 0
  v_mov_b32 v22, s48
  s_waitcnt lgkmcnt(3)
  s_waitcnt lgkmcnt(2)
  v_smfmac_f32_16x16x64_bf16 v[32:35], v[24:27], v[160:167], v7
  s_waitcnt lgkmcnt(1)
  s_waitcnt lgkmcnt(0)
  v_smfmac_f32_16x16x64_bf16 v[36:39], v[24:27], v[168:175], v7
  s_cmp_lg_u32 s58, 0
  s_cbranch_scc1 L_xs_129
  s_waitcnt vmcnt(16)
L_xs_129:
  s_waitcnt vmcnt(18)
  v_smfmac_f32_16x16x64_bf16 v[40:43], v[24:27], v[176:183], v7
  s_cmp_lg_u32 s58, 0
  s_cbranch_scc1 L_xs_130
  s_waitcnt vmcnt(14)
L_xs_130:
  s_waitcnt vmcnt(16)
  v_smfmac_f32_16x16x64_bf16 v[44:47], v[24:27], v[184:191], v7
  v_permlane32_swap_b32 v32, v36
  v_permlane32_swap_b32 v33, v37
  v_permlane32_swap_b32 v34, v38
  v_permlane32_swap_b32 v35, v39
  v_add_f32_dpp v32, v36, v32 row_ror:8 row_mask:0xf bank_mask:0x3
  v_add_f32_dpp v33, v37, v33 row_ror:8 row_mask:0xf bank_mask:0x3
  v_add_f32_dpp v34, v38, v34 row_ror:8 row_mask:0xf bank_mask:0x3
  v_add_f32_dpp v35, v39, v35 row_ror:8 row_mask:0xf bank_mask:0x3
  s_nop 0
  v_permlane32_swap_b32 v40, v44
  v_permlane32_swap_b32 v41, v45
  v_permlane32_swap_b32 v42, v46
  v_permlane32_swap_b32 v43, v47
  v_add_f32_dpp v32, v40, v44 row_ror:8 row_mask:0xf bank_mask:0xc
  v_add_f32_dpp v33, v41, v45 row_ror:8 row_mask:0xf bank_mask:0xc
  v_add_f32_dpp v34, v42, v46 row_ror:8 row_mask:0xf bank_mask:0xc
  v_add_f32_dpp v35, v43, v47 row_ror:8 row_mask:0xf bank_mask:0xc
  buffer_load_dwordx4 a[184:187], v1, s[88:91], s44 offen offset:768 nt
  buffer_load_dwordx4 a[188:191], v1, s[88:91], s44 offen offset:896 nt
  ds_write_b128 v18, v[32:35] offset:0
  s_mov_b64 exec, 1
  ds_add_rtn_u32 v20, v21, v20 offset:10304
  s_mov_b64 exec, -1
  ds_read_b128 v[24:27], v21 offset:10240
  ds_read_b128 v[28:31], v21 offset:10256
  ds_read_b128 v[192:195], v4 offset:0
  ds_read_b128 v[196:199], v4 offset:1024
  ds_read_b128 v[200:203], v4 offset:2048
  ds_read_b128 v[204:207], v4 offset:3072
  s_mov_b32 s38, s47
  s_waitcnt lgkmcnt(6)
  v_readfirstlane_b32 s39, v20
  s_and_b32 s39, s39, 3
  s_cmp_eq_u32 s39, 3
  s_mov_b32 s26, s59
  s_cselect_b32 s59, 2, s59
  s_cbranch_scc0 L_nl_131
  s_waitcnt lgkmcnt(4)
  v_or3_b32 v16, v24, v26, v28
  v_add_f32 v17, v25, v27
  v_or_b32 v16, v16, v30
  v_add_f32 v23, v29, v31
  v_cmp_eq_u32 vcc, 0, v16
  v_add_f32 v17, v17, v23
  s_cbranch_vccz L_gen_132
  v_rcp_f32 v20, v17
  s_waitcnt lgkmcnt(2)
  v_pk_add_f32 v[32:33], v[192:193], v[196:197]
  v_pk_add_f32 v[34:35], v[194:195], v[198:199]
  s_waitcnt lgkmcnt(0)
  v_pk_add_f32 v[192:193], v[200:201], v[204:205]
  v_pk_add_f32 v[194:195], v[202:203], v[206:207]
  v_pk_add_f32 v[32:33], v[32:33], v[192:193]
  v_pk_add_f32 v[34:35], v[34:35], v[194:195]
L_join_133:
  s_cmp_eq_u32 s27, 33
  v_lshrrev_b32 v18, 1, v4
  v_pk_mul_f32 v[32:33], v[32:33], v[20:21] op_sel_hi:[1,0]
  v_pk_mul_f32 v[34:35], v[34:35], v[20:21] op_sel_hi:[1,0]
  v_cvt_pk_f16_f32 v32, v32, v33
  v_cvt_pk_f16_f32 v33, v34, v35
  v_min_u32 v32, -2, v32
  v_min_u32 v33, -2, v33
  v_and_b32 v17, -2, v17
  s_cbranch_scc0 L_ls_134
  buffer_store_dwordx2 v[32:33], v18, s[16:19], s38 offen
  s_mov_b64 exec, 1
  buffer_store_dwordx2 v[16:17], v22, s[16:19], s38 offen
  s_mov_b64 exec, -1
L_nl_131:
  s_waitcnt lgkmcnt(0)
  v_mov_b64 v[48:49], v[176:177]
  v_mov_b64 v[50:51], v[178:179]
  v_mov_b64 v[52:53], v[180:181]
  v_mov_b64 v[54:55], v[182:183]
  v_mov_b64 v[56:57], v[184:185]
  v_mov_b64 v[58:59], v[186:187]
  v_mov_b64 v[60:61], v[188:189]
  v_mov_b64 v[62:63], v[190:191]
  s_add_u32 s49, s49, 1
  s_add_u32 s53, s53, 512
  s_add_u32 s56, s56, 8192
  s_mov_b32 s46, s56
  s_add_u32 s35, s35, 10
L_A1:
  s_add_u32 s38, s35, 2
  v_mov_b32 v18, s38
  s_mov_b64 exec, 1
  buffer_store_dword v18, off, s[16:19], s25
  s_mov_b64 exec, -1
  s_cmp_gt_u32 s59, 1
  s_cbranch_scc1 L_lv_136
  s_cmp_gt_u32 s59, 0
  s_cbranch_scc1 L_lv_135
  s_waitcnt vmcnt(6)
L_lv_135:
  s_waitcnt vmcnt(9)
L_lv_136:
  s_waitcnt vmcnt(12)
  buffer_load_dwordx4 v[160:163], v1, s[8:11], s40 offen offset:0 nt
  s_cmp_gt_u32 s59, 1
  s_cbranch_scc1 L_lv_138
  s_cmp_gt_u32 s59, 0
  s_cbranch_scc1 L_lv_137
  s_waitcnt vmcnt(6)
L_lv_137:
  s_waitcnt vmcnt(9)
L_lv_138:
  s_waitcnt vmcnt(12)
  buffer_load_dwordx4 v[164:167], v1, s[8:11], s40 offen offset:128 nt
  s_cmp_gt_u32 s59, 1
  s_cbranch_scc1 L_lv_140
  s_cmp_gt_u32 s59, 0
  s_cbranch_scc1 L_lv_139
  s_waitcnt vmcnt(6)
L_lv_139:
  s_waitcnt vmcnt(9)
L_lv_140:
  s_waitcnt vmcnt(12)
  buffer_load_dwordx4 v[168:171], v1, s[8:11], s40 offen offset:256 nt
  s_cmp_gt_u32 s59, 1
  s_cbranch_scc1 L_lv_142
  s_cmp_gt_u32 s59, 0
  s_cbranch_scc1 L_lv_141
  s_waitcnt vmcnt(6)
L_lv_141:
  s_waitcnt vmcnt(9)
L_lv_142:
  s_waitcnt vmcnt(12)
  buffer_load_dwordx4 v[172:175], v1, s[8:11], s40 offen offset:384 nt
  s_cmp_gt_u32 s59, 1
  s_cbranch_scc1 L_lv_144
  s_cmp_gt_u32 s59, 0
  s_cbranch_scc1 L_lv_143
  s_waitcnt vmcnt(6)
L_lv_143:
  s_waitcnt vmcnt(9)
L_lv_144:
  s_waitcnt vmcnt(12)
  buffer_load_dwordx4 v[176:179], v1, s[8:11], s40 offen offset:512 nt
  s_add_u32 s38, s35, 3
  v_mov_b32 v18, s38
  s_mov_b64 exec, 1
  buffer_store_dword v18, off, s[16:19], s25
  s_mov_b64 exec, -1
  s_cmp_gt_u32 s59, 1
  s_cbranch_scc1 L_lv_146
  s_cmp_gt_u32 s59, 0
  s_cbranch_scc1 L_lv_145
  s_waitcnt vmcnt(7)
L_lv_145:
  s_waitcnt vmcnt(10)
L_lv_146:
  s_waitcnt vmcnt(13)
  buffer_load_dwordx4 v[180:183], v1, s[8:11], s40 offen offset:640 nt
  s_cmp_gt_u32 s59, 1
  s_cbranch_scc1 L_lv_148
  s_cmp_gt_u32 s59, 0
  s_cbranch_scc1 L_lv_147
  s_waitcnt vmcnt(6)
L_lv_147:
  s_waitcnt vmcnt(10)
L_lv_148:
  s_waitcnt vmcnt(13)
  buffer_load_dwordx4 v[184:187], v1, s[8:11], s40 offen offset:768 nt
  s_cmp_gt_u32 s59, 1
  s_cbranch_scc1 L_lv_150
  s_cmp_gt_u32 s59, 0
  s_cbranch_scc1 L_lv_149
  s_waitcnt vmcnt(6)
L_lv_149:
  s_waitcnt vmcnt(10)
L_lv_150:
  s_waitcnt vmcnt(13)
  buffer_load_dwordx4 v[188:191], v1, s[8:11], s40 offen offset:896 nt
  s_cmp_gt_u32 s59, 1
  s_cbranch_scc1 L_lv_152
  s_cmp_gt_u32 s59, 0
  s_cbranch_scc1 L_lv_151
  s_waitcnt vmcnt(6)
L_lv_151:
  s_waitcnt vmcnt(10)
L_lv_152:
  s_waitcnt vmcnt(13)
  buffer_load_dwordx4 v[192:195], v1, s[8:11], s41 offen offset:0 nt
  s_cmp_gt_u32 s59, 1
  s_cbranch_scc1 L_lv_154
  s_cmp_gt_u32 s59, 0
  s_cbranch_scc1 L_lv_153
  s_waitcnt vmcnt(6)
L_lv_153:
  s_waitcnt vmcnt(9)
L_lv_154:
  s_waitcnt vmcnt(13)
  buffer_load_dwordx4 v[196:199], v1, s[8:11], s41 offen offset:128 nt
  s_cmp_gt_u32 s59, 1
  s_cbranch_scc1 L_lv_156
  s_cmp_gt_u32 s59, 0
  s_cbranch_scc1 L_lv_155
  s_waitcnt vmcnt(6)
L_lv_155:
  s_waitcnt vmcnt(9)
L_lv_156:
  s_waitcnt vmcnt(13)
  buffer_load_dwordx4 v[200:203], v1, s[8:11], s41 offen offset:256 nt
  s_cmp_gt_u32 s59, 1
  s_cbranch_scc1 L_lv_158
  s_cmp_gt_u32 s59, 0
  s_cbranch_scc1 L_lv_157
  s_waitcnt vmcnt(5)
L_lv_157:
  s_waitcnt vmcnt(9)
L_lv_158:
  s_waitcnt vmcnt(13)
  buffer_load_dwordx4 v[204:207], v1, s[8:11], s41 offen offset:384 nt
  s_cmp_gt_u32 s59, 1
  s_cbranch_scc1 L_lv_160
  s_cmp_gt_u32 s59, 0
  s_cbranch_scc1 L_lv_159
  s_waitcnt vmcnt(5)
L_lv_159:
  s_waitcnt vmcnt(9)
L_lv_160:
  s_waitcnt vmcnt(12)
  buffer_load_dwordx4 v[208:211], v1, s[8:11], s41 offen offset:512 nt
  s_add_u32 s38, s35, 4
  v_mov_b32 v18, s38
  s_mov_b64 exec, 1
  buffer_store_dword v18, off, s[16:19], s25
  s_mov_b64 exec, -1
  s_cmp_gt_u32 s59, 1
  s_cbranch_scc1 L_lv_162
  s_cmp_gt_u32 s59, 0
  s_cbranch_scc1 L_lv_161
  s_waitcnt vmcnt(6)
L_lv_161:
  s_waitcnt vmcnt(10)
L_lv_162:
  s_waitcnt vmcnt(13)
  buffer_load_dwordx4 v[212:215], v1, s[8:11], s41 offen offset:640 nt
  s_cmp_gt_u32 s59, 1
  s_cbranch_scc1 L_lv_164
  s_cmp_gt_u32 s59, 0
  s_cbranch_scc1 L_lv_163
  s_waitcnt vmcnt(6)
L_lv_163:
  s_waitcnt vmcnt(9)
L_lv_164:
  s_waitcnt vmcnt(13)
  buffer_load_dwordx4 v[216:219], v1, s[8:11], s41 offen offset:768 nt
  s_cmp_gt_u32 s59, 1
  s_cbranch_scc1 L_lv_166
  s_cmp_gt_u32 s59, 0
  s_cbranch_scc1 L_lv_165
  s_waitcnt vmcnt(6)
L_lv_165:
  s_waitcnt vmcnt(9)
L_lv_166:
  s_waitcnt vmcnt(13)
  buffer_load_dwordx4 v[220:223], v1, s[8:11], s41 offen offset:896 nt
  s_mov_b32 s59, s26
  s_cmp_gt_u32 s59, 1
  s_cbranch_scc1 L_lv_168
  s_cmp_gt_u32 s59, 0
  s_cbranch_scc1 L_lv_167
  s_waitcnt vmcnt(6)
L_lv_167:
  s_waitcnt vmcnt(9)
L_lv_168:
  s_waitcnt vmcnt(13)
  buffer_load_dwordx4 v[224:227], v1, s[8:11], s42 offen offset:0 nt
  s_cmp_gt_u32 s59, 1
  s_cbranch_scc1 L_lv_170
  s_cmp_gt_u32 s59, 0
  s_cbranch_scc1 L_lv_169
  s_waitcnt vmcnt(6)
L_lv_169:
  s_waitcnt vmcnt(9)
L_lv_170:
  s_waitcnt vmcnt(12)
  buffer_load_dwordx4 v[228:231], v1, s[8:11], s42 offen offset:128 nt
  s_cmp_gt_u32 s59, 1
  s_cbranch_scc1 L_lv_172
  s_cmp_gt_u32 s59, 0
  s_cbranch_scc1 L_lv_171
  s_waitcnt vmcnt(6)
L_lv_171:
  s_waitcnt vmcnt(9)
L_lv_172:
  s_waitcnt vmcnt(12)
  buffer_load_dwordx4 v[232:235], v1, s[8:11], s42 offen offset:256 nt
  s_cmp_gt_u32 s59, 1
  s_cbranch_scc1 L_lv_174
  s_cmp_gt_u32 s59, 0
  s_cbranch_scc1 L_lv_173
  s_waitcnt vmcnt(5)
L_lv_173:
  s_waitcnt vmcnt(9)
L_lv_174:
  s_waitcnt vmcnt(12)
  buffer_load_dwordx4 v[236:239], v1, s[8:11], s42 offen offset:384 nt
  s_cmp_gt_u32 s59, 1
  s_cbranch_scc1 L_lv_176
  s_cmp_gt_u32 s59, 0
  s_cbranch_scc1 L_lv_175
  s_waitcnt vmcnt(5)
L_lv_175:
  s_waitcnt vmcnt(9)
L_lv_176:
  s_waitcnt vmcnt(12)
  buffer_load_dwordx4 v[240:243], v1, s[8:11], s42 offen offset:512 nt
  s_add_u32 s38, s35, 5
  v_mov_b32 v18, s38
  s_mov_b64 exec, 1
  buffer_store_dword v18, off, s[16:19], s25
  s_mov_b64 exec, -1
  s_cmp_gt_u32 s59, 1
  s_cbranch_scc1 L_lv_178
  s_cmp_gt_u32 s59, 0
  s_cbranch_scc1 L_lv_177
  s_waitcnt vmcnt(6)
L_lv_177:
  s_waitcnt vmcnt(10)
L_lv_178:
  s_waitcnt vmcnt(13)
  buffer_load_dwordx4 v[244:247], v1, s[8:11], s42 offen offset:640 nt
  s_cmp_gt_u32 s59, 1
  s_cbranch_scc1 L_lv_180
  s_cmp_gt_u32 s59, 0
  s_cbranch_scc1 L_lv_179
  s_waitcnt vmcnt(6)
L_lv_179:
  s_waitcnt vmcnt(9)
L_lv_180:
  s_waitcnt vmcnt(13)
  buffer_load_dwordx4 v[248:251], v1, s[8:11], s42 offen offset:768 nt
  s_cmp_gt_u32 s59, 1
  s_cbranch_scc1 L_lv_182
  s_cmp_gt_u32 s59, 0
  s_cbranch_scc1 L_lv_181
  s_waitcnt vmcnt(6)
L_lv_181:
  s_waitcnt vmcnt(9)
L_lv_182:
  s_waitcnt vmcnt(13)
  buffer_load_dwordx4 v[252:255], v1, s[8:11], s42 offen offset:896 nt
  s_cmp_gt_u32 s59, 1
  s_cbranch_scc1 L_lv_184
  s_cmp_gt_u32 s59, 0
  s_cbranch_scc1 L_lv_183
  s_waitcnt vmcnt(6)
L_lv_183:
  s_waitcnt vmcnt(9)
L_lv_184:
  s_waitcnt vmcnt(13)
  buffer_load_dwordx4 a[192:195], v2, s[12:15], s40 offen offset:0 nt
  s_cmp_gt_u32 s59, 1
  s_cbranch_scc1 L_lv_186
  s_cmp_gt_u32 s59, 0
  s_cbranch_scc1 L_lv_185
  s_waitcnt vmcnt(6)
L_lv_185:
  s_waitcnt vmcnt(9)
L_lv_186:
  s_waitcnt vmcnt(12)
  buffer_load_dwordx4 a[200:203], v2, s[12:15], s40 offen offset:128 nt
  s_cmp_gt_u32 s59, 1
  s_cbranch_scc1 L_lv_188
  s_cmp_gt_u32 s59, 0
  s_cbranch_scc1 L_lv_187
  s_waitcnt vmcnt(6)
L_lv_187:
  s_waitcnt vmcnt(9)
L_lv_188:
  s_waitcnt vmcnt(12)
  buffer_load_dwordx4 a[208:211], v2, s[12:15], s40 offen offset:256 nt
  s_cmp_gt_u32 s59, 1
  s_cbranch_scc1 L_lv_190
  s_cmp_gt_u32 s59, 0
  s_cbranch_scc1 L_lv_189
  s_waitcnt vmcnt(5)
L_lv_189:
  s_waitcnt vmcnt(9)
L_lv_190:
  s_waitcnt vmcnt(12)
  buffer_load_dwordx4 a[216:219], v2, s[12:15], s40 offen offset:384 nt
  s_cmp_gt_u32 s59, 1
  s_cbranch_scc1 L_lv_192
  s_cmp_gt_u32 s59, 0
  s_cbranch_scc1 L_lv_191
  s_waitcnt vmcnt(5)
L_lv_191:
  s_waitcnt vmcnt(9)
L_lv_192:
  s_waitcnt vmcnt(12)
  buffer_load_dwordx4 a[224:227], v2, s[12:15], s40 offen offset:1024 nt
  s_add_u32 s38, s35, 6
  v_mov_b32 v18, s38
  s_mov_b64 exec, 1
  buffer_store_dword v18, off, s[16:19], s25
  s_mov_b64 exec, -1
  s_cmp_gt_u32 s59, 1
  s_cbranch_scc1 L_lv_194
  s_cmp_gt_u32 s59, 0
  s_cbranch_scc1 L_lv_193
  s_waitcnt vmcnt(6)
L_lv_193:
  s_waitcnt vmcnt(10)
L_lv_194:
  s_waitcnt vmcnt(13)
  buffer_load_dwordx4 a[232:235], v2, s[12:15], s40 offen offset:1152 nt
  s_cmp_gt_u32 s59, 1
  s_cbranch_scc1 L_lv_196
  s_cmp_gt_u32 s59, 0
  s_cbranch_scc1 L_lv_195
  s_waitcnt vmcnt(6)
L_lv_195:
  s_waitcnt vmcnt(9)
L_lv_196:
  s_waitcnt vmcnt(13)
  buffer_load_dwordx4 a[240:243], v2, s[12:15], s40 offen offset:1280 nt
  s_cmp_gt_u32 s59, 1
  s_cbranch_scc1 L_lv_198
  s_cmp_gt_u32 s59, 0
  s_cbranch_scc1 L_lv_197
  s_waitcnt vmcnt(6)
L_lv_197:
  s_waitcnt vmcnt(9)
L_lv_198:
  s_waitcnt vmcnt(13)
  buffer_load_dwordx4 a[248:251], v2, s[12:15], s40 offen offset:1408 nt
  s_waitcnt vmcnt(9)
  v_add_u32 v18, s53, v5
  ds_read_b128 v[24:27], v18
  ds_read_b128 v[28:31], v18 offset:256
  v_mov_b64 v[32:33], 0
  v_mov_b64 v[34:35], 0
  v_mov_b64 v[36:37], 0
  v_mov_b64 v[38:39], 0
  v_mov_b64 v[40:41], 0
  v_mov_b64 v[42:43], 0
  v_mov_b64 v[44:45], 0
  v_mov_b64 v[46:47], 0
  s_waitcnt lgkmcnt(0)
  v_smfmac_f32_16x16x64_bf16 v[32:35], v[24:27], v[160:167], v6
  v_smfmac_f32_16x16x64_bf16 v[32:35], v[28:31], v[168:175], v6
  v_smfmac_f32_16x16x64_bf16 v[36:39], v[24:27], v[176:183], v6
  v_smfmac_f32_16x16x64_bf16 v[36:39], v[28:31], v[184:191], v6
  s_cmp_gt_u32 s59, 0
  s_nop 0
  s_cbranch_scc1 L_lv_199
  s_waitcnt vmcnt(6)
L_lv_199:
  buffer_load_dwordx4 a[196:199], v2, s[12:15], s41 offen offset:0 nt
  v_smfmac_f32_16x16x64_bf16 v[40:43], v[24:27], v[192:199], v6
  v_smfmac_f32_16x16x64_bf16 v[40:43], v[28:31], v[200:207], v6
  v_smfmac_f32_16x16x64_bf16 v[44:47], v[24:27], v[208:215], v6
  v_add_f32 v19, v33, v35
  v_add_f32 v18, v32, v34
  v_smfmac_f32_16x16x64_bf16 v[44:47], v[28:31], v[216:223], v6
  s_nop 0
  v_add_f32_dpp v12, v19, v18 quad_perm:[1,1,3,3] row_mask:0x1 bank_mask:0xf
  v_smfmac_f32_16x16x64_bf16 v[32:35], v[24:27], v[224:231], v6
  v_add_f32 v21, v37, v39
  v_add_f32 v20, v36, v38
  v_smfmac_f32_16x16x64_bf16 v[32:35], v[28:31], v[232:239], v6
  s_nop 0
  v_add_f32_dpp v12, v21, v20 quad_perm:[1,1,3,3] row_mask:0x2 bank_mask:0xf
  v_smfmac_f32_16x16x64_bf16 v[36:39], v[24:27], v[240:247], v6
  v_add_f32 v19, v41, v43
  v_add_f32 v18, v40, v42
  v_smfmac_f32_16x16x64_bf16 v[36:39], v[28:31], v[248:255], v6
  s_nop 0
  v_add_f32_dpp v12, v19, v18 quad_perm:[1,1,3,3] row_mask:0x4 bank_mask:0xf
  v_smfmac_f32_16x16x64_bf16 v[40:43], v[24:27], a[128:135], v6
  v_add_f32 v21, v45, v47
  v_add_f32 v20, v44, v46
  v_smfmac_f32_16x16x64_bf16 v[40:43], v[28:31], a[136:143], v6
  s_nop 0
  v_add_f32_dpp v12, v21, v20 quad_perm:[1,1,3,3] row_mask:0x8 bank_mask:0xf
  s_cmp_gt_u32 s59, 1
  s_cbranch_scc1 L_lv_201
  s_cmp_gt_u32 s59, 0
  s_cbranch_scc1 L_lv_200
  s_waitcnt vmcnt(6)
L_lv_200:
  s_waitcnt vmcnt(9)
L_lv_201:
  buffer_load_dwordx4 a[204:207], v2, s[12:15], s41 offen offset:128 nt
  v_smfmac_f32_16x16x64_bf16 v[44:47], v[24:27], a[144:151], v6
  v_add_f32 v19, v33, v35
  v_add_f32 v18, v32, v34
  v_smfmac_f32_16x16x64_bf16 v[44:47], v[28:31], a[152:159], v6
  s_nop 0
  v_add_f32_dpp v13, v19, v18 quad_perm:[1,1,3,3] row_mask:0x1 bank_mask:0xf
  v_smfmac_f32_16x16x64_bf16 v[32:35], v[24:27], a[160:167], v6
  v_add_f32 v21, v37, v39
  v_add_f32 v20, v36, v38
  v_smfmac_f32_16x16x64_bf16 v[32:35], v[28:31], a[168:175], v6
  s_nop 0
  v_add_f32_dpp v13, v21, v20 quad_perm:[1,1,3,3] row_mask:0x2 bank_mask:0xf
  v_smfmac_f32_16x16x64_bf16 v[36:39], v[24:27], a[176:183], v6
  v_add_f32 v19, v41, v43
  v_add_f32 v18, v40, v42
  v_smfmac_f32_16x16x64_bf16 v[36:39], v[28:31], a[184:191], v6
  s_nop 0
  v_add_f32_dpp v13, v19, v18 quad_perm:[1,1,3,3] row_mask:0x4 bank_mask:0xf
  v_cmp_gt_u32 vcc, s23, v15
  v_mov_b32 v23, 0xff800000
  v_add_f32 v21, v45, v47
  v_add_f32 v20, v44, v46
  s_nop 1
  v_add_f32_dpp v13, v21, v20 quad_perm:[1,1,3,3] row_mask:0x8 bank_mask:0xf
  v_add_f32 v19, v33, v35
  v_add_f32 v18, v32, v34
  s_nop 1
  v_add_f32_dpp v14, v19, v18 quad_perm:[1,1,3,3] row_mask:0x1 bank_mask:0xf
  v_add_f32 v21, v37, v39
  v_add_f32 v20, v36, v38
  s_nop 1
  v_add_f32_dpp v14, v21, v20 quad_perm:[1,1,3,3] row_mask:0x2 bank_mask:0xf
  v_sub_f32 v14, v14, v13
  v_sub_f32 v13, v13, v12
  v_cndmask_b32 v14, v23, v14, vcc
  v_max3_f32 v16, v12, v13, v14
  s_nop 1
  v_max_f32_dpp v16, v16, v16 quad_perm:[2,3,0,1] row_mask:0xf bank_mask:0xf
  s_nop 1
  v_max_f32_dpp v16, v16, v16 row_ror:4 row_mask:0xf bank_mask:0xf
  s_nop 1
  v_max_f32_dpp v18, v16, v16 row_ror:8 row_mask:0xf bank_mask:0xf
  v_max_f32_dpp v16, v16, v16 row_ror:8 row_mask:0xf bank_mask:0xf
  s_nop 1
  v_permlane16_swap_b32 v16, v18
  v_max_f32 v19, v16, v18
  v_max_f32 v16, v16, v18
  s_nop 1
  v_permlane32_swap_b32 v16, v19
  v_max_f32 v16, v16, v19
  v_mul_f32 v16, s51, v16
  v_cmp_lt_f32 vcc, s50, abs(v16)
  s_nop 1
  v_cndmask_b32 v16, 0, v16, vcc
  v_fma_f32 v12, v12, s51, -v16
  v_fma_f32 v14, v14, s51, -v16
  v_fma_f32 v13, v13, s51, -v16
  v_exp_f32 v12, v12
  v_exp_f32 v14, v14
  v_exp_f32 v13, v13
  s_cmp_gt_u32 s59, 1
  s_cbranch_scc1 L_lv_203
  s_cmp_gt_u32 s59, 0
  s_cbranch_scc1 L_lv_202
  s_waitcnt vmcnt(6)
L_lv_202:
  s_waitcnt vmcnt(9)
L_lv_203:
  buffer_load_dwordx4 a[212:215], v2, s[12:15], s41 offen offset:256 nt
  v_add_f32 v17, v12, v13
  v_mov_b32_dpp v18, v12 quad_perm:[0,0,0,0] row_mask:0xf bank_mask:0xf
  v_add_f32 v17, v14, v17
  v_mov_b32_dpp v19, v12 quad_perm:[2,2,2,2] row_mask:0xf bank_mask:0xf
  s_nop 0
  v_add_f32_dpp v17, v17, v17 quad_perm:[2,3,0,1] row_mask:0xf bank_mask:0xf
  v_cvt_pk_bf16_f32 v20, v18, v19
  s_nop 0
  v_add_f32_dpp v17, v17, v17 row_ror:4 row_mask:0xf bank_mask:0xf
  v_mov_b32_dpp v18, v14 quad_perm:[0,0,0,0] row_mask:0xf bank_mask:0xf
  s_nop 0
  v_add_f32_dpp v17, v17, v17 row_ror:8 row_mask:0xf bank_mask:0xf
  v_mov_b32_dpp v19, v14 quad_perm:[2,2,2,2] row_mask:0xf bank_mask:0xf
  v_mov_b32 v23, v17
  v_cvt_pk_bf16_f32 v22, v18, v19
  s_nop 0
  v_permlane16_swap_b32 v17, v23
  v_mov_b32_dpp v0, v22 row_shl:4 row_mask:0xf bank_mask:0xf
  v_add_f32 v17, v17, v23
  s_nop 0
  v_permlane32_swap_b32 v22, v0
  v_mov_b32 v23, v17
  v_mov_b32_dpp v18, v13 quad_perm:[0,0,0,0] row_mask:0xf bank_mask:0xf
  s_nop 0
  v_permlane32_swap_b32 v17, v23
  v_mov_b32_dpp v19, v13 quad_perm:[2,2,2,2] row_mask:0xf bank_mask:0xf
  v_add_f32 v17, v17, v23
  v_cvt_pk_bf16_f32 v21, v18, v19
  v_lshrrev_b32 v18, 6, v4
  v_lshl_add_u32 v18, v18, 4, s57
  v_mov_b32 v19, s55
  ds_write_b96 v18, v[20:22]
  s_mov_b64 exec, 1
  ds_write_b64 v19, v[16:17] offset:10336
  s_mov_b64 exec, -1
  s_cmp_gt_u32 s59, 1
  s_cbranch_scc1 L_lv_205
  s_cmp_gt_u32 s59, 0
  s_cbranch_scc1 L_lv_204
  s_waitcnt vmcnt(5)
L_lv_204:
  s_waitcnt vmcnt(9)
L_lv_205:
  buffer_load_dwordx4 a[220:223], v2, s[12:15], s41 offen offset:384 nt
  v_mov_b64 v[32:33], 0
  v_mov_b64 v[34:35], 0
  v_mov_b64 v[36:37], 0
  v_mov_b64 v[38:39], 0
  v_mov_b64 v[40:41], 0
  v_mov_b64 v[42:43], 0
  v_mov_b64 v[44:45], 0
  v_mov_b64 v[46:47], 0
  s_cmp_gt_u32 s59, 1
  s_cbranch_scc1 L_lv_207
  s_cmp_gt_u32 s59, 0
  s_cbranch_scc1 L_lv_206
  s_waitcnt vmcnt(5)
L_lv_206:
  s_waitcnt vmcnt(9)
L_lv_207:
  s_waitcnt vmcnt(12)
  buffer_load_dwordx4 a[228:231], v2, s[12:15], s41 offen offset:1024 nt
  s_add_u32 s38, s35, 7
  v_mov_b32 v18, s38
  s_mov_b64 exec, 1
  buffer_store_dword v18, off, s[16:19], s25
  s_mov_b64 exec, -1
  s_cmp_gt_u32 s59, 1
  s_cbranch_scc1 L_lv_209
  s_cmp_gt_u32 s59, 0
  s_cbranch_scc1 L_lv_208
  s_waitcnt vmcnt(6)
L_lv_208:
  s_waitcnt vmcnt(10)
L_lv_209:
  s_waitcnt vmcnt(13)
  buffer_load_dwordx4 a[236:239], v2, s[12:15], s41 offen offset:1152 nt
  s_cmp_gt_u32 s59, 1
  s_cbranch_scc1 L_lv_211
  s_cmp_gt_u32 s59, 0
  s_cbranch_scc1 L_lv_210
  s_waitcnt vmcnt(6)
L_lv_210:
  s_waitcnt vmcnt(9)
L_lv_211:
  s_waitcnt vmcnt(13)
  buffer_load_dwordx4 a[244:247], v2, s[12:15], s41 offen offset:1280 nt
  s_cmp_gt_u32 s59, 1
  s_cbranch_scc1 L_lv_213
  s_cmp_gt_u32 s59, 0
  s_cbranch_scc1 L_lv_212
  s_waitcnt vmcnt(6)
L_lv_212:
  s_waitcnt vmcnt(9)
L_lv_213:
  s_waitcnt vmcnt(13)
  buffer_load_dwordx4 a[252:255], v2, s[12:15], s41 offen offset:1408 nt
  s_add_u32 m0, s45, 17408
  s_cmp_gt_u32 s59, 1
  s_cbranch_scc1 L_lv_215
  s_cmp_gt_u32 s59, 0
  s_cbranch_scc1 L_lv_214
  s_waitcnt vmcnt(6)
L_lv_214:
  s_waitcnt vmcnt(9)
L_lv_215:
  s_waitcnt vmcnt(13)
  buffer_load_dwordx4 v2, s[12:15], s42 offen offset:0 nt lds
  s_add_u32 m0, s45, 18304
  s_cmp_gt_u32 s59, 1
  s_cbranch_scc1 L_lv_217
  s_cmp_gt_u32 s59, 0
  s_cbranch_scc1 L_lv_216
  s_waitcnt vmcnt(6)
L_lv_216:
  s_waitcnt vmcnt(9)
L_lv_217:
  s_waitcnt vmcnt(12)
  buffer_load_dwordx4 v2, s[12:15], s42 offen offset:128 nt lds
  buffer_load_dwordx4 v[24:27], v5, s[16:19], s46 offen sc1
  buffer_load_dwordx4 v[28:31], v5, s[16:19], s46 offen offset:256 sc1
  s_add_u32 m0, s45, 19200
  s_cmp_gt_u32 s59, 1
  s_cbranch_scc1 L_lv_219
  s_cmp_gt_u32 s59, 0
  s_cbranch_scc1 L_lv_218
  s_waitcnt vmcnt(8)
L_lv_218:
  s_waitcnt vmcnt(11)
L_lv_219:
  s_waitcnt vmcnt(14)
  buffer_load_dwordx4 v2, s[12:15], s42 offen offset:256 nt lds
  s_add_u32 m0, s45, 20096
  s_cmp_gt_u32 s59, 1
  s_cbranch_scc1 L_lv_221
  s_cmp_gt_u32 s59, 0
  s_cbranch_scc1 L_lv_220
  s_waitcnt vmcnt(7)
L_lv_220:
  s_waitcnt vmcnt(11)
L_lv_221:
  s_waitcnt vmcnt(14)
  buffer_load_dwordx4 v2, s[12:15], s42 offen offset:384 nt lds
  s_add_u32 m0, s45, 20480
  s_cmp_gt_u32 s59, 1
  s_cbranch_scc1 L_lv_223
  s_cmp_gt_u32 s59, 0
  s_cbranch_scc1 L_lv_222
  s_waitcnt vmcnt(7)
L_lv_222:
  s_waitcnt vmcnt(11)
L_lv_223:
  s_waitcnt vmcnt(14)
  buffer_load_dwordx4 v2, s[12:15], s42 offen offset:1024 nt lds
  s_add_u32 s38, s35, 8
  v_mov_b32 v18, s38
  s_mov_b64 exec, 1
  buffer_store_dword v18, off, s[16:19], s25
  s_mov_b64 exec, -1
  s_add_u32 m0, s45, 21376
  s_cmp_gt_u32 s59, 1
  s_cbranch_scc1 L_lv_225
  s_cmp_gt_u32 s59, 0
  s_cbranch_scc1 L_lv_224
  s_waitcnt vmcnt(8)
L_lv_224:
  s_waitcnt vmcnt(12)
L_lv_225:
  s_waitcnt vmcnt(15)
  buffer_load_dwordx4 v2, s[12:15], s42 offen offset:1152 nt lds
  s_add_u32 m0, s45, 22272
  s_cmp_gt_u32 s59, 1
  s_cbranch_scc1 L_lv_227
  s_cmp_gt_u32 s59, 0
  s_cbranch_scc1 L_lv_226
  s_waitcnt vmcnt(8)
L_lv_226:
  s_waitcnt vmcnt(11)
L_lv_227:
  s_waitcnt vmcnt(15)
  buffer_load_dwordx4 v2, s[12:15], s42 offen offset:1280 nt lds
  s_add_u32 m0, s45, 23168
  s_cmp_gt_u32 s59, 1
  s_cbranch_scc1 L_lv_229
  s_cmp_gt_u32 s59, 0
  s_cbranch_scc1 L_lv_228
  s_waitcnt vmcnt(8)
L_lv_228:
  s_waitcnt vmcnt(11)
L_lv_229:
  s_waitcnt vmcnt(15)
  buffer_load_dwordx4 v2, s[12:15], s42 offen offset:1408 nt lds
  s_add_u32 m0, s45, 25600
  s_cmp_gt_u32 s59, 1
  s_cbranch_scc1 L_lv_231
  s_cmp_gt_u32 s59, 0
  s_cbranch_scc1 L_lv_230
  s_waitcnt vmcnt(6)
L_lv_230:
  s_waitcnt vmcnt(11)
L_lv_231:
  s_waitcnt vmcnt(15)
  buffer_load_dwordx4 v2, s[12:15], s43 offen offset:0 nt lds
  s_waitcnt vmcnt(8)
  s_mov_b32 s58, 0
  v_max3_u32 v18, v24, v25, v26
  v_max3_u32 v18, v18, v27, v28
  v_max3_u32 v18, v18, v29, v30
  v_max3_u32 v18, v18, v31, v31
  v_cmp_eq_u32 vcc, -1, v18
  s_cbranch_vccz L_E1
  s_add_u32 m0, s45, 26496
  s_cmp_gt_u32 s59, 0
  s_cbranch_scc1 L_lv_232
  s_waitcnt vmcnt(6)
L_lv_232:
  buffer_load_dwordx4 v2, s[12:15], s43 offen offset:128 nt lds
  v_lshrrev_b32 v19, 1, v4
  buffer_load_dword v16, v19, s[16:19], s20 offen sc1
  buffer_load_dwordx4 v[24:27], v5, s[16:19], s46 offen sc1
  buffer_load_dwordx4 v[28:31], v5, s[16:19], s46 offen offset:256 sc1
  s_add_u32 m0, s45, 27392
  s_cmp_gt_u32 s59, 0
  s_cbranch_scc1 L_lv_233
  s_waitcnt vmcnt(9)
L_lv_233:
  buffer_load_dwordx4 v2, s[12:15], s43 offen offset:256 nt lds
  s_add_u32 m0, s45, 28288
  s_cmp_gt_u32 s59, 1
  s_cbranch_scc1 L_lv_235
  s_cmp_gt_u32 s59, 0
  s_cbranch_scc1 L_lv_234
  s_waitcnt vmcnt(8)
L_lv_234:
  s_waitcnt vmcnt(12)
L_lv_235:
  buffer_load_dwordx4 v2, s[12:15], s43 offen offset:384 nt lds
  s_add_u32 m0, s45, 28672
  s_cmp_gt_u32 s59, 1
  s_cbranch_scc1 L_lv_237
  s_cmp_gt_u32 s59, 0
  s_cbranch_scc1 L_lv_236
  s_waitcnt vmcnt(8)
L_lv_236:
  s_waitcnt vmcnt(12)
L_lv_237:
  buffer_load_dwordx4 v2, s[12:15], s43 offen offset:1024 nt lds
  s_add_u32 s38, s35, 9
  v_mov_b32 v18, s38
  s_mov_b64 exec, 1
  buffer_store_dword v18, off, s[16:19], s25
  s_mov_b64 exec, -1
  s_add_u32 m0, s45, 29568
  s_cmp_gt_u32 s59, 1
  s_cbranch_scc1 L_lv_239
  s_cmp_gt_u32 s59, 0
  s_cbranch_scc1 L_lv_238
  s_waitcnt vmcnt(9)
L_lv_238:
  s_waitcnt vmcnt(13)
L_lv_239:
  buffer_load_dwordx4 v2, s[12:15], s43 offen offset:1152 nt lds
  buffer_load_dwordx4 v[24:27], v5, s[16:19], s46 offen sc1
  buffer_load_dwordx4 v[28:31], v5, s[16:19], s46 offen offset:256 sc1
  s_add_u32 m0, s45, 30464
  s_cmp_gt_u32 s59, 1
  s_cbranch_scc1 L_lv_241
  s_cmp_gt_u32 s59, 0
  s_cbranch_scc1 L_lv_240
  s_waitcnt vmcnt(11)
L_lv_240:
  s_waitcnt vmcnt(14)
L_lv_241:
  s_waitcnt vmcnt(18)
  buffer_load_dwordx4 v2, s[12:15], s43 offen offset:1280 nt lds
  s_add_u32 m0, s45, 31360
  s_cmp_gt_u32 s59, 1
  s_cbranch_scc1 L_lv_243
  s_cmp_gt_u32 s59, 0
  s_cbranch_scc1 L_lv_242
  s_waitcnt vmcnt(11)
L_lv_242:
  s_waitcnt vmcnt(14)
L_lv_243:
  s_waitcnt vmcnt(18)
  buffer_load_dwordx4 v2, s[12:15], s43 offen offset:1408 nt lds
  s_add_u32 m0, s45, 33792
  s_cmp_gt_u32 s59, 1
  s_cbranch_scc1 L_lv_245
  s_cmp_gt_u32 s59, 0
  s_cbranch_scc1 L_lv_244
  s_waitcnt vmcnt(8)
L_lv_244:
  s_waitcnt vmcnt(14)
L_lv_245:
  s_waitcnt vmcnt(18)
  buffer_load_dwordx4 v2, s[92:95], s44 offen offset:0 nt lds
  s_mov_b32 s59, 1
  s_waitcnt vmcnt(10)
  v_max3_u32 v18, v24, v25, v26
  v_max3_u32 v18, v18, v27, v28
  v_max3_u32 v18, v18, v29, v30
  v_max3_u32 v18, v18, v31, v31
  v_cmp_eq_u32 vcc, -1, v18
  s_cbranch_vccz L_Xok1
  s_movk_i32 s34, 6
  s_movk_i32 s32, 0
  s_call_b64 s[96:97], L_help
  s_waitcnt vmcnt(3)
L_X1:
  v_max3_u32 v18, v24, v25, v26
  v_max3_u32 v18, v18, v27, v28
  v_max3_u32 v18, v18, v29, v30
  v_max3_u32 v18, v18, v31, v31
  v_cmp_eq_u32 vcc, -1, v18
  s_cbranch_vccz L_Xok1
L_Xpoll1:
  s_mov_b32 s59, 1
  s_sub_u32 s52, s52, 1
  s_cbranch_scc1 L_bail
  v_lshrrev_b32 v19, 1, v4
  buffer_load_dword v16, v19, s[16:19], s20 offen sc1
  buffer_load_dwordx4 v[24:27], v5, s[16:19], s46 offen sc1
  buffer_load_dwordx4 v[28:31], v5, s[16:19], s46 offen offset:256 sc1
  s_waitcnt vmcnt(0)
  v_max3_u32 v18, v24, v25, v26
  v_max3_u32 v18, v18, v27, v28
  v_max3_u32 v18, v18, v29, v30
  v_max3_u32 v18, v18, v31, v31
  v_cmp_eq_u32 vcc, -1, v18
  s_cbranch_vccz L_Xok1
  s_movk_i32 s32, 0
  s_call_b64 s[96:97], L_help
  s_branch L_Xpoll1
L_Xok1:
  s_add_u32 s38, s35, 10
  v_mov_b32 v18, s38
  s_mov_b64 exec, 1
  buffer_store_dword v18, off, s[16:19], s25
  s_mov_b64 exec, -1
  s_cmp_eq_u32 s49, 3
  s_cbranch_scc1 L_last
  v_smfmac_f32_16x16x64_bf16 v[32:35], v[24:27], v[64:71], v6
  v_smfmac_f32_16x16x64_bf16 v[32:35], v[28:31], v[72:79], v6
  ds_read_b128 v[64:67], v3 offset:16384
  ds_read_b128 v[68:71], v3 offset:34816
  ds_read_b128 v[72:75], v3 offset:35840
  ds_read_b128 v[76:79], v3 offset:36864
  v_smfmac_f32_16x16x64_bf16 v[36:39], v[24:27], v[80:87], v6
  v_smfmac_f32_16x16x64_bf16 v[36:39], v[28:31], v[88:95], v6
  v_smfmac_f32_16x16x64_bf16 v[40:43], v[24:27], v[96:103], v6
  v_smfmac_f32_16x16x64_bf16 v[40:43], v[28:31], v[104:111], v6
  s_waitcnt lgkmcnt(0)
  s_add_u32 m0, s45, 33792
  s_nop 0
  buffer_load_dwordx4 v2, s[92:95], s44 offen offset:1024 nt lds
  s_add_u32 m0, s45, 35712
  s_nop 0
  buffer_load_dwordx4 v2, s[92:95], s44 offen offset:128 nt lds
  s_add_u32 m0, s45, 35712
  s_nop 0
  buffer_load_dwordx4 v2, s[92:95], s44 offen offset:1152 nt lds
  ds_read_b128 v[96:99], v3 offset:0
  ds_read_b128 v[100:103], v3 offset:8192
  ds_read_b128 v[104:107], v3 offset:1024
  ds_read_b128 v[108:111], v3 offset:9216
  v_smfmac_f32_16x16x64_bf16 v[44:47], v[24:27], v[112:119], v6
  v_add_f32 v19, v33, v35
  v_add_f32 v18, v32, v34
  v_smfmac_f32_16x16x64_bf16 v[44:47], v[28:31], v[120:127], v6
  s_nop 0
  v_add_f32_dpp v12, v19, v18 quad_perm:[1,1,3,3] row_mask:0x1 bank_mask:0xf
  buffer_load_dwordx4 v[80:83], v2, s[92:95], s44 offen offset:256 nt
  buffer_load_dwordx4 v[84:87], v2, s[92:95], s44 offen offset:1280 nt
  ds_read_b128 v[112:115], v3 offset:2048
  ds_read_b128 v[116:119], v3 offset:10240
  ds_read_b128 v[120:123], v3 offset:3072
  ds_read_b128 v[124:127], v3 offset:11264
  v_smfmac_f32_16x16x64_bf16 v[32:35], v[24:27], v[128:135], v6
  v_add_f32 v21, v37, v39
  v_add_f32 v20, v36, v38
  v_smfmac_f32_16x16x64_bf16 v[32:35], v[28:31], v[136:143], v6
  s_nop 0
  v_add_f32_dpp v12, v21, v20 quad_perm:[1,1,3,3] row_mask:0x2 bank_mask:0xf
  buffer_load_dwordx4 v[88:91], v2, s[92:95], s44 offen offset:384 nt
  buffer_load_dwordx4 v[92:95], v2, s[92:95], s44 offen offset:1408 nt
  ds_read_b128 v[128:131], v3 offset:4096
  ds_read_b128 v[132:135], v3 offset:12288
  v_smfmac_f32_16x16x64_bf16 v[36:39], v[24:27], v[144:151], v6
  v_add_f32 v19, v41, v43
  v_add_f32 v18, v40, v42
  v_smfmac_f32_16x16x64_bf16 v[36:39], v[28:31], v[152:159], v6
  s_nop 0
  v_add_f32_dpp v12, v19, v18 quad_perm:[1,1,3,3] row_mask:0x4 bank_mask:0xf
  ds_read_b128 v[136:139], v3 offset:5120
  ds_read_b128 v[140:143], v3 offset:13312
  v_smfmac_f32_16x16x64_bf16 v[40:43], v[24:27], a[0:7], v6
  v_add_f32 v21, v45, v47
  v_add_f32 v20, v44, v46
  v_smfmac_f32_16x16x64_bf16 v[40:43], v[28:31], a[8:15], v6
  s_nop 0
  v_add_f32_dpp v12, v21, v20 quad_perm:[1,1,3,3] row_mask:0x8 bank_mask:0xf
  ds_read_b128 v[144:147], v3 offset:6144
  ds_read_b128 v[148:151], v3 offset:14336
  v_smfmac_f32_16x16x64_bf16 v[44:47], v[24:27], a[16:23], v6
  v_add_f32 v19, v33, v35
  v_add_f32 v18, v32, v34
  v_smfmac_f32_16x16x64_bf16 v[44:47], v[28:31], a[24:31], v6
  s_nop 0
  v_add_f32_dpp v13, v19, v18 quad_perm:[1,1,3,3] row_mask:0x1 bank_mask:0xf
  ds_read_b128 v[152:155], v3 offset:7168
  ds_read_b128 v[156:159], v3 offset:15360
  v_smfmac_f32_16x16x64_bf16 v[32:35], v[24:27], a[32:39], v6
  v_add_f32 v21, v37, v39
  v_add_f32 v20, v36, v38
  v_smfmac_f32_16x16x64_bf16 v[32:35], v[28:31], a[40:47], v6
  s_nop 0
  v_add_f32_dpp v13, v21, v20 quad_perm:[1,1,3,3] row_mask:0x2 bank_mask:0xf
  v_smfmac_f32_16x16x64_bf16 v[36:39], v[24:27], a[48:55], v6
  v_add_f32 v19, v41, v43
  v_add_f32 v18, v40, v42
  v_smfmac_f32_16x16x64_bf16 v[36:39], v[28:31], a[56:63], v6
  s_nop 0
  v_add_f32_dpp v13, v19, v18 quad_perm:[1,1,3,3] row_mask:0x4 bank_mask:0xf
  s_add_u32 s40, s40, 0x2000000
  s_add_u32 s41, s41, 0x2000000
  s_add_u32 s42, s42, 0x2000000
  s_add_u32 s43, s43, 0x2000000
  s_add_u32 s44, s44, 0x2000000
  s_add_u32 s90, s90, 0x2000000
  s_min_u32 s90, s90, s10
  s_mov_b32 s94, s90
  buffer_load_dwordx4 a[0:3], v1, s[8:11], s43 offen offset:0 nt
  v_cmp_gt_u32 vcc, s22, v15
  v_mov_b32 v23, 0xff800000
  v_add_f32 v21, v45, v47
  v_add_f32 v20, v44, v46
  v_mov_b32 v40, 0
  s_nop 0
  v_add_f32_dpp v13, v21, v20 quad_perm:[1,1,3,3] row_mask:0x8 bank_mask:0xf
  v_mov_b32 v41, 0
  v_mov_b32 v42, 0
  v_mov_b32 v43, 0
  v_add_f32 v19, v33, v35
  v_add_f32 v18, v32, v34
  v_mov_b32 v44, 0
  s_nop 0
  v_add_f32_dpp v14, v19, v18 quad_perm:[1,1,3,3] row_mask:0x1 bank_mask:0xf
  v_mov_b32 v45, 0
  v_mov_b32 v46, 0
  v_add_f32 v21, v37, v39
  v_add_f32 v20, v36, v38
  v_mov_b32 v47, 0
  s_nop 0
  v_add_f32_dpp v14, v21, v20 quad_perm:[1,1,3,3] row_mask:0x2 bank_mask:0xf
  v_sub_f32 v14, v14, v13
  v_sub_f32 v13, v13, v12
  v_cndmask_b32 v14, v23, v14, vcc
  v_max3_f32 v16, v12, v13, v14
  v_mov_b32 v32, 0
  v_mov_b32 v33, 0
  v_max_f32_dpp v16, v16, v16 quad_perm:[2,3,0,1] row_mask:0xf bank_mask:0xf
  v_mov_b32 v34, 0
  v_mov_b32 v35, 0
  v_max_f32_dpp v16, v16, v16 row_ror:4 row_mask:0xf bank_mask:0xf
  v_mov_b32 v36, 0
  v_mov_b32 v37, 0
  v_max_f32_dpp v18, v16, v16 row_ror:8 row_mask:0xf bank_mask:0xf
  v_max_f32_dpp v16, v16, v16 row_ror:8 row_mask:0xf bank_mask:0xf
  v_mov_b32 v38, 0
  v_mov_b32 v39, 0
  v_permlane16_swap_b32 v16, v18
  v_max_f32 v19, v16, v18
  v_max_f32 v16, v16, v18
  s_nop 1
  v_permlane32_swap_b32 v16, v19
  v_max_f32 v16, v16, v19
  v_mul_f32 v16, s51, v16
  v_cmp_lt_f32 vcc, s50, abs(v16)
  s_nop 1
  v_cndmask_b32 v16, 0, v16, vcc
  v_fma_f32 v12, v12, s51, -v16
  v_fma_f32 v14, v14, s51, -v16
  v_fma_f32 v13, v13, s51, -v16
  v_exp_f32 v12, v12
  v_exp_f32 v14, v14
  v_exp_f32 v13, v13
  buffer_load_dwordx4 a[4:7], v1, s[8:11], s43 offen offset:128 nt
  s_cmp_lg_u32 s58, 0
  s_cbranch_scc1 L_eq_246
  s_waitcnt vmcnt(13)
L_eq_246:
  v_mov_b32_dpp v18, v12 quad_perm:[0,0,0,0] row_mask:0xf bank_mask:0xf
  v_mov_b32_dpp v19, v12 quad_perm:[2,2,2,2] row_mask:0xf bank_mask:0xf
  v_cvt_pk_bf16_f32 v20, v18, v19
  v_and_b32 v24, v20, v8
  v_and_b32 v26, v20, v10
  v_and_b32_dpp v25, v20, v9 row_shr:4 row_mask:0xf bank_mask:0xf bound_ctrl:0
  v_and_b32_dpp v27, v20, v11 row_shr:4 row_mask:0xf bank_mask:0xf bound_ctrl:0
  s_nop 1
  v_smfmac_f32_16x16x64_bf16 v[32:35], v[24:27], a[64:71], v7
  v_mov_b32_dpp v18, v14 quad_perm:[0,0,0,0] row_mask:0xf bank_mask:0xf
  v_mov_b32_dpp v19, v14 quad_perm:[2,2,2,2] row_mask:0xf bank_mask:0xf
  v_cvt_pk_bf16_f32 v22, v18, v19
  v_smfmac_f32_16x16x64_bf16 v[36:39], v[24:27], a[72:79], v7
  s_nop 0
  v_mov_b32_dpp v0, v22 row_shl:4 row_mask:0xf bank_mask:0xf
  s_nop 1
  v_permlane32_swap_b32 v22, v0
  v_smfmac_f32_16x16x64_bf16 v[40:43], v[24:27], a[80:87], v7
  v_and_b32 v28, v22, v8
  v_and_b32 v30, v22, v10
  v_smfmac_f32_16x16x64_bf16 v[44:47], v[24:27], a[88:95], v7
  v_and_b32_dpp v29, v22, v9 row_shr:4 row_mask:0xf bank_mask:0xf bound_ctrl:0
  v_and_b32_dpp v31, v22, v11 row_shr:4 row_mask:0xf bank_mask:0xf bound_ctrl:0
  buffer_load_dwordx4 a[8:11], v1, s[8:11], s43 offen offset:256 nt
  s_nop 0
  v_smfmac_f32_16x16x64_bf16 v[32:35], v[28:31], v[64:71], v7
  v_and_b32 v25, v20, v9
  v_add_f32 v17, v12, v13
  v_smfmac_f32_16x16x64_bf16 v[36:39], v[28:31], v[72:79], v7
  v_and_b32 v27, v20, v11
  v_add_f32 v17, v14, v17
  v_smfmac_f32_16x16x64_bf16 v[40:43], v[28:31], v[48:55], v7
  v_and_b32_dpp v24, v20, v8 row_shl:4 row_mask:0xf bank_mask:0xf bound_ctrl:0
  v_add_f32_dpp v17, v17, v17 quad_perm:[2,3,0,1] row_mask:0xf bank_mask:0xf
  v_smfmac_f32_16x16x64_bf16 v[44:47], v[28:31], v[56:63], v7
  v_and_b32_dpp v26, v20, v10 row_shl:4 row_mask:0xf bank_mask:0xf bound_ctrl:0
  v_add_f32_dpp v17, v17, v17 row_ror:4 row_mask:0xf bank_mask:0xf
  s_nop 0
  v_smfmac_f32_16x16x64_bf16 v[32:35], v[24:27], a[96:103], v7
  v_mov_b32_dpp v18, v13 quad_perm:[0,0,0,0] row_mask:0xf bank_mask:0xf
  v_mov_b32_dpp v19, v13 quad_perm:[2,2,2,2] row_mask:0xf bank_mask:0xf
  v_smfmac_f32_16x16x64_bf16 v[36:39], v[24:27], a[104:111], v7
  v_cvt_pk_bf16_f32 v21, v18, v19
  v_and_b32 v28, v21, v8
  v_smfmac_f32_16x16x64_bf16 v[40:43], v[24:27], a[112:119], v7
  v_and_b32 v30, v21, v10
  v_and_b32_dpp v29, v21, v9 row_shr:4 row_mask:0xf bank_mask:0xf bound_ctrl:0
  v_smfmac_f32_16x16x64_bf16 v[44:47], v[24:27], a[120:127], v7
  v_and_b32_dpp v31, v21, v11 row_shr:4 row_mask:0xf bank_mask:0xf bound_ctrl:0
  v_add_f32_dpp v17, v17, v17 row_ror:8 row_mask:0xf bank_mask:0xf
  buffer_load_dwordx4 a[12:15], v1, s[8:11], s43 offen offset:384 nt
  s_waitcnt lgkmcnt(15)
  s_waitcnt lgkmcnt(14)
  v_smfmac_f32_16x16x64_bf16 v[32:35], v[28:31], v[96:103], v7
  v_and_b32 v25, v21, v9
  v_mov_b32 v23, v17
  s_waitcnt lgkmcnt(13)
  s_waitcnt lgkmcnt(12)
  v_smfmac_f32_16x16x64_bf16 v[36:39], v[28:31], v[104:111], v7
  v_and_b32 v27, v21, v11
  v_permlane16_swap_b32 v17, v23
  s_waitcnt lgkmcnt(11)
  s_waitcnt lgkmcnt(10)
  v_smfmac_f32_16x16x64_bf16 v[40:43], v[28:31], v[112:119], v7
  v_and_b32_dpp v24, v21, v8 row_shl:4 row_mask:0xf bank_mask:0xf bound_ctrl:0
  v_add_f32 v17, v17, v23
  s_waitcnt lgkmcnt(9)
  s_waitcnt lgkmcnt(8)
  v_smfmac_f32_16x16x64_bf16 v[44:47], v[28:31], v[120:127], v7
  v_and_b32_dpp v26, v21, v10 row_shl:4 row_mask:0xf bank_mask:0xf bound_ctrl:0
  v_mov_b32 v23, v17
  s_waitcnt lgkmcnt(7)
  s_waitcnt lgkmcnt(6)
  v_smfmac_f32_16x16x64_bf16 v[32:35], v[24:27], v[128:135], v7
  v_permlane32_swap_b32 v17, v23
  v_add_f32 v17, v17, v23
  s_waitcnt lgkmcnt(5)
  s_waitcnt lgkmcnt(4)
  v_smfmac_f32_16x16x64_bf16 v[36:39], v[24:27], v[136:143], v7
  v_add_u32 v18, s54, v4
  v_mov_b32 v19, s55
  s_waitcnt lgkmcnt(3)
  s_waitcnt lgkmcnt(2)
  v_smfmac_f32_16x16x64_bf16 v[40:43], v[24:27], v[144:151], v7
  v_mov_b32 v20, 1
  v_mov_b32 v21, 0
  s_waitcnt lgkmcnt(1)
  s_waitcnt lgkmcnt(0)
  v_smfmac_f32_16x16x64_bf16 v[44:47], v[24:27], v[152:159], v7
  v_mov_b32 v22, s48
  buffer_load_dwordx4 a[16:19], v1, s[8:11], s43 offen offset:512 nt
  v_permlane32_swap_b32 v32, v36
  v_permlane32_swap_b32 v33, v37
  v_permlane32_swap_b32 v34, v38
  v_permlane32_swap_b32 v35, v39
  v_add_f32_dpp v32, v36, v32 row_ror:8 row_mask:0xf bank_mask:0x3
  v_add_f32_dpp v33, v37, v33 row_ror:8 row_mask:0xf bank_mask:0x3
  v_add_f32_dpp v34, v38, v34 row_ror:8 row_mask:0xf bank_mask:0x3
  v_add_f32_dpp v35, v39, v35 row_ror:8 row_mask:0xf bank_mask:0x3
  v_permlane32_swap_b32 v40, v44
  v_permlane32_swap_b32 v41, v45
  v_permlane32_swap_b32 v42, v46
  v_permlane32_swap_b32 v43, v47
  v_add_f32_dpp v32, v40, v44 row_ror:8 row_mask:0xf bank_mask:0xc
  v_add_f32_dpp v33, v41, v45 row_ror:8 row_mask:0xf bank_mask:0xc
  v_add_f32_dpp v34, v42, v46 row_ror:8 row_mask:0xf bank_mask:0xc
  v_add_f32_dpp v35, v43, v47 row_ror:8 row_mask:0xf bank_mask:0xc
  buffer_load_dwordx4 a[20:23], v1, s[8:11], s43 offen offset:640 nt
  ds_write_b128 v18, v[32:35] offset:4096
  s_mov_b64 exec, 1
  ds_write_b64 v19, v[16:17] offset:10272
  ds_add_rtn_u32 v20, v21, v20 offset:10308
  s_mov_b64 exec, -1
  ds_read_b128 v[24:27], v21 offset:10272
  ds_read_b128 v[28:31], v21 offset:10288
  ds_read_b128 v[96:99], v4 offset:4096
  ds_read_b128 v[100:103], v4 offset:5120
  ds_read_b128 v[104:107], v4 offset:6144
  ds_read_b128 v[108:111], v4 offset:7168
  s_add_u32 s38, s47, 524288
  s_waitcnt lgkmcnt(6)
  v_readfirstlane_b32 s39, v20
  s_and_b32 s39, s39, 3
  s_cmp_eq_u32 s39, 3
  s_cselect_b32 s58, 1, 0
  s_cbranch_scc0 L_nl_247
  s_waitcnt lgkmcnt(4)
  v_or3_b32 v16, v24, v26, v28
  v_add_f32 v17, v25, v27
  v_or_b32 v16, v16, v30
  v_add_f32 v23, v29, v31
  v_cmp_eq_u32 vcc, 0, v16
  v_add_f32 v17, v17, v23
  s_cbranch_vccz L_gen_248
  v_rcp_f32 v20, v17
  s_waitcnt lgkmcnt(2)
  v_pk_add_f32 v[32:33], v[96:97], v[100:101]
  v_pk_add_f32 v[34:35], v[98:99], v[102:103]
  s_waitcnt lgkmcnt(0)
  v_pk_add_f32 v[96:97], v[104:105], v[108:109]
  v_pk_add_f32 v[98:99], v[106:107], v[110:111]
  v_pk_add_f32 v[32:33], v[32:33], v[96:97]
  v_pk_add_f32 v[34:35], v[34:35], v[98:99]
L_join_249:
  s_cmp_eq_u32 s27, 33
  v_lshrrev_b32 v18, 1, v4
  v_pk_mul_f32 v[32:33], v[32:33], v[20:21] op_sel_hi:[1,0]
  v_pk_mul_f32 v[34:35], v[34:35], v[20:21] op_sel_hi:[1,0]
  v_cvt_pk_f16_f32 v32, v32, v33
  v_cvt_pk_f16_f32 v33, v34, v35
  v_min_u32 v32, -2, v32
  v_min_u32 v33, -2, v33
  v_and_b32 v17, -2, v17
  s_cbranch_scc0 L_ls_250
  buffer_store_dwordx2 v[32:33], v18, s[16:19], s38 offen
  s_mov_b64 exec, 1
  buffer_store_dwordx2 v[16:17], v22, s[16:19], s38 offen
  s_mov_b64 exec, -1
L_nl_247:
  s_waitcnt lgkmcnt(0)
L_PV1:
  v_lshrrev_b32 v18, 6, v4
  v_lshl_add_u32 v18, v18, 4, s57
  ds_read_b96 v[20:22], v18
  buffer_load_dwordx4 a[24:27], v1, s[8:11], s43 offen offset:768 nt
  buffer_load_dwordx4 a[28:31], v1, s[8:11], s43 offen offset:896 nt
  v_mov_b64 v[32:33], 0
  v_mov_b64 v[34:35], 0
  v_mov_b64 v[36:37], 0
  v_mov_b64 v[38:39], 0
  v_mov_b64 v[40:41], 0
  v_mov_b64 v[42:43], 0
  v_mov_b64 v[44:45], 0
  v_mov_b64 v[46:47], 0
  s_cmp_lg_u32 s58, 0
  s_cbranch_scc1 L_xs_251
  s_waitcnt vmcnt(17)
L_xs_251:
  s_waitcnt vmcnt(19)
  ds_read_b128 v[96:99], v3 offset:17408
  ds_read_b128 v[100:103], v3 offset:25600
  ds_read_b128 v[104:107], v3 offset:18432
  ds_read_b128 v[108:111], v3 offset:26624
  ds_read_b128 v[112:115], v3 offset:19456
  ds_read_b128 v[116:119], v3 offset:27648
  ds_read_b128 v[120:123], v3 offset:20480
  ds_read_b128 v[124:127], v3 offset:28672
  s_waitcnt lgkmcnt(8)
  v_and_b32 v24, v20, v8
  v_and_b32 v26, v20, v10
  v_and_b32_dpp v25, v20, v9 row_shr:4 row_mask:0xf bank_mask:0xf bound_ctrl:0
  v_and_b32_dpp v27, v20, v11 row_shr:4 row_mask:0xf bank_mask:0xf bound_ctrl:0
  s_nop 1
  v_smfmac_f32_16x16x64_bf16 v[32:35], v[24:27], a[192:199], v7
  v_and_b32 v29, v20, v9
  v_smfmac_f32_16x16x64_bf16 v[36:39], v[24:27], a[200:207], v7
  v_and_b32 v31, v20, v11
  v_smfmac_f32_16x16x64_bf16 v[40:43], v[24:27], a[208:215], v7
  v_and_b32_dpp v28, v20, v8 row_shl:4 row_mask:0xf bank_mask:0xf bound_ctrl:0
  v_smfmac_f32_16x16x64_bf16 v[44:47], v[24:27], a[216:223], v7
  v_and_b32_dpp v30, v20, v10 row_shl:4 row_mask:0xf bank_mask:0xf bound_ctrl:0
  ds_read_b128 v[128:131], v3 offset:21504
  ds_read_b128 v[132:135], v3 offset:29696
  ds_read_b128 v[136:139], v3 offset:22528
  ds_read_b128 v[140:143], v3 offset:30720
  ds_read_b128 v[144:147], v3 offset:23552
  ds_read_b128 v[148:151], v3 offset:31744
  ds_read_b128 v[152:155], v3 offset:24576
  ds_read_b128 v[156:159], v3 offset:32768
  buffer_load_dwordx4 a[32:35], v1, s[88:91], s44 offen offset:0 nt
  buffer_load_dwordx4 a[36:39], v1, s[88:91], s44 offen offset:128 nt
  v_smfmac_f32_16x16x64_bf16 v[32:35], v[28:31], a[224:231], v7
  v_and_b32 v24, v21, v8
  v_smfmac_f32_16x16x64_bf16 v[36:39], v[28:31], a[232:239], v7
  v_and_b32 v26, v21, v10
  v_smfmac_f32_16x16x64_bf16 v[40:43], v[28:31], a[240:247], v7
  v_and_b32_dpp v25, v21, v9 row_shr:4 row_mask:0xf bank_mask:0xf bound_ctrl:0
  v_smfmac_f32_16x16x64_bf16 v[44:47], v[28:31], a[248:255], v7
  v_and_b32_dpp v27, v21, v11 row_shr:4 row_mask:0xf bank_mask:0xf bound_ctrl:0
  buffer_load_dwordx4 a[40:43], v1, s[88:91], s44 offen offset:256 nt
  s_waitcnt lgkmcnt(15)
  s_waitcnt lgkmcnt(14)
  v_smfmac_f32_16x16x64_bf16 v[32:35], v[24:27], v[96:103], v7
  v_and_b32 v29, v21, v9
  s_waitcnt lgkmcnt(13)
  s_waitcnt lgkmcnt(12)
  v_smfmac_f32_16x16x64_bf16 v[36:39], v[24:27], v[104:111], v7
  v_and_b32 v31, v21, v11
  s_waitcnt lgkmcnt(11)
  s_waitcnt lgkmcnt(10)
  v_smfmac_f32_16x16x64_bf16 v[40:43], v[24:27], v[112:119], v7
  v_and_b32_dpp v28, v21, v8 row_shl:4 row_mask:0xf bank_mask:0xf bound_ctrl:0
  s_waitcnt lgkmcnt(9)
  s_waitcnt lgkmcnt(8)
  v_smfmac_f32_16x16x64_bf16 v[44:47], v[24:27], v[120:127], v7
  v_and_b32_dpp v30, v21, v10 row_shl:4 row_mask:0xf bank_mask:0xf bound_ctrl:0
  buffer_load_dwordx4 a[44:47], v1, s[88:91], s44 offen offset:384 nt
  buffer_load_dwordx4 a[48:51], v1, s[88:91], s44 offen offset:512 nt
  s_waitcnt lgkmcnt(7)
  s_waitcnt lgkmcnt(6)
  v_smfmac_f32_16x16x64_bf16 v[32:35], v[28:31], v[128:135], v7
  v_and_b32 v24, v22, v8
  s_waitcnt lgkmcnt(5)
  s_waitcnt lgkmcnt(4)
  v_smfmac_f32_16x16x64_bf16 v[36:39], v[28:31], v[136:143], v7
  v_and_b32 v26, v22, v10
  s_waitcnt lgkmcnt(3)
  s_waitcnt lgkmcnt(2)
  v_smfmac_f32_16x16x64_bf16 v[40:43], v[28:31], v[144:151], v7
  v_and_b32_dpp v25, v22, v9 row_shr:4 row_mask:0xf bank_mask:0xf bound_ctrl:0
  s_waitcnt lgkmcnt(1)
  s_waitcnt lgkmcnt(0)
  v_smfmac_f32_16x16x64_bf16 v[44:47], v[28:31], v[152:159], v7
  v_and_b32_dpp v27, v22, v11 row_shr:4 row_mask:0xf bank_mask:0xf bound_ctrl:0
  buffer_load_dwordx4 a[52:55], v1, s[88:91], s44 offen offset:640 nt
  s_cmp_lg_u32 s58, 0
  s_cbranch_scc1 L_xs_252
  s_waitcnt vmcnt(20)
L_xs_252:
  s_waitcnt vmcnt(22)
  ds_read_b128 v[64:67], v3 offset:33792
  ds_read_b128 v[68:71], v3 offset:34816
  s_cmp_lg_u32 s58, 0
  s_cbranch_scc1 L_xs_253
  s_waitcnt vmcnt(18)
L_xs_253:
  s_waitcnt vmcnt(20)
  ds_read_b128 v[72:75], v3 offset:35840
  ds_read_b128 v[76:79], v3 offset:36864
  v_add_u32 v18, s54, v4
  v_mov_b32 v19, s55
  v_mov_b32 v20, 1
  v_mov_b32 v21, 0
  v_mov_b32 v22, s48
  s_waitcnt lgkmcnt(3)
  s_waitcnt lgkmcnt(2)
  v_smfmac_f32_16x16x64_bf16 v[32:35], v[24:27], v[64:71], v7
  s_waitcnt lgkmcnt(1)
  s_waitcnt lgkmcnt(0)
  v_smfmac_f32_16x16x64_bf16 v[36:39], v[24:27], v[72:79], v7
  s_cmp_lg_u32 s58, 0
  s_cbranch_scc1 L_xs_254
  s_waitcnt vmcnt(16)
L_xs_254:
  s_waitcnt vmcnt(18)
  v_smfmac_f32_16x16x64_bf16 v[40:43], v[24:27], v[80:87], v7
  s_cmp_lg_u32 s58, 0
  s_cbranch_scc1 L_xs_255
  s_waitcnt vmcnt(14)
L_xs_255:
  s_waitcnt vmcnt(16)
  v_smfmac_f32_16x16x64_bf16 v[44:47], v[24:27], v[88:95], v7
  v_permlane32_swap_b32 v32, v36
  v_permlane32_swap_b32 v33, v37
  v_permlane32_swap_b32 v34, v38
  v_permlane32_swap_b32 v35, v39
  v_add_f32_dpp v32, v36, v32 row_ror:8 row_mask:0xf bank_mask:0x3
  v_add_f32_dpp v33, v37, v33 row_ror:8 row_mask:0xf bank_mask:0x3
  v_add_f32_dpp v34, v38, v34 row_ror:8 row_mask:0xf bank_mask:0x3
  v_add_f32_dpp v35, v39, v35 row_ror:8 row_mask:0xf bank_mask:0x3
  s_nop 0
  v_permlane32_swap_b32 v40, v44
  v_permlane32_swap_b32 v41, v45
  v_permlane32_swap_b32 v42, v46
  v_permlane32_swap_b32 v43, v47
  v_add_f32_dpp v32, v40, v44 row_ror:8 row_mask:0xf bank_mask:0xc
  v_add_f32_dpp v33, v41, v45 row_ror:8 row_mask:0xf bank_mask:0xc
  v_add_f32_dpp v34, v42, v46 row_ror:8 row_mask:0xf bank_mask:0xc
  v_add_f32_dpp v35, v43, v47 row_ror:8 row_mask:0xf bank_mask:0xc
  buffer_load_dwordx4 a[56:59], v1, s[88:91], s44 offen offset:768 nt
  buffer_load_dwordx4 a[60:63], v1, s[88:91], s44 offen offset:896 nt
  ds_write_b128 v18, v[32:35] offset:0
  s_mov_b64 exec, 1
  ds_add_rtn_u32 v20, v21, v20 offset:10304
  s_mov_b64 exec, -1
  ds_read_b128 v[24:27], v21 offset:10336
  ds_read_b128 v[28:31], v21 offset:10352
  ds_read_b128 v[96:99], v4 offset:0
  ds_read_b128 v[100:103], v4 offset:1024
  ds_read_b128 v[104:107], v4 offset:2048
  ds_read_b128 v[108:111], v4 offset:3072
  s_mov_b32 s38, s47
  s_waitcnt lgkmcnt(6)
  v_readfirstlane_b32 s39, v20
  s_and_b32 s39, s39, 3
  s_cmp_eq_u32 s39, 3
  s_mov_b32 s26, s59
  s_cselect_b32 s59, 2, s59
  s_cbranch_scc0 L_nl_256
  s_waitcnt lgkmcnt(4)
  v_or3_b32 v16, v24, v26, v28
  v_add_f32 v17, v25, v27
  v_or_b32 v16, v16, v30
  v_add_f32 v23, v29, v31
  v_cmp_eq_u32 vcc, 0, v16
  v_add_f32 v17, v17, v23
  s_cbranch_vccz L_gen_257
  v_rcp_f32 v20, v17
  s_waitcnt lgkmcnt(2)
  v_pk_add_f32 v[32:33], v[96:97], v[100:101]
  v_pk_add_f32 v[34:35], v[98:99], v[102:103]
  s_waitcnt lgkmcnt(0)
  v_pk_add_f32 v[96:97], v[104:105], v[108:109]
  v_pk_add_f32 v[98:99], v[106:107], v[110:111]
  v_pk_add_f32 v[32:33], v[32:33], v[96:97]
  v_pk_add_f32 v[34:35], v[34:35], v[98:99]
L_join_258:
  s_cmp_eq_u32 s27, 33
  v_lshrrev_b32 v18, 1, v4
  v_pk_mul_f32 v[32:33], v[32:33], v[20:21] op_sel_hi:[1,0]
  v_pk_mul_f32 v[34:35], v[34:35], v[20:21] op_sel_hi:[1,0]
  v_cvt_pk_f16_f32 v32, v32, v33
  v_cvt_pk_f16_f32 v33, v34, v35
  v_min_u32 v32, -2, v32
  v_min_u32 v33, -2, v33
  v_and_b32 v17, -2, v17
  s_cbranch_scc0 L_ls_259
  buffer_store_dwordx2 v[32:33], v18, s[16:19], s38 offen
  s_mov_b64 exec, 1
  buffer_store_dwordx2 v[16:17], v22, s[16:19], s38 offen
  s_mov_b64 exec, -1
L_nl_256:
  s_waitcnt lgkmcnt(0)
  v_mov_b64 v[48:49], v[80:81]
  v_mov_b64 v[50:51], v[82:83]
  v_mov_b64 v[52:53], v[84:85]
  v_mov_b64 v[54:55], v[86:87]
  v_mov_b64 v[56:57], v[88:89]
  v_mov_b64 v[58:59], v[90:91]
  v_mov_b64 v[60:61], v[92:93]
  v_mov_b64 v[62:63], v[94:95]
  s_add_u32 s49, s49, 1
  s_add_u32 s53, s53, 512
  s_add_u32 s56, s56, 8192
  s_mov_b32 s46, s56
  s_add_u32 s35, s35, 10
  s_branch L_A0
L_last:
  v_lshrrev_b32 v18, 6, v4
  v_lshl_add_u32 v18, v18, 4, s57
  ds_read_b96 v[20:22], v18
  v_smfmac_f32_16x16x64_bf16 v[32:35], v[24:27], v[64:71], v6
  v_smfmac_f32_16x16x64_bf16 v[32:35], v[28:31], v[72:79], v6
  buffer_load_dwordx4 v[68:71], v2, s[92:95], s44 offen offset:1024 nt
  buffer_load_dwordx4 v[72:75], v2, s[92:95], s44 offen offset:128 nt
  buffer_load_dwordx4 v[76:79], v2, s[92:95], s44 offen offset:1152 nt
  v_smfmac_f32_16x16x64_bf16 v[36:39], v[24:27], v[80:87], v6
  v_smfmac_f32_16x16x64_bf16 v[36:39], v[28:31], v[88:95], v6
  buffer_load_dwordx4 v[80:83], v2, s[92:95], s44 offen offset:256 nt
  buffer_load_dwordx4 v[84:87], v2, s[92:95], s44 offen offset:1280 nt
  buffer_load_dwordx4 v[88:91], v2, s[92:95], s44 offen offset:384 nt
  buffer_load_dwordx4 v[92:95], v2, s[92:95], s44 offen offset:1408 nt
  v_smfmac_f32_16x16x64_bf16 v[40:43], v[24:27], v[96:103], v6
  v_smfmac_f32_16x16x64_bf16 v[40:43], v[28:31], v[104:111], v6
  ds_read_b128 v[96:99], v3 offset:17408
  ds_read_b128 v[104:107], v3 offset:18432
  v_smfmac_f32_16x16x64_bf16 v[44:47], v[24:27], v[112:119], v6
  v_add_f32 v17, v33, v35
  v_add_f32 v16, v32, v34
  v_smfmac_f32_16x16x64_bf16 v[44:47], v[28:31], v[120:127], v6
  s_nop 0
  v_add_f32_dpp v12, v17, v16 quad_perm:[1,1,3,3] row_mask:0x1 bank_mask:0xf
  ds_read_b128 v[112:115], v3 offset:19456
  ds_read_b128 v[120:123], v3 offset:20480
  v_smfmac_f32_16x16x64_bf16 v[32:35], v[24:27], v[128:135], v6
  v_add_f32 v19, v37, v39
  v_add_f32 v18, v36, v38
  v_smfmac_f32_16x16x64_bf16 v[32:35], v[28:31], v[136:143], v6
  s_nop 0
  v_add_f32_dpp v12, v19, v18 quad_perm:[1,1,3,3] row_mask:0x2 bank_mask:0xf
  s_waitcnt vmcnt(22)
  ds_read_b128 v[128:131], v3 offset:21504
  s_waitcnt vmcnt(20)
  ds_read_b128 v[136:139], v3 offset:22528
  v_smfmac_f32_16x16x64_bf16 v[36:39], v[24:27], v[144:151], v6
  v_add_f32 v17, v41, v43
  v_add_f32 v16, v40, v42
  v_smfmac_f32_16x16x64_bf16 v[36:39], v[28:31], v[152:159], v6
  s_nop 0
  v_add_f32_dpp v12, v17, v16 quad_perm:[1,1,3,3] row_mask:0x4 bank_mask:0xf
  s_waitcnt vmcnt(19)
  ds_read_b128 v[144:147], v3 offset:23552
  s_waitcnt vmcnt(18)
  ds_read_b128 v[152:155], v3 offset:24576
  v_smfmac_f32_16x16x64_bf16 v[40:43], v[24:27], a[0:7], v6
  v_add_f32 v19, v45, v47
  v_add_f32 v18, v44, v46
  v_smfmac_f32_16x16x64_bf16 v[40:43], v[28:31], a[8:15], v6
  s_nop 0
  v_add_f32_dpp v12, v19, v18 quad_perm:[1,1,3,3] row_mask:0x8 bank_mask:0xf
  v_smfmac_f32_16x16x64_bf16 v[44:47], v[24:27], a[16:23], v6
  v_add_f32 v17, v33, v35
  v_add_f32 v16, v32, v34
  v_smfmac_f32_16x16x64_bf16 v[44:47], v[28:31], a[24:31], v6
  s_nop 0
  v_add_f32_dpp v13, v17, v16 quad_perm:[1,1,3,3] row_mask:0x1 bank_mask:0xf
  v_smfmac_f32_16x16x64_bf16 v[32:35], v[24:27], a[32:39], v6
  v_add_f32 v19, v37, v39
  v_add_f32 v18, v36, v38
  v_smfmac_f32_16x16x64_bf16 v[32:35], v[28:31], a[40:47], v6
  s_nop 0
  v_add_f32_dpp v13, v19, v18 quad_perm:[1,1,3,3] row_mask:0x2 bank_mask:0xf
  v_smfmac_f32_16x16x64_bf16 v[36:39], v[24:27], a[48:55], v6
  v_add_f32 v17, v41, v43
  v_add_f32 v16, v40, v42
  v_smfmac_f32_16x16x64_bf16 v[36:39], v[28:31], a[56:63], v6
  s_nop 0
  v_add_f32_dpp v13, v17, v16 quad_perm:[1,1,3,3] row_mask:0x4 bank_mask:0xf
  v_add_f32 v19, v45, v47
  v_add_f32 v18, v44, v46
  v_mov_b64 v[40:41], 0
  v_mov_b64 v[42:43], 0
  v_add_f32_dpp v13, v19, v18 quad_perm:[1,1,3,3] row_mask:0x8 bank_mask:0xf
  s_cmp_lg_u32 s58, 0
  s_cbranch_scc1 L_eq_260
  s_waitcnt vmcnt(11)
L_eq_260:
  s_waitcnt lgkmcnt(8)
  v_and_b32 v24, v20, v8
  v_and_b32 v26, v20, v10
  v_add_f32 v17, v33, v35
  v_add_f32 v16, v32, v34
  v_mov_b64 v[44:45], 0
  v_mov_b64 v[46:47], 0
  v_add_f32_dpp v14, v17, v16 quad_perm:[1,1,3,3] row_mask:0x1 bank_mask:0xf
  v_and_b32_dpp v25, v20, v9 row_shr:4 row_mask:0xf bank_mask:0xf bound_ctrl:0
  v_and_b32_dpp v27, v20, v11 row_shr:4 row_mask:0xf bank_mask:0xf bound_ctrl:0
  v_add_f32 v19, v37, v39
  v_add_f32 v18, v36, v38
  v_mov_b64 v[32:33], 0
  v_mov_b64 v[34:35], 0
  v_add_f32_dpp v14, v19, v18 quad_perm:[1,1,3,3] row_mask:0x2 bank_mask:0xf
  v_mov_b64 v[36:37], 0
  v_mov_b64 v[38:39], 0
  s_waitcnt vmcnt(17)
  ds_read_b128 v[100:103], v3 offset:25600
  v_smfmac_f32_16x16x64_bf16 v[32:35], v[24:27], a[192:199], v7
  v_and_b32 v29, v20, v9
  s_waitcnt vmcnt(16)
  ds_read_b128 v[108:111], v3 offset:26624
  v_smfmac_f32_16x16x64_bf16 v[36:39], v[24:27], a[200:207], v7
  v_and_b32 v31, v20, v11
  s_waitcnt vmcnt(15)
  ds_read_b128 v[116:119], v3 offset:27648
  v_smfmac_f32_16x16x64_bf16 v[40:43], v[24:27], a[208:215], v7
  v_and_b32_dpp v28, v20, v8 row_shl:4 row_mask:0xf bank_mask:0xf bound_ctrl:0
  s_waitcnt vmcnt(14)
  ds_read_b128 v[124:127], v3 offset:28672
  v_smfmac_f32_16x16x64_bf16 v[44:47], v[24:27], a[216:223], v7
  v_and_b32_dpp v30, v20, v10 row_shl:4 row_mask:0xf bank_mask:0xf bound_ctrl:0
  s_waitcnt vmcnt(13)
  ds_read_b128 v[132:135], v3 offset:29696
  v_smfmac_f32_16x16x64_bf16 v[32:35], v[28:31], a[224:231], v7
  v_and_b32 v24, v21, v8
  s_waitcnt vmcnt(11)
  ds_read_b128 v[140:143], v3 offset:30720
  v_smfmac_f32_16x16x64_bf16 v[36:39], v[28:31], a[232:239], v7
  v_and_b32 v26, v21, v10
  s_waitcnt vmcnt(10)
  ds_read_b128 v[148:151], v3 offset:31744
  v_smfmac_f32_16x16x64_bf16 v[40:43], v[28:31], a[240:247], v7
  v_and_b32_dpp v25, v21, v9 row_shr:4 row_mask:0xf bank_mask:0xf bound_ctrl:0
  s_waitcnt vmcnt(9)
  ds_read_b128 v[156:159], v3 offset:32768
  v_smfmac_f32_16x16x64_bf16 v[44:47], v[28:31], a[248:255], v7
  v_and_b32_dpp v27, v21, v11 row_shr:4 row_mask:0xf bank_mask:0xf bound_ctrl:0
  s_waitcnt vmcnt(8)
  ds_read_b128 v[64:67], v3 offset:33792
  s_waitcnt lgkmcnt(15)
  s_waitcnt lgkmcnt(8)
  v_smfmac_f32_16x16x64_bf16 v[32:35], v[24:27], v[96:103], v7
  v_and_b32 v29, v21, v9
  s_waitcnt lgkmcnt(7)
  v_smfmac_f32_16x16x64_bf16 v[36:39], v[24:27], v[104:111], v7
  v_and_b32 v31, v21, v11
  s_waitcnt lgkmcnt(6)
  v_smfmac_f32_16x16x64_bf16 v[40:43], v[24:27], v[112:119], v7
  v_and_b32_dpp v28, v21, v8 row_shl:4 row_mask:0xf bank_mask:0xf bound_ctrl:0
  s_waitcnt lgkmcnt(5)
  v_smfmac_f32_16x16x64_bf16 v[44:47], v[24:27], v[120:127], v7
  v_and_b32_dpp v30, v21, v10 row_shl:4 row_mask:0xf bank_mask:0xf bound_ctrl:0
  s_waitcnt lgkmcnt(4)
  s_nop 0
  v_smfmac_f32_16x16x64_bf16 v[32:35], v[28:31], v[128:135], v7
  v_and_b32 v24, v22, v8
  s_waitcnt lgkmcnt(3)
  v_smfmac_f32_16x16x64_bf16 v[36:39], v[28:31], v[136:143], v7
  v_and_b32 v26, v22, v10
  s_waitcnt lgkmcnt(2)
  v_smfmac_f32_16x16x64_bf16 v[40:43], v[28:31], v[144:151], v7
  v_and_b32_dpp v25, v22, v9 row_shr:4 row_mask:0xf bank_mask:0xf bound_ctrl:0
  s_waitcnt lgkmcnt(1)
  v_smfmac_f32_16x16x64_bf16 v[44:47], v[28:31], v[152:159], v7
  v_and_b32_dpp v27, v22, v11 row_shr:4 row_mask:0xf bank_mask:0xf bound_ctrl:0
  v_add_u32 v18, s54, v4
  v_mov_b32 v19, s55
  v_mov_b32 v20, 1
  v_mov_b32 v21, 0
  v_mov_b32 v22, s48
  s_waitcnt vmcnt(6)
  s_waitcnt lgkmcnt(0)
  v_smfmac_f32_16x16x64_bf16 v[32:35], v[24:27], v[64:71], v7
  s_waitcnt vmcnt(4)
  v_smfmac_f32_16x16x64_bf16 v[36:39], v[24:27], v[72:79], v7
  s_waitcnt vmcnt(2)
  v_smfmac_f32_16x16x64_bf16 v[40:43], v[24:27], v[80:87], v7
  s_nop 6
  v_permlane32_swap_b32 v32, v36
  v_permlane32_swap_b32 v33, v37
  v_permlane32_swap_b32 v34, v38
  v_permlane32_swap_b32 v35, v39
  v_add_f32_dpp v32, v36, v32 row_ror:8 row_mask:0xf bank_mask:0x3
  v_add_f32_dpp v33, v37, v33 row_ror:8 row_mask:0xf bank_mask:0x3
  v_add_f32_dpp v34, v38, v34 row_ror:8 row_mask:0xf bank_mask:0x3
  v_add_f32_dpp v35, v39, v35 row_ror:8 row_mask:0xf bank_mask:0x3
  s_waitcnt vmcnt(0)
  v_smfmac_f32_16x16x64_bf16 v[44:47], v[24:27], v[88:95], v7
  s_nop 8
  v_permlane32_swap_b32 v40, v44
  v_permlane32_swap_b32 v41, v45
  v_permlane32_swap_b32 v42, v46
  v_permlane32_swap_b32 v43, v47
  v_add_f32_dpp v32, v40, v44 row_ror:8 row_mask:0xf bank_mask:0xc
  v_add_f32_dpp v33, v41, v45 row_ror:8 row_mask:0xf bank_mask:0xc
  v_add_f32_dpp v34, v42, v46 row_ror:8 row_mask:0xf bank_mask:0xc
  v_add_f32_dpp v35, v43, v47 row_ror:8 row_mask:0xf bank_mask:0xc
  ds_write_b128 v18, v[32:35] offset:0
  s_mov_b64 exec, 1
  ds_add_rtn_u32 v20, v21, v20 offset:10304
  s_mov_b64 exec, -1
  ds_read_b128 v[24:27], v21 offset:10336
  ds_read_b128 v[28:31], v21 offset:10352
  ds_read_b128 v[96:99], v4 offset:0
  ds_read_b128 v[100:103], v4 offset:1024
  ds_read_b128 v[104:107], v4 offset:2048
  ds_read_b128 v[108:111], v4 offset:3072
  s_mov_b32 s38, s47
  s_waitcnt lgkmcnt(6)
  v_readfirstlane_b32 s39, v20
  s_and_b32 s39, s39, 3
  s_cmp_eq_u32 s39, 3
  s_mov_b32 s26, s59
  s_cselect_b32 s59, 2, s59
  s_cbranch_scc0 L_nl_261
  s_waitcnt lgkmcnt(4)
  v_or3_b32 v16, v24, v26, v28
  v_add_f32 v17, v25, v27
  v_or_b32 v16, v16, v30
  v_add_f32 v23, v29, v31
  v_cmp_eq_u32 vcc, 0, v16
  v_add_f32 v17, v17, v23
  s_cbranch_vccz L_gen_262
  v_rcp_f32 v20, v17
  s_waitcnt lgkmcnt(2)
  v_pk_add_f32 v[32:33], v[96:97], v[100:101]
  v_pk_add_f32 v[34:35], v[98:99], v[102:103]
  s_waitcnt lgkmcnt(0)
  v_pk_add_f32 v[96:97], v[104:105], v[108:109]
  v_pk_add_f32 v[98:99], v[106:107], v[110:111]
  v_pk_add_f32 v[32:33], v[32:33], v[96:97]
  v_pk_add_f32 v[34:35], v[34:35], v[98:99]
L_join_263:
  s_cmp_eq_u32 s27, 33
  v_lshrrev_b32 v18, 1, v4
  v_pk_mul_f32 v[32:33], v[32:33], v[20:21] op_sel_hi:[1,0]
  v_pk_mul_f32 v[34:35], v[34:35], v[20:21] op_sel_hi:[1,0]
  v_cvt_pk_f16_f32 v32, v32, v33
  v_cvt_pk_f16_f32 v33, v34, v35
  v_min_u32 v32, -2, v32
  v_min_u32 v33, -2, v33
  v_and_b32 v17, -2, v17
  s_cbranch_scc0 L_ls_264
  buffer_store_dwordx2 v[32:33], v18, s[16:19], s38 offen
  s_mov_b64 exec, 1
  buffer_store_dwordx2 v[16:17], v22, s[16:19], s38 offen
  s_mov_b64 exec, -1
L_nl_261:
  s_waitcnt lgkmcnt(0)
  ds_read_b128 a[0:3], v3 offset:16384
  ds_read_b128 a[4:7], v3 offset:34816
  ds_read_b128 a[8:11], v3 offset:35840
  ds_read_b128 a[12:15], v3 offset:36864
  ds_read_b128 v[96:99], v3 offset:0
  ds_read_b128 v[100:103], v3 offset:8192
  ds_read_b128 v[104:107], v3 offset:1024
  ds_read_b128 v[108:111], v3 offset:9216
  ds_read_b128 v[112:115], v3 offset:2048
  ds_read_b128 v[116:119], v3 offset:10240
  ds_read_b128 v[120:123], v3 offset:3072
  ds_read_b128 v[124:127], v3 offset:11264
  ds_read_b128 v[128:131], v3 offset:4096
  ds_read_b128 v[132:135], v3 offset:12288
  ds_read_b128 v[136:139], v3 offset:5120
  ds_read_b128 v[140:143], v3 offset:13312
  ds_read_b128 v[144:147], v3 offset:6144
  ds_read_b128 v[148:151], v3 offset:14336
  ds_read_b128 v[152:155], v3 offset:7168
  ds_read_b128 v[156:159], v3 offset:15360
  v_cmp_gt_u32 vcc, s22, v15
  v_mov_b32 v23, 0xff800000
  v_mov_b32 v40, 0
  v_mov_b32 v41, 0
  v_mov_b32 v42, 0
  v_mov_b32 v43, 0
  v_mov_b32 v44, 0
  v_mov_b32 v45, 0
  v_mov_b32 v46, 0
  v_mov_b32 v47, 0
  v_sub_f32 v14, v14, v13
  v_sub_f32 v13, v13, v12
  v_cndmask_b32 v14, v23, v14, vcc
  v_max3_f32 v16, v12, v13, v14
  v_mov_b32 v32, 0
  v_mov_b32 v33, 0
  v_max_f32_dpp v16, v16, v16 quad_perm:[2,3,0,1] row_mask:0xf bank_mask:0xf
  v_mov_b32 v34, 0
  v_mov_b32 v35, 0
  v_max_f32_dpp v16, v16, v16 row_ror:4 row_mask:0xf bank_mask:0xf
  v_mov_b32 v36, 0
  v_mov_b32 v37, 0
  v_max_f32_dpp v18, v16, v16 row_ror:8 row_mask:0xf bank_mask:0xf
  v_max_f32_dpp v16, v16, v16 row_ror:8 row_mask:0xf bank_mask:0xf
  v_mov_b32 v38, 0
  v_mov_b32 v39, 0
  v_permlane16_swap_b32 v16, v18
  v_max_f32 v19, v16, v18
  v_max_f32 v16, v16, v18
  s_nop 1
  v_permlane32_swap_b32 v16, v19
  v_max_f32 v16, v16, v19
  v_mul_f32 v16, s51, v16
  v_cmp_lt_f32 vcc, s50, abs(v16)
  s_nop 1
  v_cndmask_b32 v16, 0, v16, vcc
  v_fma_f32 v12, v12, s51, -v16
  v_fma_f32 v14, v14, s51, -v16
  v_fma_f32 v13, v13, s51, -v16
  v_exp_f32 v12, v12
  v_exp_f32 v14, v14
  v_exp_f32 v13, v13
  v_mov_b32_dpp v18, v12 quad_perm:[0,0,0,0] row_mask:0xf bank_mask:0xf
  v_mov_b32_dpp v19, v12 quad_perm:[2,2,2,2] row_mask:0xf bank_mask:0xf
  v_cvt_pk_bf16_f32 v20, v18, v19
  v_and_b32 v24, v20, v8
  v_and_b32 v26, v20, v10
  v_and_b32_dpp v25, v20, v9 row_shr:4 row_mask:0xf bank_mask:0xf bound_ctrl:0
  v_and_b32_dpp v27, v20, v11 row_shr:4 row_mask:0xf bank_mask:0xf bound_ctrl:0
  s_nop 1
  v_smfmac_f32_16x16x64_bf16 v[32:35], v[24:27], a[64:71], v7
  v_and_b32 v29, v20, v9
  v_add_f32 v17, v12, v13
  v_smfmac_f32_16x16x64_bf16 v[36:39], v[24:27], a[72:79], v7
  v_and_b32 v31, v20, v11
  v_add_f32 v17, v14, v17
  v_smfmac_f32_16x16x64_bf16 v[40:43], v[24:27], a[80:87], v7
  v_and_b32_dpp v28, v20, v8 row_shl:4 row_mask:0xf bank_mask:0xf bound_ctrl:0
  v_add_f32_dpp v17, v17, v17 quad_perm:[2,3,0,1] row_mask:0xf bank_mask:0xf
  v_smfmac_f32_16x16x64_bf16 v[44:47], v[24:27], a[88:95], v7
  v_and_b32_dpp v30, v20, v10 row_shl:4 row_mask:0xf bank_mask:0xf bound_ctrl:0
  v_add_f32_dpp v17, v17, v17 row_ror:4 row_mask:0xf bank_mask:0xf
  s_nop 0
  v_smfmac_f32_16x16x64_bf16 v[32:35], v[28:31], a[96:103], v7
  v_mov_b32_dpp v18, v14 quad_perm:[0,0,0,0] row_mask:0xf bank_mask:0xf
  v_mov_b32_dpp v19, v14 quad_perm:[2,2,2,2] row_mask:0xf bank_mask:0xf
  v_cvt_pk_bf16_f32 v22, v18, v19
  v_smfmac_f32_16x16x64_bf16 v[36:39], v[28:31], a[104:111], v7
  s_nop 0
  v_mov_b32_dpp v0, v22 row_shl:4 row_mask:0xf bank_mask:0xf
  s_nop 1
  v_permlane32_swap_b32 v22, v0
  v_smfmac_f32_16x16x64_bf16 v[40:43], v[28:31], a[112:119], v7
  v_and_b32 v24, v22, v8
  v_and_b32 v26, v22, v10
  v_smfmac_f32_16x16x64_bf16 v[44:47], v[28:31], a[120:127], v7
  v_and_b32_dpp v25, v22, v9 row_shr:4 row_mask:0xf bank_mask:0xf bound_ctrl:0
  v_and_b32_dpp v27, v22, v11 row_shr:4 row_mask:0xf bank_mask:0xf bound_ctrl:0
  s_waitcnt lgkmcnt(15)
  s_nop 0
  v_smfmac_f32_16x16x64_bf16 v[32:35], v[24:27], a[0:7], v7
  v_mov_b32_dpp v18, v13 quad_perm:[0,0,0,0] row_mask:0xf bank_mask:0xf
  v_mov_b32_dpp v19, v13 quad_perm:[2,2,2,2] row_mask:0xf bank_mask:0xf
  v_smfmac_f32_16x16x64_bf16 v[36:39], v[24:27], a[8:15], v7
  v_cvt_pk_bf16_f32 v21, v18, v19
  v_and_b32 v28, v21, v8
  v_smfmac_f32_16x16x64_bf16 v[40:43], v[24:27], v[48:55], v7
  v_and_b32 v30, v21, v10
  v_and_b32_dpp v29, v21, v9 row_shr:4 row_mask:0xf bank_mask:0xf bound_ctrl:0
  v_smfmac_f32_16x16x64_bf16 v[44:47], v[24:27], v[56:63], v7
  v_and_b32_dpp v31, v21, v11 row_shr:4 row_mask:0xf bank_mask:0xf bound_ctrl:0
  v_add_f32_dpp v17, v17, v17 row_ror:8 row_mask:0xf bank_mask:0xf
  s_waitcnt lgkmcnt(14)
  v_smfmac_f32_16x16x64_bf16 v[32:35], v[28:31], v[96:103], v7
  v_and_b32 v25, v21, v9
  v_mov_b32 v23, v17
  s_waitcnt lgkmcnt(13)
  s_waitcnt lgkmcnt(12)
  v_smfmac_f32_16x16x64_bf16 v[36:39], v[28:31], v[104:111], v7
  v_and_b32 v27, v21, v11
  v_permlane16_swap_b32 v17, v23
  s_waitcnt lgkmcnt(11)
  s_waitcnt lgkmcnt(10)
  v_smfmac_f32_16x16x64_bf16 v[40:43], v[28:31], v[112:119], v7
  v_and_b32_dpp v24, v21, v8 row_shl:4 row_mask:0xf bank_mask:0xf bound_ctrl:0
  v_add_f32 v17, v17, v23
  s_waitcnt lgkmcnt(9)
  s_waitcnt lgkmcnt(8)
  v_smfmac_f32_16x16x64_bf16 v[44:47], v[28:31], v[120:127], v7
  v_and_b32_dpp v26, v21, v10 row_shl:4 row_mask:0xf bank_mask:0xf bound_ctrl:0
  v_mov_b32 v23, v17
  s_waitcnt lgkmcnt(7)
  s_waitcnt lgkmcnt(6)
  v_smfmac_f32_16x16x64_bf16 v[32:35], v[24:27], v[128:135], v7
  v_permlane32_swap_b32 v17, v23
  v_add_f32 v17, v17, v23
  s_waitcnt lgkmcnt(5)
  s_waitcnt lgkmcnt(4)
  v_smfmac_f32_16x16x64_bf16 v[36:39], v[24:27], v[136:143], v7
  v_add_u32 v18, s54, v4
  v_mov_b32 v19, s55
  s_waitcnt lgkmcnt(3)
  s_waitcnt lgkmcnt(2)
  v_smfmac_f32_16x16x64_bf16 v[40:43], v[24:27], v[144:151], v7
  v_mov_b32 v20, 1
  v_mov_b32 v21, 0
  s_waitcnt lgkmcnt(1)
  s_waitcnt lgkmcnt(0)
  v_smfmac_f32_16x16x64_bf16 v[44:47], v[24:27], v[152:159], v7
  v_mov_b32 v22, s48
  v_permlane32_swap_b32 v32, v36
  v_permlane32_swap_b32 v33, v37
  v_permlane32_swap_b32 v34, v38
  v_permlane32_swap_b32 v35, v39
  v_add_f32_dpp v32, v36, v32 row_ror:8 row_mask:0xf bank_mask:0x3
  v_add_f32_dpp v33, v37, v33 row_ror:8 row_mask:0xf bank_mask:0x3
  v_add_f32_dpp v34, v38, v34 row_ror:8 row_mask:0xf bank_mask:0x3
  v_add_f32_dpp v35, v39, v35 row_ror:8 row_mask:0xf bank_mask:0x3
  v_permlane32_swap_b32 v40, v44
  v_permlane32_swap_b32 v41, v45
  v_permlane32_swap_b32 v42, v46
  v_permlane32_swap_b32 v43, v47
  v_add_f32_dpp v32, v40, v44 row_ror:8 row_mask:0xf bank_mask:0xc
  v_add_f32_dpp v33, v41, v45 row_ror:8 row_mask:0xf bank_mask:0xc
  v_add_f32_dpp v34, v42, v46 row_ror:8 row_mask:0xf bank_mask:0xc
  v_add_f32_dpp v35, v43, v47 row_ror:8 row_mask:0xf bank_mask:0xc
  ds_write_b128 v18, v[32:35] offset:4096
  s_mov_b64 exec, 1
  ds_write_b64 v19, v[16:17] offset:10272
  ds_add_rtn_u32 v20, v21, v20 offset:10308
  s_mov_b64 exec, -1
  ds_read_b128 v[24:27], v21 offset:10272
  ds_read_b128 v[28:31], v21 offset:10288
  ds_read_b128 v[96:99], v4 offset:4096
  ds_read_b128 v[100:103], v4 offset:5120
  ds_read_b128 v[104:107], v4 offset:6144
  ds_read_b128 v[108:111], v4 offset:7168
  s_add_u32 s38, s47, 524288
  s_waitcnt lgkmcnt(6)
  v_readfirstlane_b32 s39, v20
  s_and_b32 s39, s39, 3
  s_cmp_eq_u32 s39, 3
  s_cselect_b32 s58, 1, 0
  s_cbranch_scc0 L_nl_265
  s_waitcnt lgkmcnt(4)
  v_or3_b32 v16, v24, v26, v28
  v_add_f32 v17, v25, v27
  v_or_b32 v16, v16, v30
  v_add_f32 v23, v29, v31
  v_cmp_eq_u32 vcc, 0, v16
  v_add_f32 v17, v17, v23
  s_cbranch_vccz L_gen_266
  v_rcp_f32 v20, v17
  s_waitcnt lgkmcnt(2)
  v_pk_add_f32 v[32:33], v[96:97], v[100:101]
  v_pk_add_f32 v[34:35], v[98:99], v[102:103]
  s_waitcnt lgkmcnt(0)
  v_pk_add_f32 v[96:97], v[104:105], v[108:109]
  v_pk_add_f32 v[98:99], v[106:107], v[110:111]
  v_pk_add_f32 v[32:33], v[32:33], v[96:97]
  v_pk_add_f32 v[34:35], v[34:35], v[98:99]
L_join_267:
  s_cmp_eq_u32 s27, 33
  v_lshrrev_b32 v18, 1, v4
  v_pk_mul_f32 v[32:33], v[32:33], v[20:21] op_sel_hi:[1,0]
  v_pk_mul_f32 v[34:35], v[34:35], v[20:21] op_sel_hi:[1,0]
  v_cvt_pk_f16_f32 v32, v32, v33
  v_cvt_pk_f16_f32 v33, v34, v35
  v_min_u32 v32, -2, v32
  v_min_u32 v33, -2, v33
  v_and_b32 v17, -2, v17
  s_cbranch_scc0 L_ls_268
  buffer_store_dwordx2 v[32:33], v18, s[16:19], s38 offen
  s_mov_b64 exec, 1
  buffer_store_dwordx2 v[16:17], v22, s[16:19], s38 offen
  s_mov_b64 exec, -1
L_nl_265:
  s_waitcnt lgkmcnt(0)
  s_add_u32 s49, s49, 1
  s_add_u32 s46, s56, 8192
  s_barrier
  ds_read_b128 a[64:67], v3 offset:17408
  ds_read_b128 a[72:75], v3 offset:18432
  ds_read_b128 a[80:83], v3 offset:19456
  ds_read_b128 a[88:91], v3 offset:20480
  ds_read_b128 a[96:99], v3 offset:21504
  ds_read_b128 a[104:107], v3 offset:22528
  ds_read_b128 a[112:115], v3 offset:23552
  ds_read_b128 a[120:123], v3 offset:24576
  ds_read_b128 a[68:71], v3 offset:25600
  ds_read_b128 a[76:79], v3 offset:26624
  ds_read_b128 a[84:87], v3 offset:27648
  ds_read_b128 a[92:95], v3 offset:28672
  ds_read_b128 a[100:103], v3 offset:29696
  ds_read_b128 a[108:111], v3 offset:30720
  ds_read_b128 a[116:119], v3 offset:31744
  ds_read_b128 a[124:127], v3 offset:32768
  v_mov_b64 v[32:33], 0
  v_mov_b64 v[34:35], 0
  v_mov_b64 v[36:37], 0
  v_mov_b64 v[38:39], 0
  v_mov_b64 v[40:41], 0
  v_mov_b64 v[42:43], 0
  v_mov_b64 v[44:45], 0
  v_mov_b64 v[46:47], 0
  v_mov_b64 v[96:97], 0
  v_mov_b64 v[98:99], 0
  v_mov_b64 v[100:101], 0
  v_mov_b64 v[102:103], 0
  v_mov_b64 v[104:105], 0
  v_mov_b64 v[106:107], 0
  v_mov_b64 v[108:109], 0
  v_mov_b64 v[110:111], 0
  v_mov_b64 v[112:113], 0
  v_mov_b64 v[114:115], 0
  v_mov_b64 v[116:117], 0
  v_mov_b64 v[118:119], 0
  v_mov_b64 v[120:121], 0
  v_mov_b64 v[122:123], 0
  v_mov_b64 v[124:125], 0
  v_mov_b64 v[126:127], 0
  v_mov_b64 v[128:129], 0
  v_mov_b64 v[130:131], 0
  v_mov_b64 v[132:133], 0
  v_mov_b64 v[134:135], 0
  v_cmp_gt_u32 s[40:41], s23, v15
  s_mov_b32 s42, 0x53800000
  v_mov_b32 v23, 0xff800000
  v_mov_b32 v16, 0
  s_mov_b32 s43, 0x2b800000
  s_mov_b32 s42, 0x28000000
L_Fpoll:
  s_sub_u32 s52, s52, 1
  s_cbranch_scc1 L_bail
  buffer_load_dwordx4 v[24:27], v5, s[16:19], s46 offen sc1
  buffer_load_dwordx4 v[28:31], v5, s[16:19], s46 offen offset:256 sc1
  s_waitcnt vmcnt(0) lgkmcnt(0)
  v_max3_u32 v18, v24, v25, v26
  v_max3_u32 v18, v18, v27, v28
  v_max3_u32 v18, v18, v29, v30
  v_max3_u32 v18, v18, v31, v31
  v_cmp_eq_u32 vcc, -1, v18
  s_cbranch_vccnz L_Fpoll
  v_smfmac_f32_16x16x64_bf16 v[96:99], v[24:27], v[160:167], v6
  v_smfmac_f32_16x16x64_bf16 v[96:99], v[28:31], v[168:175], v6
  v_smfmac_f32_16x16x64_bf16 v[100:103], v[24:27], v[176:183], v6
  v_smfmac_f32_16x16x64_bf16 v[100:103], v[28:31], v[184:191], v6
  v_smfmac_f32_16x16x64_bf16 v[104:107], v[24:27], v[192:199], v6
  s_nop 5
  v_add_f32 v149, v97, v99
  v_add_f32 v148, v96, v98
  v_smfmac_f32_16x16x64_bf16 v[104:107], v[28:31], v[200:207], v6
  s_nop 0
  v_add_f32_dpp v12, v149, v148 quad_perm:[1,1,3,3] row_mask:0x1 bank_mask:0xf
  v_smfmac_f32_16x16x64_bf16 v[108:111], v[24:27], v[208:215], v6
  v_add_f32 v151, v101, v103
  v_add_f32 v150, v100, v102
  v_smfmac_f32_16x16x64_bf16 v[108:111], v[28:31], v[216:223], v6
  s_nop 0
  v_add_f32_dpp v12, v151, v150 quad_perm:[1,1,3,3] row_mask:0x2 bank_mask:0xf
  v_smfmac_f32_16x16x64_bf16 v[112:115], v[24:27], v[224:231], v6
  v_add_f32 v149, v105, v107
  v_add_f32 v148, v104, v106
  v_smfmac_f32_16x16x64_bf16 v[112:115], v[28:31], v[232:239], v6
  s_nop 0
  v_add_f32_dpp v12, v149, v148 quad_perm:[1,1,3,3] row_mask:0x4 bank_mask:0xf
  v_smfmac_f32_16x16x64_bf16 v[116:119], v[24:27], v[240:247], v6
  v_add_f32 v151, v109, v111
  v_add_f32 v150, v108, v110
  v_smfmac_f32_16x16x64_bf16 v[116:119], v[28:31], v[248:255], v6
  s_nop 0
  v_add_f32_dpp v12, v151, v150 quad_perm:[1,1,3,3] row_mask:0x8 bank_mask:0xf
  v_fma_f32 v12, v12, s51, -v16
  v_smfmac_f32_16x16x64_bf16 v[120:123], v[24:27], a[128:135], v6
  v_add_f32 v149, v113, v115
  v_add_f32 v148, v112, v114
  v_exp_f32 v12, v12
  v_smfmac_f32_16x16x64_bf16 v[120:123], v[28:31], a[136:143], v6
  v_add_f32_dpp v13, v149, v148 quad_perm:[1,1,3,3] row_mask:0x1 bank_mask:0xf
  v_mov_b32_dpp v18, v12 quad_perm:[0,0,0,0] row_mask:0xf bank_mask:0xf
  v_mov_b32_dpp v19, v12 quad_perm:[2,2,2,2] row_mask:0xf bank_mask:0xf
  v_smfmac_f32_16x16x64_bf16 v[124:127], v[24:27], a[144:151], v6
  v_add_f32 v151, v117, v119
  v_add_f32 v150, v116, v118
  v_cvt_pk_bf16_f32 v20, v18, v19
  v_smfmac_f32_16x16x64_bf16 v[124:127], v[28:31], a[152:159], v6
  v_add_f32_dpp v13, v151, v150 quad_perm:[1,1,3,3] row_mask:0x2 bank_mask:0xf
  v_and_b32 v136, v20, v8
  v_and_b32 v138, v20, v10
  v_smfmac_f32_16x16x64_bf16 v[128:131], v[24:27], a[160:167], v6
  v_add_f32 v149, v121, v123
  v_add_f32 v148, v120, v122
  v_and_b32_dpp v137, v20, v9 row_shr:4 row_mask:0xf bank_mask:0xf bound_ctrl:0
  v_and_b32_dpp v139, v20, v11 row_shr:4 row_mask:0xf bank_mask:0xf bound_ctrl:0
  v_smfmac_f32_16x16x64_bf16 v[128:131], v[28:31], a[168:175], v6
  v_add_f32_dpp v13, v149, v148 quad_perm:[1,1,3,3] row_mask:0x4 bank_mask:0xf
  v_and_b32 v141, v20, v9
  v_and_b32 v143, v20, v11
  v_smfmac_f32_16x16x64_bf16 v[132:135], v[24:27], a[176:183], v6
  v_add_f32 v151, v125, v127
  v_add_f32 v150, v124, v126
  v_and_b32_dpp v140, v20, v8 row_shl:4 row_mask:0xf bank_mask:0xf bound_ctrl:0
  v_smfmac_f32_16x16x64_bf16 v[132:135], v[28:31], a[184:191], v6
  v_add_f32_dpp v13, v151, v150 quad_perm:[1,1,3,3] row_mask:0x8 bank_mask:0xf
  v_and_b32_dpp v142, v20, v10 row_shl:4 row_mask:0xf bank_mask:0xf bound_ctrl:0
  v_fma_f32 v13, v13, s51, -v16
  v_smfmac_f32_16x16x64_bf16 v[32:35], v[136:139], a[192:199], v7
  v_add_f32 v149, v129, v131
  v_add_f32 v148, v128, v130
  v_exp_f32 v13, v13
  v_smfmac_f32_16x16x64_bf16 v[36:39], v[136:139], a[200:207], v7
  v_add_f32_dpp v14, v149, v148 quad_perm:[1,1,3,3] row_mask:0x1 bank_mask:0xf
  v_mov_b32_dpp v18, v13 quad_perm:[0,0,0,0] row_mask:0xf bank_mask:0xf
  v_mov_b32_dpp v19, v13 quad_perm:[2,2,2,2] row_mask:0xf bank_mask:0xf
  v_smfmac_f32_16x16x64_bf16 v[40:43], v[136:139], a[208:215], v7
  v_add_f32 v151, v133, v135
  v_add_f32 v150, v132, v134
  v_cvt_pk_bf16_f32 v21, v18, v19
  v_smfmac_f32_16x16x64_bf16 v[44:47], v[136:139], a[216:223], v7
  v_add_f32_dpp v14, v151, v150 quad_perm:[1,1,3,3] row_mask:0x2 bank_mask:0xf
  v_cndmask_b32 v14, v23, v14, s[40:41]
  v_fma_f32 v14, v14, s51, -v16
  v_smfmac_f32_16x16x64_bf16 v[32:35], v[140:143], a[224:231], v7
  v_exp_f32 v14, v14
  v_and_b32 v136, v21, v8
  v_and_b32 v138, v21, v10
  v_smfmac_f32_16x16x64_bf16 v[36:39], v[140:143], a[232:239], v7
  v_and_b32_dpp v137, v21, v9 row_shr:4 row_mask:0xf bank_mask:0xf bound_ctrl:0
  v_and_b32_dpp v139, v21, v11 row_shr:4 row_mask:0xf bank_mask:0xf bound_ctrl:0
  v_mov_b32_dpp v18, v14 quad_perm:[0,0,0,0] row_mask:0xf bank_mask:0xf
  v_smfmac_f32_16x16x64_bf16 v[40:43], v[140:143], a[240:247], v7
  v_mov_b32_dpp v19, v14 quad_perm:[2,2,2,2] row_mask:0xf bank_mask:0xf
  v_cvt_pk_bf16_f32 v22, v18, v19
  v_add_f32 v17, v12, v13
  v_smfmac_f32_16x16x64_bf16 v[44:47], v[140:143], a[248:255], v7
  v_mov_b32_dpp v0, v22 row_shl:4 row_mask:0xf bank_mask:0xf
  v_add_f32 v17, v14, v17
  v_smfmac_f32_16x16x64_bf16 v[32:35], v[136:139], a[64:71], v7
  v_permlane32_swap_b32 v22, v0
  v_and_b32 v141, v21, v9
  v_and_b32 v143, v21, v11
  v_smfmac_f32_16x16x64_bf16 v[36:39], v[136:139], a[72:79], v7
  v_and_b32_dpp v140, v21, v8 row_shl:4 row_mask:0xf bank_mask:0xf bound_ctrl:0
  v_and_b32_dpp v142, v21, v10 row_shl:4 row_mask:0xf bank_mask:0xf bound_ctrl:0
  v_add_f32_dpp v17, v17, v17 quad_perm:[2,3,0,1] row_mask:0xf bank_mask:0xf
  v_smfmac_f32_16x16x64_bf16 v[40:43], v[136:139], a[80:87], v7
  v_and_b32 v144, v22, v8
  v_and_b32 v146, v22, v10
  v_add_f32_dpp v17, v17, v17 row_ror:4 row_mask:0xf bank_mask:0xf
  v_smfmac_f32_16x16x64_bf16 v[44:47], v[136:139], a[88:95], v7
  v_and_b32_dpp v145, v22, v9 row_shr:4 row_mask:0xf bank_mask:0xf bound_ctrl:0
  v_and_b32_dpp v147, v22, v11 row_shr:4 row_mask:0xf bank_mask:0xf bound_ctrl:0
  v_add_f32_dpp v17, v17, v17 row_ror:8 row_mask:0xf bank_mask:0xf
  v_smfmac_f32_16x16x64_bf16 v[32:35], v[140:143], a[96:103], v7
  v_mov_b32 v23, v17
  v_add_u32 v18, s54, v4
  v_mov_b32 v19, s55
  v_smfmac_f32_16x16x64_bf16 v[32:35], v[144:147], v[64:71], v7
  v_permlane16_swap_b32 v17, v23
  v_add_f32 v17, v17, v23
  v_mov_b32 v23, v17
  v_smfmac_f32_16x16x64_bf16 v[36:39], v[140:143], a[104:111], v7
  s_nop 0
  v_permlane32_swap_b32 v17, v23
  v_add_f32 v17, v17, v23
  v_smfmac_f32_16x16x64_bf16 v[36:39], v[144:147], v[72:79], v7
  v_subrev_u32 v23, s43, v17
  v_cmp_lt_u32 vcc, s42, v23
  v_mov_b32 v20, 1
  v_mov_b32 v21, 0
  v_smfmac_f32_16x16x64_bf16 v[40:43], v[140:143], a[112:119], v7
  s_bitcmp1_b32 vcc_lo, 0
  s_cbranch_scc1 L_Fslow
  v_mov_b32 v22, s48
  v_smfmac_f32_16x16x64_bf16 v[40:43], v[144:147], v[80:87], v7
  v_permlane32_swap_b32 v32, v36
  v_permlane32_swap_b32 v33, v37
  v_permlane32_swap_b32 v34, v38
  v_smfmac_f32_16x16x64_bf16 v[44:47], v[140:143], a[120:127], v7
  v_permlane32_swap_b32 v35, v39
  v_add_f32_dpp v32, v36, v32 row_ror:8 row_mask:0xf bank_mask:0x3
  v_add_f32_dpp v33, v37, v33 row_ror:8 row_mask:0xf bank_mask:0x3
  v_smfmac_f32_16x16x64_bf16 v[44:47], v[144:147], v[88:95], v7
  v_add_f32_dpp v34, v38, v34 row_ror:8 row_mask:0xf bank_mask:0x3
  v_add_f32_dpp v35, v39, v35 row_ror:8 row_mask:0xf bank_mask:0x3
  s_nop 6
  v_permlane32_swap_b32 v40, v44
  v_permlane32_swap_b32 v41, v45
  v_permlane32_swap_b32 v42, v46
  v_permlane32_swap_b32 v43, v47
  v_add_f32_dpp v32, v40, v44 row_ror:8 row_mask:0xf bank_mask:0xc
  v_add_f32_dpp v33, v41, v45 row_ror:8 row_mask:0xf bank_mask:0xc
  v_add_f32_dpp v34, v42, v46 row_ror:8 row_mask:0xf bank_mask:0xc
  v_add_f32_dpp v35, v43, v47 row_ror:8 row_mask:0xf bank_mask:0xc
L_Fepi:
  ds_write_b128 v18, v[32:35] offset:4096
  s_mov_b64 exec, 1
  ds_write_b64 v19, v[16:17] offset:10272
  ds_add_rtn_u32 v20, v21, v20 offset:10308
  s_mov_b64 exec, -1
  ds_read_b128 v[24:27], v21 offset:10272
  ds_read_b128 v[28:31], v21 offset:10288
  ds_read_b128 v[48:51], v4 offset:4096
  ds_read_b128 v[52:55], v4 offset:5120
  ds_read_b128 v[56:59], v4 offset:6144
  ds_read_b128 v[60:63], v4 offset:7168
  s_add_u32 s38, s47, 1572864
  s_waitcnt lgkmcnt(6)
  v_readfirstlane_b32 s39, v20
  s_and_b32 s39, s39, 3
  s_cmp_eq_u32 s39, 3
  s_cselect_b32 s58, 1, 0
  s_cbranch_scc0 L_nl_269
  s_waitcnt lgkmcnt(4)
  v_or3_b32 v16, v24, v26, v28
  v_add_f32 v17, v25, v27
  v_or_b32 v16, v16, v30
  v_add_f32 v23, v29, v31
  v_cmp_eq_u32 vcc, 0, v16
  v_add_f32 v17, v17, v23
  s_cbranch_vccz L_gen_270
  v_rcp_f32 v20, v17
  s_waitcnt lgkmcnt(2)
  v_pk_add_f32 v[32:33], v[48:49], v[52:53]
  v_pk_add_f32 v[34:35], v[50:51], v[54:55]
  s_waitcnt lgkmcnt(0)
  v_pk_add_f32 v[48:49], v[56:57], v[60:61]
  v_pk_add_f32 v[50:51], v[58:59], v[62:63]
  v_pk_add_f32 v[32:33], v[32:33], v[48:49]
  v_pk_add_f32 v[34:35], v[34:35], v[50:51]
L_join_271:
  s_cmp_eq_u32 s27, 33
  v_lshrrev_b32 v18, 1, v4
  v_pk_mul_f32 v[32:33], v[32:33], v[20:21] op_sel_hi:[1,0]
  v_pk_mul_f32 v[34:35], v[34:35], v[20:21] op_sel_hi:[1,0]
  v_cvt_pk_f16_f32 v32, v32, v33
  v_cvt_pk_f16_f32 v33, v34, v35
  v_min_u32 v32, -2, v32
  v_min_u32 v33, -2, v33
  v_and_b32 v17, -2, v17
  s_cbranch_scc0 L_ls_272
  buffer_store_dwordx2 v[32:33], v18, s[16:19], s38 offen
  s_mov_b64 exec, 1
  buffer_store_dwordx2 v[16:17], v22, s[16:19], s38 offen
  s_mov_b64 exec, -1
L_nl_269:
  s_waitcnt lgkmcnt(0)
  s_branch L_fin
L_Fslow:
  s_nop 8
  v_mov_b64 v[32:33], 0
  v_mov_b64 v[34:35], 0
  v_mov_b64 v[36:37], 0
  v_mov_b64 v[38:39], 0
  v_mov_b64 v[40:41], 0
  v_mov_b64 v[42:43], 0
  v_mov_b64 v[44:45], 0
  v_mov_b64 v[46:47], 0
  v_smfmac_f32_16x16x64_bf16 v[32:35], v[24:27], v[160:167], v6
  v_smfmac_f32_16x16x64_bf16 v[32:35], v[28:31], v[168:175], v6
  v_smfmac_f32_16x16x64_bf16 v[36:39], v[24:27], v[176:183], v6
  v_smfmac_f32_16x16x64_bf16 v[36:39], v[28:31], v[184:191], v6
  v_smfmac_f32_16x16x64_bf16 v[40:43], v[24:27], v[192:199], v6
  v_smfmac_f32_16x16x64_bf16 v[40:43], v[28:31], v[200:207], v6
  v_smfmac_f32_16x16x64_bf16 v[44:47], v[24:27], v[208:215], v6
  s_nop 3
  v_add_f32 v19, v33, v35
  v_add_f32 v18, v32, v34
  v_smfmac_f32_16x16x64_bf16 v[44:47], v[28:31], v[216:223], v6
  s_nop 0
  v_add_f32_dpp v12, v19, v18 quad_perm:[1,1,3,3] row_mask:0x1 bank_mask:0xf
  v_smfmac_f32_16x16x64_bf16 v[32:35], v[24:27], v[224:231], v6
  v_add_f32 v21, v37, v39
  v_add_f32 v20, v36, v38
  v_smfmac_f32_16x16x64_bf16 v[32:35], v[28:31], v[232:239], v6
  s_nop 0
  v_add_f32_dpp v12, v21, v20 quad_perm:[1,1,3,3] row_mask:0x2 bank_mask:0xf
  v_smfmac_f32_16x16x64_bf16 v[36:39], v[24:27], v[240:247], v6
  v_add_f32 v19, v41, v43
  v_add_f32 v18, v40, v42
  v_smfmac_f32_16x16x64_bf16 v[36:39], v[28:31], v[248:255], v6
  s_nop 0
  v_add_f32_dpp v12, v19, v18 quad_perm:[1,1,3,3] row_mask:0x4 bank_mask:0xf
  v_smfmac_f32_16x16x64_bf16 v[40:43], v[24:27], a[128:135], v6
  v_add_f32 v21, v45, v47
  v_add_f32 v20, v44, v46
  v_smfmac_f32_16x16x64_bf16 v[40:43], v[28:31], a[136:143], v6
  s_nop 0
  v_add_f32_dpp v12, v21, v20 quad_perm:[1,1,3,3] row_mask:0x8 bank_mask:0xf
  v_smfmac_f32_16x16x64_bf16 v[44:47], v[24:27], a[144:151], v6
  v_add_f32 v19, v33, v35
  v_add_f32 v18, v32, v34
  v_smfmac_f32_16x16x64_bf16 v[44:47], v[28:31], a[152:159], v6
  s_nop 0
  v_add_f32_dpp v13, v19, v18 quad_perm:[1,1,3,3] row_mask:0x1 bank_mask:0xf
  v_smfmac_f32_16x16x64_bf16 v[32:35], v[24:27], a[160:167], v6
  v_add_f32 v21, v37, v39
  v_add_f32 v20, v36, v38
  v_smfmac_f32_16x16x64_bf16 v[32:35], v[28:31], a[168:175], v6
  s_nop 0
  v_add_f32_dpp v13, v21, v20 quad_perm:[1,1,3,3] row_mask:0x2 bank_mask:0xf
  v_smfmac_f32_16x16x64_bf16 v[36:39], v[24:27], a[176:183], v6
  v_add_f32 v19, v41, v43
  v_add_f32 v18, v40, v42
  v_smfmac_f32_16x16x64_bf16 v[36:39], v[28:31], a[184:191], v6
  s_nop 0
  v_add_f32_dpp v13, v19, v18 quad_perm:[1,1,3,3] row_mask:0x4 bank_mask:0xf
  v_cmp_gt_u32 vcc, s23, v15
  v_mov_b32 v23, 0xff800000
  v_add_f32 v21, v45, v47
  v_add_f32 v20, v44, v46
  v_mov_b32 v40, 0
  s_nop 0
  v_add_f32_dpp v13, v21, v20 quad_perm:[1,1,3,3] row_mask:0x8 bank_mask:0xf
  v_mov_b32 v41, 0
  v_mov_b32 v42, 0
  v_mov_b32 v43, 0
  v_add_f32 v19, v33, v35
  v_add_f32 v18, v32, v34
  v_mov_b32 v44, 0
  s_nop 0
  v_add_f32_dpp v14, v19, v18 quad_perm:[1,1,3,3] row_mask:0x1 bank_mask:0xf
  v_mov_b32 v45, 0
  v_mov_b32 v46, 0
  v_add_f32 v21, v37, v39
  v_add_f32 v20, v36, v38
  v_mov_b32 v47, 0
  s_nop 0
  v_add_f32_dpp v14, v21, v20 quad_perm:[1,1,3,3] row_mask:0x2 bank_mask:0xf
  v_sub_f32 v14, v14, v13
  v_sub_f32 v13, v13, v12
  v_cndmask_b32 v14, v23, v14, vcc
  v_max3_f32 v16, v12, v13, v14
  v_mov_b32 v32, 0
  v_mov_b32 v33, 0
  v_max_f32_dpp v16, v16, v16 quad_perm:[2,3,0,1] row_mask:0xf bank_mask:0xf
  v_mov_b32 v34, 0
  v_mov_b32 v35, 0
  v_max_f32_dpp v16, v16, v16 row_ror:4 row_mask:0xf bank_mask:0xf
  v_mov_b32 v36, 0
  v_mov_b32 v37, 0
  v_max_f32_dpp v18, v16, v16 row_ror:8 row_mask:0xf bank_mask:0xf
  v_max_f32_dpp v16, v16, v16 row_ror:8 row_mask:0xf bank_mask:0xf
  v_mov_b32 v38, 0
  v_mov_b32 v39, 0
  v_permlane16_swap_b32 v16, v18
  v_max_f32 v19, v16, v18
  v_max_f32 v16, v16, v18
  s_nop 1
  v_permlane32_swap_b32 v16, v19
  v_max_f32 v16, v16, v19
  v_mul_f32 v16, s51, v16
  v_cmp_lt_f32 vcc, s50, abs(v16)
  s_nop 1
  v_cndmask_b32 v16, 0, v16, vcc
  v_fma_f32 v12, v12, s51, -v16
  v_fma_f32 v14, v14, s51, -v16
  v_fma_f32 v13, v13, s51, -v16
  v_exp_f32 v12, v12
  v_exp_f32 v14, v14
  v_exp_f32 v13, v13
  v_mov_b32_dpp v18, v12 quad_perm:[0,0,0,0] row_mask:0xf bank_mask:0xf
  v_mov_b32_dpp v19, v12 quad_perm:[2,2,2,2] row_mask:0xf bank_mask:0xf
  v_cvt_pk_bf16_f32 v20, v18, v19
  v_and_b32 v24, v20, v8
  v_and_b32 v26, v20, v10
  v_and_b32_dpp v25, v20, v9 row_shr:4 row_mask:0xf bank_mask:0xf bound_ctrl:0
  v_and_b32_dpp v27, v20, v11 row_shr:4 row_mask:0xf bank_mask:0xf bound_ctrl:0
  s_nop 1
  v_smfmac_f32_16x16x64_bf16 v[32:35], v[24:27], a[192:199], v7
  v_mov_b32_dpp v18, v14 quad_perm:[0,0,0,0] row_mask:0xf bank_mask:0xf
  v_mov_b32_dpp v19, v14 quad_perm:[2,2,2,2] row_mask:0xf bank_mask:0xf
  v_cvt_pk_bf16_f32 v22, v18, v19
  v_smfmac_f32_16x16x64_bf16 v[36:39], v[24:27], a[200:207], v7
  s_nop 0
  v_mov_b32_dpp v0, v22 row_shl:4 row_mask:0xf bank_mask:0xf
  s_nop 1
  v_permlane32_swap_b32 v22, v0
  v_smfmac_f32_16x16x64_bf16 v[40:43], v[24:27], a[208:215], v7
  v_and_b32 v28, v22, v8
  v_and_b32 v30, v22, v10
  v_smfmac_f32_16x16x64_bf16 v[44:47], v[24:27], a[216:223], v7
  v_and_b32_dpp v29, v22, v9 row_shr:4 row_mask:0xf bank_mask:0xf bound_ctrl:0
  v_and_b32_dpp v31, v22, v11 row_shr:4 row_mask:0xf bank_mask:0xf bound_ctrl:0
  s_nop 1
  v_smfmac_f32_16x16x64_bf16 v[32:35], v[28:31], v[64:71], v7
  v_and_b32 v25, v20, v9
  v_add_f32 v17, v12, v13
  v_smfmac_f32_16x16x64_bf16 v[36:39], v[28:31], v[72:79], v7
  v_and_b32 v27, v20, v11
  v_add_f32 v17, v14, v17
  v_smfmac_f32_16x16x64_bf16 v[40:43], v[28:31], v[80:87], v7
  v_and_b32_dpp v24, v20, v8 row_shl:4 row_mask:0xf bank_mask:0xf bound_ctrl:0
  v_add_f32_dpp v17, v17, v17 quad_perm:[2,3,0,1] row_mask:0xf bank_mask:0xf
  v_smfmac_f32_16x16x64_bf16 v[44:47], v[28:31], v[88:95], v7
  v_and_b32_dpp v26, v20, v10 row_shl:4 row_mask:0xf bank_mask:0xf bound_ctrl:0
  v_add_f32_dpp v17, v17, v17 row_ror:4 row_mask:0xf bank_mask:0xf
  s_nop 0
  v_smfmac_f32_16x16x64_bf16 v[32:35], v[24:27], a[224:231], v7
  v_mov_b32_dpp v18, v13 quad_perm:[0,0,0,0] row_mask:0xf bank_mask:0xf
  v_mov_b32_dpp v19, v13 quad_perm:[2,2,2,2] row_mask:0xf bank_mask:0xf
  v_smfmac_f32_16x16x64_bf16 v[36:39], v[24:27], a[232:239], v7
  v_cvt_pk_bf16_f32 v21, v18, v19
  v_and_b32 v28, v21, v8
  v_smfmac_f32_16x16x64_bf16 v[40:43], v[24:27], a[240:247], v7
  v_and_b32 v30, v21, v10
  v_and_b32_dpp v29, v21, v9 row_shr:4 row_mask:0xf bank_mask:0xf bound_ctrl:0
  v_smfmac_f32_16x16x64_bf16 v[44:47], v[24:27], a[248:255], v7
  v_and_b32_dpp v31, v21, v11 row_shr:4 row_mask:0xf bank_mask:0xf bound_ctrl:0
  v_add_f32_dpp v17, v17, v17 row_ror:8 row_mask:0xf bank_mask:0xf
  s_nop 0
  v_smfmac_f32_16x16x64_bf16 v[32:35], v[28:31], a[64:71], v7
  v_and_b32 v25, v21, v9
  v_mov_b32 v23, v17
  v_smfmac_f32_16x16x64_bf16 v[36:39], v[28:31], a[72:79], v7
  v_and_b32 v27, v21, v11
  v_permlane16_swap_b32 v17, v23
  v_smfmac_f32_16x16x64_bf16 v[40:43], v[28:31], a[80:87], v7
  v_and_b32_dpp v24, v21, v8 row_shl:4 row_mask:0xf bank_mask:0xf bound_ctrl:0
  v_add_f32 v17, v17, v23
  v_smfmac_f32_16x16x64_bf16 v[44:47], v[28:31], a[88:95], v7
  v_and_b32_dpp v26, v21, v10 row_shl:4 row_mask:0xf bank_mask:0xf bound_ctrl:0
  v_mov_b32 v23, v17
  s_nop 0
  v_smfmac_f32_16x16x64_bf16 v[32:35], v[24:27], a[96:103], v7
  v_permlane32_swap_b32 v17, v23
  v_add_f32 v17, v17, v23
  v_smfmac_f32_16x16x64_bf16 v[36:39], v[24:27], a[104:111], v7
  v_add_u32 v18, s54, v4
  v_mov_b32 v19, s55
  v_smfmac_f32_16x16x64_bf16 v[40:43], v[24:27], a[112:119], v7
  v_mov_b32 v20, 1
  v_mov_b32 v21, 0
  v_smfmac_f32_16x16x64_bf16 v[44:47], v[24:27], a[120:127], v7
  v_mov_b32 v22, s48
  s_nop 1
  v_permlane32_swap_b32 v32, v36
  v_permlane32_swap_b32 v33, v37
  v_permlane32_swap_b32 v34, v38
  v_permlane32_swap_b32 v35, v39
  v_add_f32_dpp v32, v36, v32 row_ror:8 row_mask:0xf bank_mask:0x3
  v_add_f32_dpp v33, v37, v33 row_ror:8 row_mask:0xf bank_mask:0x3
  v_add_f32_dpp v34, v38, v34 row_ror:8 row_mask:0xf bank_mask:0x3
  v_add_f32_dpp v35, v39, v35 row_ror:8 row_mask:0xf bank_mask:0x3
  v_permlane32_swap_b32 v40, v44
  v_permlane32_swap_b32 v41, v45
  v_permlane32_swap_b32 v42, v46
  v_permlane32_swap_b32 v43, v47
  v_add_f32_dpp v32, v40, v44 row_ror:8 row_mask:0xf bank_mask:0xc
  v_add_f32_dpp v33, v41, v45 row_ror:8 row_mask:0xf bank_mask:0xc
  v_add_f32_dpp v34, v42, v46 row_ror:8 row_mask:0xf bank_mask:0xc
  v_add_f32_dpp v35, v43, v47 row_ror:8 row_mask:0xf bank_mask:0xc
  s_branch L_Fepi
L_first:
  s_lshl_b32 s38, s3, 9
  v_add_u32 v18, s38, v5
  ds_write_b128 v18, v[24:27] offset:8192
  ds_write_b128 v18, v[28:31] offset:8448
  s_add_u32 m0, s45, 33792
  s_nop 0
  buffer_load_dwordx4 v2, s[92:95], s44 offen offset:1024 nt lds
  s_add_u32 m0, s45, 35712
  s_nop 0
  buffer_load_dwordx4 v2, s[92:95], s44 offen offset:128 nt lds
  s_add_u32 m0, s45, 35712
  s_nop 0
  buffer_load_dwordx4 v2, s[92:95], s44 offen offset:1152 nt lds
  buffer_load_dwordx4 v[176:179], v2, s[92:95], s44 offen offset:256 nt
  buffer_load_dwordx4 v[180:183], v2, s[92:95], s44 offen offset:1280 nt
  buffer_load_dwordx4 v[184:187], v2, s[92:95], s44 offen offset:384 nt
  buffer_load_dwordx4 v[188:191], v2, s[92:95], s44 offen offset:1408 nt
  s_cmp_lg_u32 s58, 0
  s_cbranch_scc1 L_eq_273
  s_waitcnt vmcnt(11)
L_eq_273:
  s_waitcnt lgkmcnt(0)
  s_barrier
  v_add_u32 v18, s53, v5
  ds_read_b128 v[24:27], v18
  ds_read_b128 v[28:31], v18 offset:256
  v_mov_b64 v[32:33], 0
  v_mov_b64 v[34:35], 0
  v_mov_b64 v[36:37], 0
  v_mov_b64 v[38:39], 0
  v_mov_b64 v[40:41], 0
  v_mov_b64 v[42:43], 0
  v_mov_b64 v[44:45], 0
  v_mov_b64 v[46:47], 0
  s_waitcnt lgkmcnt(0)
  v_smfmac_f32_16x16x64_bf16 v[32:35], v[24:27], v[64:71], v6
  v_smfmac_f32_16x16x64_bf16 v[32:35], v[28:31], v[72:79], v6
  v_smfmac_f32_16x16x64_bf16 v[36:39], v[24:27], v[80:87], v6
  v_smfmac_f32_16x16x64_bf16 v[36:39], v[28:31], v[88:95], v6
  s_add_u32 s40, s40, 0x2000000
  s_add_u32 s41, s41, 0x2000000
  s_add_u32 s42, s42, 0x2000000
  s_add_u32 s43, s43, 0x2000000
  s_add_u32 s44, s44, 0x2000000
  s_add_u32 s90, s90, 0x2000000
  s_min_u32 s90, s90, s10
  s_mov_b32 s94, s90
  buffer_load_dwordx4 a[128:131], v1, s[8:11], s43 offen offset:0 nt
  buffer_load_dwordx4 a[132:135], v1, s[8:11], s43 offen offset:128 nt
  v_smfmac_f32_16x16x64_bf16 v[40:43], v[24:27], v[96:103], v6
  v_smfmac_f32_16x16x64_bf16 v[40:43], v[28:31], v[104:111], v6
  v_smfmac_f32_16x16x64_bf16 v[44:47], v[24:27], v[112:119], v6
  v_add_f32 v19, v33, v35
  v_add_f32 v18, v32, v34
  v_smfmac_f32_16x16x64_bf16 v[44:47], v[28:31], v[120:127], v6
  s_nop 0
  v_add_f32_dpp v12, v19, v18 quad_perm:[1,1,3,3] row_mask:0x1 bank_mask:0xf
  v_smfmac_f32_16x16x64_bf16 v[32:35], v[24:27], v[128:135], v6
  v_add_f32 v21, v37, v39
  v_add_f32 v20, v36, v38
  v_smfmac_f32_16x16x64_bf16 v[32:35], v[28:31], v[136:143], v6
  s_nop 0
  v_add_f32_dpp v12, v21, v20 quad_perm:[1,1,3,3] row_mask:0x2 bank_mask:0xf
  buffer_load_dwordx4 a[136:139], v1, s[8:11], s43 offen offset:256 nt
  v_smfmac_f32_16x16x64_bf16 v[36:39], v[24:27], v[144:151], v6
  v_add_f32 v19, v41, v43
  v_add_f32 v18, v40, v42
  v_smfmac_f32_16x16x64_bf16 v[36:39], v[28:31], v[152:159], v6
  s_nop 0
  v_add_f32_dpp v12, v19, v18 quad_perm:[1,1,3,3] row_mask:0x4 bank_mask:0xf
  v_smfmac_f32_16x16x64_bf16 v[40:43], v[24:27], a[0:7], v6
  v_add_f32 v21, v45, v47
  v_add_f32 v20, v44, v46
  v_smfmac_f32_16x16x64_bf16 v[40:43], v[28:31], a[8:15], v6
  s_nop 0
  v_add_f32_dpp v12, v21, v20 quad_perm:[1,1,3,3] row_mask:0x8 bank_mask:0xf
  v_smfmac_f32_16x16x64_bf16 v[44:47], v[24:27], a[16:23], v6
  v_add_f32 v19, v33, v35
  v_add_f32 v18, v32, v34
  v_smfmac_f32_16x16x64_bf16 v[44:47], v[28:31], a[24:31], v6
  s_nop 0
  v_add_f32_dpp v13, v19, v18 quad_perm:[1,1,3,3] row_mask:0x1 bank_mask:0xf
  buffer_load_dwordx4 a[140:143], v1, s[8:11], s43 offen offset:384 nt
  v_smfmac_f32_16x16x64_bf16 v[32:35], v[24:27], a[32:39], v6
  v_add_f32 v21, v37, v39
  v_add_f32 v20, v36, v38
  v_smfmac_f32_16x16x64_bf16 v[32:35], v[28:31], a[40:47], v6
  s_nop 0
  v_add_f32_dpp v13, v21, v20 quad_perm:[1,1,3,3] row_mask:0x2 bank_mask:0xf
  v_smfmac_f32_16x16x64_bf16 v[36:39], v[24:27], a[48:55], v6
  v_add_f32 v19, v41, v43
  v_add_f32 v18, v40, v42
  v_smfmac_f32_16x16x64_bf16 v[36:39], v[28:31], a[56:63], v6
  s_nop 0
  v_add_f32_dpp v13, v19, v18 quad_perm:[1,1,3,3] row_mask:0x4 bank_mask:0xf
  v_cmp_gt_u32 vcc, s22, v15
  v_mov_b32 v23, 0xff800000
  v_add_f32 v21, v45, v47
  v_add_f32 v20, v44, v46
  s_nop 1
  v_add_f32_dpp v13, v21, v20 quad_perm:[1,1,3,3] row_mask:0x8 bank_mask:0xf
  v_add_f32 v19, v33, v35
  v_add_f32 v18, v32, v34
  s_nop 1
  v_add_f32_dpp v14, v19, v18 quad_perm:[1,1,3,3] row_mask:0x1 bank_mask:0xf
  v_add_f32 v21, v37, v39
  v_add_f32 v20, v36, v38
  s_nop 1
  v_add_f32_dpp v14, v21, v20 quad_perm:[1,1,3,3] row_mask:0x2 bank_mask:0xf
  v_sub_f32 v14, v14, v13
  v_sub_f32 v13, v13, v12
  v_cndmask_b32 v14, v23, v14, vcc
  v_max3_f32 v16, v12, v13, v14
  s_nop 1
  v_max_f32_dpp v16, v16, v16 quad_perm:[2,3,0,1] row_mask:0xf bank_mask:0xf
  s_nop 1
  v_max_f32_dpp v16, v16, v16 row_ror:4 row_mask:0xf bank_mask:0xf
  s_nop 1
  v_max_f32_dpp v18, v16, v16 row_ror:8 row_mask:0xf bank_mask:0xf
  v_max_f32_dpp v16, v16, v16 row_ror:8 row_mask:0xf bank_mask:0xf
  s_nop 1
  v_permlane16_swap_b32 v16, v18
  v_max_f32 v19, v16, v18
  v_max_f32 v16, v16, v18
  s_nop 1
  v_permlane32_swap_b32 v16, v19
  v_max_f32 v16, v16, v19
  v_mul_f32 v16, s51, v16
  v_cmp_lt_f32 vcc, s50, abs(v16)
  s_nop 1
  v_cndmask_b32 v16, 0, v16, vcc
  v_fma_f32 v12, v12, s51, -v16
  v_fma_f32 v14, v14, s51, -v16
  v_fma_f32 v13, v13, s51, -v16
  v_exp_f32 v12, v12
  v_exp_f32 v14, v14
  v_exp_f32 v13, v13
  buffer_load_dwordx4 a[144:147], v1, s[8:11], s43 offen offset:512 nt
  v_add_f32 v17, v12, v13
  v_mov_b32_dpp v18, v12 quad_perm:[0,0,0,0] row_mask:0xf bank_mask:0xf
  v_add_f32 v17, v14, v17
  v_mov_b32_dpp v19, v12 quad_perm:[2,2,2,2] row_mask:0xf bank_mask:0xf
  s_nop 0
  v_add_f32_dpp v17, v17, v17 quad_perm:[2,3,0,1] row_mask:0xf bank_mask:0xf
  v_cvt_pk_bf16_f32 v20, v18, v19
  s_nop 0
  v_add_f32_dpp v17, v17, v17 row_ror:4 row_mask:0xf bank_mask:0xf
  v_mov_b32_dpp v18, v14 quad_perm:[0,0,0,0] row_mask:0xf bank_mask:0xf
  s_nop 0
  v_add_f32_dpp v17, v17, v17 row_ror:8 row_mask:0xf bank_mask:0xf
  v_mov_b32_dpp v19, v14 quad_perm:[2,2,2,2] row_mask:0xf bank_mask:0xf
  v_mov_b32 v23, v17
  v_cvt_pk_bf16_f32 v22, v18, v19
  s_nop 0
  v_permlane16_swap_b32 v17, v23
  v_mov_b32_dpp v0, v22 row_shl:4 row_mask:0xf bank_mask:0xf
  v_add_f32 v17, v17, v23
  s_nop 0
  v_permlane32_swap_b32 v22, v0
  v_mov_b32 v23, v17
  v_mov_b32_dpp v18, v13 quad_perm:[0,0,0,0] row_mask:0xf bank_mask:0xf
  s_nop 0
  v_permlane32_swap_b32 v17, v23
  v_mov_b32_dpp v19, v13 quad_perm:[2,2,2,2] row_mask:0xf bank_mask:0xf
  v_add_f32 v17, v17, v23
  v_cvt_pk_bf16_f32 v21, v18, v19
  v_lshrrev_b32 v18, 6, v4
  v_lshl_add_u32 v18, v18, 4, s57
  v_mov_b32 v19, s55
  ds_write_b96 v18, v[20:22]
  s_mov_b64 exec, 1
  ds_write_b64 v19, v[16:17] offset:10240
  s_mov_b64 exec, -1
  buffer_load_dwordx4 a[148:151], v1, s[8:11], s43 offen offset:640 nt
  s_branch L_PV0
L_fin:
  s_branch L_end
L_st0:
  s_cmp_gt_u32 s59, 0
  s_cbranch_scc1 L_lv_274
  s_waitcnt vmcnt(6)
L_lv_274:
  buffer_load_dwordx4 a[68:71], v2, s[12:15], s41 offen offset:0 nt
  s_cmp_gt_u32 s59, 1
  s_cbranch_scc1 L_lv_276
  s_cmp_gt_u32 s59, 0
  s_cbranch_scc1 L_lv_275
  s_waitcnt vmcnt(6)
L_lv_275:
  s_waitcnt vmcnt(9)
L_lv_276:
  buffer_load_dwordx4 a[76:79], v2, s[12:15], s41 offen offset:128 nt
  s_cmp_gt_u32 s59, 1
  s_cbranch_scc1 L_lv_278
  s_cmp_gt_u32 s59, 0
  s_cbranch_scc1 L_lv_277
  s_waitcnt vmcnt(6)
L_lv_277:
  s_waitcnt vmcnt(9)
L_lv_278:
  buffer_load_dwordx4 a[84:87], v2, s[12:15], s41 offen offset:256 nt
  s_cmp_gt_u32 s59, 1
  s_cbranch_scc1 L_lv_280
  s_cmp_gt_u32 s59, 0
  s_cbranch_scc1 L_lv_279
  s_waitcnt vmcnt(5)
L_lv_279:
  s_waitcnt vmcnt(9)
L_lv_280:
  buffer_load_dwordx4 a[92:95], v2, s[12:15], s41 offen offset:384 nt
  s_branch L_st0r
L_E0:
  s_mov_b32 s58, 1
  s_add_u32 m0, s45, 9088
  s_nop 0
  buffer_load_dwordx4 v2, s[12:15], s43 offen offset:128 nt lds
  s_add_u32 m0, s45, 9984
  s_nop 0
  buffer_load_dwordx4 v2, s[12:15], s43 offen offset:256 nt lds
  s_add_u32 m0, s45, 10880
  s_nop 0
  buffer_load_dwordx4 v2, s[12:15], s43 offen offset:384 nt lds
  s_add_u32 m0, s45, 11264
  s_nop 0
  buffer_load_dwordx4 v2, s[12:15], s43 offen offset:1024 nt lds
  s_add_u32 s38, s35, 9
  v_mov_b32 v18, s38
  s_mov_b64 exec, 1
  buffer_store_dword v18, off, s[16:19], s25
  s_mov_b64 exec, -1
  s_add_u32 m0, s45, 12160
  s_nop 0
  buffer_load_dwordx4 v2, s[12:15], s43 offen offset:1152 nt lds
  s_add_u32 m0, s45, 13056
  s_nop 0
  buffer_load_dwordx4 v2, s[12:15], s43 offen offset:1280 nt lds
  s_add_u32 m0, s45, 13952
  s_waitcnt vmcnt(14)
  buffer_load_dwordx4 v2, s[12:15], s43 offen offset:1408 nt lds
  s_add_u32 m0, s45, 16384
  s_waitcnt vmcnt(14)
  buffer_load_dwordx4 v2, s[92:95], s44 offen offset:0 nt lds
  s_mov_b32 s59, 1
  s_branch L_Xok0
L_ls_125:
  buffer_store_dwordx2 v[32:33], v18, s[16:19], s38 offen sc1
  v_or_b32 v17, s4, v17
  s_mov_b64 exec, 1
  s_lshr_b32 s39, s4, 24
  s_add_u32 s38, s38, s39
  buffer_store_dwordx2 v[16:17], v22, s[16:19], s38 offen sc1
  s_mov_b64 exec, -1
  s_branch L_nl_122
L_gen_123:
  v_max3_f32 v16, v24, v26, v28
  v_max_f32 v16, v16, v30
  v_sub_f32 v24, v24, v16
  v_sub_f32 v26, v26, v16
  v_sub_f32 v28, v28, v16
  v_sub_f32 v30, v30, v16
  v_exp_f32 v24, v24
  v_exp_f32 v26, v26
  v_exp_f32 v28, v28
  v_exp_f32 v30, v30
  v_mul_f32 v17, v24, v25
  v_fmac_f32 v17, v26, v27
  v_fmac_f32 v17, v28, v29
  v_fmac_f32 v17, v30, v31
  v_min_u32 v16, -2, v16
  v_rcp_f32 v20, v17
  s_waitcnt lgkmcnt(0)
  v_pk_mul_f32 v[32:33], v[192:193], v[24:25] op_sel_hi:[1,0]
  v_pk_mul_f32 v[34:35], v[194:195], v[24:25] op_sel_hi:[1,0]
  v_pk_fma_f32 v[32:33], v[196:197], v[26:27], v[32:33] op_sel_hi:[1,0,1]
  v_pk_fma_f32 v[34:35], v[198:199], v[26:27], v[34:35] op_sel_hi:[1,0,1]
  v_pk_fma_f32 v[32:33], v[200:201], v[28:29], v[32:33] op_sel_hi:[1,0,1]
  v_pk_fma_f32 v[34:35], v[202:203], v[28:29], v[34:35] op_sel_hi:[1,0,1]
  v_pk_fma_f32 v[32:33], v[204:205], v[30:31], v[32:33] op_sel_hi:[1,0,1]
  v_pk_fma_f32 v[34:35], v[206:207], v[30:31], v[34:35] op_sel_hi:[1,0,1]
  s_branch L_join_124
L_ls_134:
  buffer_store_dwordx2 v[32:33], v18, s[16:19], s38 offen sc1
  v_or_b32 v17, s4, v17
  s_mov_b64 exec, 1
  s_lshr_b32 s39, s4, 24
  s_add_u32 s38, s38, s39
  buffer_store_dwordx2 v[16:17], v22, s[16:19], s38 offen sc1
  s_mov_b64 exec, -1
  s_branch L_nl_131
L_gen_132:
  v_max3_f32 v16, v24, v26, v28
  v_max_f32 v16, v16, v30
  v_sub_f32 v24, v24, v16
  v_sub_f32 v26, v26, v16
  v_sub_f32 v28, v28, v16
  v_sub_f32 v30, v30, v16
  v_exp_f32 v24, v24
  v_exp_f32 v26, v26
  v_exp_f32 v28, v28
  v_exp_f32 v30, v30
  v_mul_f32 v17, v24, v25
  v_fmac_f32 v17, v26, v27
  v_fmac_f32 v17, v28, v29
  v_fmac_f32 v17, v30, v31
  v_min_u32 v16, -2, v16
  v_rcp_f32 v20, v17
  s_waitcnt lgkmcnt(0)
  v_pk_mul_f32 v[32:33], v[192:193], v[24:25] op_sel_hi:[1,0]
  v_pk_mul_f32 v[34:35], v[194:195], v[24:25] op_sel_hi:[1,0]
  v_pk_fma_f32 v[32:33], v[196:197], v[26:27], v[32:33] op_sel_hi:[1,0,1]
  v_pk_fma_f32 v[34:35], v[198:199], v[26:27], v[34:35] op_sel_hi:[1,0,1]
  v_pk_fma_f32 v[32:33], v[200:201], v[28:29], v[32:33] op_sel_hi:[1,0,1]
  v_pk_fma_f32 v[34:35], v[202:203], v[28:29], v[34:35] op_sel_hi:[1,0,1]
  v_pk_fma_f32 v[32:33], v[204:205], v[30:31], v[32:33] op_sel_hi:[1,0,1]
  v_pk_fma_f32 v[34:35], v[206:207], v[30:31], v[34:35] op_sel_hi:[1,0,1]
  s_branch L_join_133
L_E1:
  s_mov_b32 s58, 1
  s_add_u32 m0, s45, 26496
  s_nop 0
  buffer_load_dwordx4 v2, s[12:15], s43 offen offset:128 nt lds
  s_add_u32 m0, s45, 27392
  s_nop 0
  buffer_load_dwordx4 v2, s[12:15], s43 offen offset:256 nt lds
  s_add_u32 m0, s45, 28288
  s_nop 0
  buffer_load_dwordx4 v2, s[12:15], s43 offen offset:384 nt lds
  s_add_u32 m0, s45, 28672
  s_nop 0
  buffer_load_dwordx4 v2, s[12:15], s43 offen offset:1024 nt lds
  s_add_u32 s38, s35, 9
  v_mov_b32 v18, s38
  s_mov_b64 exec, 1
  buffer_store_dword v18, off, s[16:19], s25
  s_mov_b64 exec, -1
  s_add_u32 m0, s45, 29568
  s_nop 0
  buffer_load_dwordx4 v2, s[12:15], s43 offen offset:1152 nt lds
  s_add_u32 m0, s45, 30464
  s_nop 0
  buffer_load_dwordx4 v2, s[12:15], s43 offen offset:1280 nt lds
  s_add_u32 m0, s45, 31360
  s_waitcnt vmcnt(14)
  buffer_load_dwordx4 v2, s[12:15], s43 offen offset:1408 nt lds
  s_add_u32 m0, s45, 33792
  s_waitcnt vmcnt(14)
  buffer_load_dwordx4 v2, s[92:95], s44 offen offset:0 nt lds
  s_mov_b32 s59, 1
  s_branch L_Xok1
L_ls_250:
  buffer_store_dwordx2 v[32:33], v18, s[16:19], s38 offen sc1
  v_or_b32 v17, s4, v17
  s_mov_b64 exec, 1
  s_lshr_b32 s39, s4, 24
  s_add_u32 s38, s38, s39
  buffer_store_dwordx2 v[16:17], v22, s[16:19], s38 offen sc1
  s_mov_b64 exec, -1
  s_branch L_nl_247
L_gen_248:
  v_max3_f32 v16, v24, v26, v28
  v_max_f32 v16, v16, v30
  v_sub_f32 v24, v24, v16
  v_sub_f32 v26, v26, v16
  v_sub_f32 v28, v28, v16
  v_sub_f32 v30, v30, v16
  v_exp_f32 v24, v24
  v_exp_f32 v26, v26
  v_exp_f32 v28, v28
  v_exp_f32 v30, v30
  v_mul_f32 v17, v24, v25
  v_fmac_f32 v17, v26, v27
  v_fmac_f32 v17, v28, v29
  v_fmac_f32 v17, v30, v31
  v_min_u32 v16, -2, v16
  v_rcp_f32 v20, v17
  s_waitcnt lgkmcnt(0)
  v_pk_mul_f32 v[32:33], v[96:97], v[24:25] op_sel_hi:[1,0]
  v_pk_mul_f32 v[34:35], v[98:99], v[24:25] op_sel_hi:[1,0]
  v_pk_fma_f32 v[32:33], v[100:101], v[26:27], v[32:33] op_sel_hi:[1,0,1]
  v_pk_fma_f32 v[34:35], v[102:103], v[26:27], v[34:35] op_sel_hi:[1,0,1]
  v_pk_fma_f32 v[32:33], v[104:105], v[28:29], v[32:33] op_sel_hi:[1,0,1]
  v_pk_fma_f32 v[34:35], v[106:107], v[28:29], v[34:35] op_sel_hi:[1,0,1]
  v_pk_fma_f32 v[32:33], v[108:109], v[30:31], v[32:33] op_sel_hi:[1,0,1]
  v_pk_fma_f32 v[34:35], v[110:111], v[30:31], v[34:35] op_sel_hi:[1,0,1]
  s_branch L_join_249
L_ls_259:
  buffer_store_dwordx2 v[32:33], v18, s[16:19], s38 offen sc1
  v_or_b32 v17, s4, v17
  s_mov_b64 exec, 1
  s_lshr_b32 s39, s4, 24
  s_add_u32 s38, s38, s39
  buffer_store_dwordx2 v[16:17], v22, s[16:19], s38 offen sc1
  s_mov_b64 exec, -1
  s_branch L_nl_256
L_gen_257:
  v_max3_f32 v16, v24, v26, v28
  v_max_f32 v16, v16, v30
  v_sub_f32 v24, v24, v16
  v_sub_f32 v26, v26, v16
  v_sub_f32 v28, v28, v16
  v_sub_f32 v30, v30, v16
  v_exp_f32 v24, v24
  v_exp_f32 v26, v26
  v_exp_f32 v28, v28
  v_exp_f32 v30, v30
  v_mul_f32 v17, v24, v25
  v_fmac_f32 v17, v26, v27
  v_fmac_f32 v17, v28, v29
  v_fmac_f32 v17, v30, v31
  v_min_u32 v16, -2, v16
  v_rcp_f32 v20, v17
  s_waitcnt lgkmcnt(0)
  v_pk_mul_f32 v[32:33], v[96:97], v[24:25] op_sel_hi:[1,0]
  v_pk_mul_f32 v[34:35], v[98:99], v[24:25] op_sel_hi:[1,0]
  v_pk_fma_f32 v[32:33], v[100:101], v[26:27], v[32:33] op_sel_hi:[1,0,1]
  v_pk_fma_f32 v[34:35], v[102:103], v[26:27], v[34:35] op_sel_hi:[1,0,1]
  v_pk_fma_f32 v[32:33], v[104:105], v[28:29], v[32:33] op_sel_hi:[1,0,1]
  v_pk_fma_f32 v[34:35], v[106:107], v[28:29], v[34:35] op_sel_hi:[1,0,1]
  v_pk_fma_f32 v[32:33], v[108:109], v[30:31], v[32:33] op_sel_hi:[1,0,1]
  v_pk_fma_f32 v[34:35], v[110:111], v[30:31], v[34:35] op_sel_hi:[1,0,1]
  s_branch L_join_258
L_ls_264:
  buffer_store_dwordx2 v[32:33], v18, s[16:19], s38 offen sc1
  v_or_b32 v17, s4, v17
  s_mov_b64 exec, 1
  s_lshr_b32 s39, s4, 24
  s_add_u32 s38, s38, s39
  buffer_store_dwordx2 v[16:17], v22, s[16:19], s38 offen sc1
  s_mov_b64 exec, -1
  s_branch L_nl_261
L_gen_262:
  v_max3_f32 v16, v24, v26, v28
  v_max_f32 v16, v16, v30
  v_sub_f32 v24, v24, v16
  v_sub_f32 v26, v26, v16
  v_sub_f32 v28, v28, v16
  v_sub_f32 v30, v30, v16
  v_exp_f32 v24, v24
  v_exp_f32 v26, v26
  v_exp_f32 v28, v28
  v_exp_f32 v30, v30
  v_mul_f32 v17, v24, v25
  v_fmac_f32 v17, v26, v27
  v_fmac_f32 v17, v28, v29
  v_fmac_f32 v17, v30, v31
  v_min_u32 v16, -2, v16
  v_rcp_f32 v20, v17
  s_waitcnt lgkmcnt(0)
  v_pk_mul_f32 v[32:33], v[96:97], v[24:25] op_sel_hi:[1,0]
  v_pk_mul_f32 v[34:35], v[98:99], v[24:25] op_sel_hi:[1,0]
  v_pk_fma_f32 v[32:33], v[100:101], v[26:27], v[32:33] op_sel_hi:[1,0,1]
  v_pk_fma_f32 v[34:35], v[102:103], v[26:27], v[34:35] op_sel_hi:[1,0,1]
  v_pk_fma_f32 v[32:33], v[104:105], v[28:29], v[32:33] op_sel_hi:[1,0,1]
  v_pk_fma_f32 v[34:35], v[106:107], v[28:29], v[34:35] op_sel_hi:[1,0,1]
  v_pk_fma_f32 v[32:33], v[108:109], v[30:31], v[32:33] op_sel_hi:[1,0,1]
  v_pk_fma_f32 v[34:35], v[110:111], v[30:31], v[34:35] op_sel_hi:[1,0,1]
  s_branch L_join_263
L_ls_268:
  buffer_store_dwordx2 v[32:33], v18, s[16:19], s38 offen sc1
  v_or_b32 v17, s4, v17
  s_mov_b64 exec, 1
  s_lshr_b32 s39, s4, 24
  s_add_u32 s38, s38, s39
  buffer_store_dwordx2 v[16:17], v22, s[16:19], s38 offen sc1
  s_mov_b64 exec, -1
  s_branch L_nl_265
L_gen_266:
  v_max3_f32 v16, v24, v26, v28
  v_max_f32 v16, v16, v30
  v_sub_f32 v24, v24, v16
  v_sub_f32 v26, v26, v16
  v_sub_f32 v28, v28, v16
  v_sub_f32 v30, v30, v16
  v_exp_f32 v24, v24
  v_exp_f32 v26, v26
  v_exp_f32 v28, v28
  v_exp_f32 v30, v30
  v_mul_f32 v17, v24, v25
  v_fmac_f32 v17, v26, v27
  v_fmac_f32 v17, v28, v29
  v_fmac_f32 v17, v30, v31
  v_min_u32 v16, -2, v16
  v_rcp_f32 v20, v17
  s_waitcnt lgkmcnt(0)
  v_pk_mul_f32 v[32:33], v[96:97], v[24:25] op_sel_hi:[1,0]
  v_pk_mul_f32 v[34:35], v[98:99], v[24:25] op_sel_hi:[1,0]
  v_pk_fma_f32 v[32:33], v[100:101], v[26:27], v[32:33] op_sel_hi:[1,0,1]
  v_pk_fma_f32 v[34:35], v[102:103], v[26:27], v[34:35] op_sel_hi:[1,0,1]
  v_pk_fma_f32 v[32:33], v[104:105], v[28:29], v[32:33] op_sel_hi:[1,0,1]
  v_pk_fma_f32 v[34:35], v[106:107], v[28:29], v[34:35] op_sel_hi:[1,0,1]
  v_pk_fma_f32 v[32:33], v[108:109], v[30:31], v[32:33] op_sel_hi:[1,0,1]
  v_pk_fma_f32 v[34:35], v[110:111], v[30:31], v[34:35] op_sel_hi:[1,0,1]
  s_branch L_join_267
L_ls_272:
  buffer_store_dwordx2 v[32:33], v18, s[16:19], s38 offen sc1
  v_or_b32 v17, s4, v17
  s_mov_b64 exec, 1
  s_lshr_b32 s39, s4, 24
  s_add_u32 s38, s38, s39
  buffer_store_dwordx2 v[16:17], v22, s[16:19], s38 offen sc1
  s_mov_b64 exec, -1
  s_branch L_nl_269
L_gen_270:
  v_max3_f32 v16, v24, v26, v28
  v_max_f32 v16, v16, v30
  v_sub_f32 v24, v24, v16
  v_sub_f32 v26, v26, v16
  v_sub_f32 v28, v28, v16
  v_sub_f32 v30, v30, v16
  v_exp_f32 v24, v24
  v_exp_f32 v26, v26
  v_exp_f32 v28, v28
  v_exp_f32 v30, v30
  v_mul_f32 v17, v24, v25
  v_fmac_f32 v17, v26, v27
  v_fmac_f32 v17, v28, v29
  v_fmac_f32 v17, v30, v31
  v_min_u32 v16, -2, v16
  v_rcp_f32 v20, v17
  s_waitcnt lgkmcnt(0)
  v_pk_mul_f32 v[32:33], v[48:49], v[24:25] op_sel_hi:[1,0]
  v_pk_mul_f32 v[34:35], v[50:51], v[24:25] op_sel_hi:[1,0]
  v_pk_fma_f32 v[32:33], v[52:53], v[26:27], v[32:33] op_sel_hi:[1,0,1]
  v_pk_fma_f32 v[34:35], v[54:55], v[26:27], v[34:35] op_sel_hi:[1,0,1]
  v_pk_fma_f32 v[32:33], v[56:57], v[28:29], v[32:33] op_sel_hi:[1,0,1]
  v_pk_fma_f32 v[34:35], v[58:59], v[28:29], v[34:35] op_sel_hi:[1,0,1]
  v_pk_fma_f32 v[32:33], v[60:61], v[30:31], v[32:33] op_sel_hi:[1,0,1]
  v_pk_fma_f32 v[34:35], v[62:63], v[30:31], v[34:35] op_sel_hi:[1,0,1]
  s_branch L_join_271
L_help:
  v_subrev_u32 v16, s35, v16
  v_cmp_ge_i32 vcc, s34, v16
  s_and_b32 s33, vcc_lo, 0xfffffff
  s_cbranch_scc0 L_help9
  s_bcnt1_i32_b32 s38, s33
  s_max_u32 s38, s38, s32
  s_bfe_u32 s32, s21, 0x50001
  s_mul_i32 s38, s38, s32
  s_lshr_b32 s38, s38, 5
  v_mbcnt_lo_u32_b32 v17, s33, 0
  v_cmp_eq_u32 vcc, s38, v17
  s_add_u32 s21, s21, 23
  s_and_b32 s38, vcc_lo, s33
  s_cbranch_scc0 L_help9
  s_ff1_i32_b32 s32, s38
  s_and_b32 s38, s21, 1
  s_mov_b32 m0, 163072
  v_readlane_b32 s33, v16, s32
  s_sub_i32 s39, s34, 2
  s_max_i32 s33, s33, s39
  s_add_i32 s33, s33, s38
  s_add_i32 s33, s33, 2
  s_min_i32 s33, s33, 12
  s_cmp_ge_u32 s32, 14
  s_cselect_b32 s38, 14, 0
  s_cselect_b32 s39, 0x200000, 0
  s_sub_u32 s32, s32, s38
  s_sub_u32 s39, s39, s24
  s_add_u32 s39, s39, s40
  s_cmp_lt_i32 s33, 0
  s_cselect_b32 s38, 10, 0
  s_cselect_b32 s30, 0x2000000, 0
  s_add_i32 s33, s33, s38
  s_sub_u32 s39, s39, s30
  s_cmp_ge_i32 s33, 10
  s_cselect_b32 s38, 10, 0
  s_cselect_b32 s30, 0x2000000, 0
  s_sub_i32 s33, s33, s38
  s_add_u32 s39, s39, s30
  s_cmp_ge_u32 s33, 5
  s_cselect_b64 s[28:29], s[12:13], s[8:9]
  s_cselect_b32 s38, 0, 3
  s_add_u32 s33, s33, s38
  s_mov_b32 s30, 0x8000000
  s_mov_b32 s31, 0x20000
  s_cmp_ge_u32 s33, 5
  s_cselect_b32 s38, 5, 0
  s_sub_u32 s33, s33, s38
  s_mul_i32 s38, s33, 458752
  s_add_u32 s39, s39, s38
  v_lshlrev_b32 v19, 3, v4
  s_lshl_b32 s38, s32, 6
  s_cmp_lg_u32 s33, 4
  s_cbranch_scc1 L_help2
  s_mul_i32 s38, s32, 36
  s_min_u32 s32, s32, 8
  s_add_u32 s38, s38, s32
  s_mul_i32 s32, s3, 7
  s_sub_u32 s38, s38, s32
  s_mov_b32 exec_hi, 0xff
L_help2:
  s_lshl_b32 s38, s38, 9
  s_add_u32 s39, s39, s38
  buffer_load_dword v19, s[28:31], s39 offen  lds
  s_mov_b32 exec_hi, -1
L_help9:
  s_setpc_b64 s[96:97]
L_chain:
  s_lshl4_add_u32 s2, s38, s36
  s_mov_b32 s8, s2
  s_mov_b32 s9, s5
  s_mov_b32 s10, 0
  v_lshlrev_b32 v1, 4, v0
  v_bfe_u32 v2, v0, 0, 1
  v_lshlrev_b32 v2, 4, v2
  v_bfe_u32 v6, v0, 4, 2
  v_lshl_add_u32 v2, v6, 5, v2
  v_bfe_u32 v4, v0, 1, 1
  v_bfe_u32 v6, v0, 3, 1
  v_lshl_add_u32 v4, v6, 2, v4
  v_bfe_u32 v6, v0, 2, 1
  v_lshl_add_u32 v4, v6, 3, v4
  s_lshl_b32 s98, s3, 13
  s_add_u32 s98, s98, 8192
  s_movk_i32 s99, 1024
  s_mul_i32 s32, s3, 7168
  s_add_u32 s32, s32, 8192
  s_lshl_b32 s38, 1, s101
  v_mov_b32 v28, s100
  v_mov_b32 v29, s38
  s_or_b32 s38, s3, s7
  s_waitcnt lgkmcnt(0)
  s_cbranch_scc1 L_cl_281
  s_mov_b64 exec, 1
  global_atomic_or v46, v28, v29, s[84:85] sc0 sc1
  s_mov_b64 exec, -1
L_cl_281:
  s_mov_b64 s[16:17], s[86:87]
  s_mov_b32 s18, 0x20000000
  s_mov_b32 s19, 0x20000
  s_cmp_lt_u32 s2, 16
  s_cbranch_scc1 L_roleOQ
  s_cmp_lt_u32 s2, 30
  s_cbranch_scc1 L_roleF
  v_and_b32 v6, 1, v0
  v_cmp_eq_u32 vcc, 1, v6
  v_mov_b32 v3, 0x44444444
  v_mov_b32 v6, 0xeeeeeeee
  v_cndmask_b32 v3, v3, v6, vcc
  v_bfe_u32 v9, v0, 0, 5
  v_lshlrev_b32 v9, 3, v9
  v_bfe_u32 v6, v0, 5, 1
  v_lshl_add_u32 v9, v6, 10, v9
  v_mul_u32_u24 v5, 6144, v6
  s_mul_i32 s38, s3, 1792
  v_add3_u32 v5, v5, v9, s38
  s_mov_b32 s57, 0x40000000
  s_mov_b32 s56, 0x40000000
  s_mov_b32 s49, -1
  s_waitcnt vmcnt(0)
  v_mov_b32 v28, 0
  s_cmp_lg_u32 s3, 0
  s_cbranch_scc1 L_rs_282
  s_movk_i32 s38, 0x100
  s_cmp_lg_u32 s7, 0
  s_cbranch_scc1 L_rw_283
  v_readfirstlane_b32 s39, v46
  s_bitcmp1_b32 s39, s101
  s_cbranch_scc0 L_rw_283
  s_call_b64 s[96:97], L_lost
L_rw_283:
  v_mov_b32 v29, s38
  ds_write_b32 v28, v29 offset:4096
  s_waitcnt lgkmcnt(0)
L_rs_282:
  s_barrier
  ds_read_b32 v29, v28 offset:4096
  s_waitcnt lgkmcnt(0)
  v_readfirstlane_b32 s38, v29
  s_cmp_lg_u32 s38, 0x100
  s_cbranch_scc1 L_redo
  v_mov_b32 v20, -1
  v_mov_b32 v21, -1
  v_mov_b32 v22, -1
  v_mov_b32 v23, -1
  s_lshl2_add_u32 s38, s8, s3
  s_mul_i32 s38, s38, 4608
  s_add_u32 s38, s38, 0x10000
  buffer_store_dwordx4 v[20:23], v1, s[16:19], s38 offen offset:0 sc1
  buffer_store_dwordx4 v[20:23], v1, s[16:19], s38 offen offset:1024 sc1
  buffer_store_dwordx4 v[20:23], v1, s[16:19], s38 offen offset:2048 sc1
  buffer_store_dwordx4 v[20:23], v1, s[16:19], s38 offen offset:3072 sc1
  buffer_store_dwordx4 v[20:23], v1, s[16:19], s38 offen offset:3584 sc1
  s_lshl_b32 s38, s3, 11
  s_lshl_b32 s39, s8, 15
  s_add_u32 s38, s38, s39
  s_add_u32 s38, s38, 0x780000
  buffer_store_dwordx4 v[20:23], v1, s[16:19], s38 offen offset:0 sc1
  buffer_store_dwordx4 v[20:23], v1, s[16:19], s38 offen offset:1024 sc1
  s_waitcnt vmcnt(0)
  s_barrier
  s_cmp_lg_u32 s3, 0
  s_cbranch_scc1 L_sg_284
  s_mov_b64 exec, 1
  v_mov_b32 v28, 0
  v_mov_b32 v29, s9
  global_atomic_add v28, v29, s[84:85] offset:16 sc1
  s_mov_b64 exec, -1
L_sg_284:
  s_sub_u32 s2, s2, 30
  s_cmp_lg_u32 s2, 0
  s_cbranch_scc1 L_end
  s_mul_i32 s38, s3, 1536
  s_add_u32 s11, s38, 0x98000
  s_mov_b32 s4, -1
  s_mov_b32 s5, -1
  s_mov_b32 s6, 12
  s_waitcnt vmcnt(0)
L_nr_285:
  s_waitcnt lgkmcnt(0)
  s_memtime s[58:59]
  s_waitcnt lgkmcnt(0)
  buffer_load_dword v28, off, s[16:19], s11 sc1
  s_waitcnt vmcnt(0)
  s_memtime s[38:39]
  s_waitcnt lgkmcnt(0)
  s_sub_u32 s38, s38, s58
  s_min_u32 s38, s38, s4
  s_mov_b32 s4, s5
  s_mov_b32 s5, s38
  s_xor_b32 s11, s11, 0x2000
  s_and_b32 s38, s6, 1
  s_lshl_b32 s38, s38, 7
  s_add_u32 s11, s11, s38
  s_sub_u32 s6, s6, 1
  s_cmp_lg_u32 s6, 0
  s_cbranch_scc1 L_nr_285
  s_cmp_gt_u32 s4, s5
  s_cselect_b32 s10, 0x2000, 0
  s_getreg_b32 s38, hwreg(HW_REG_XCC_ID, 2, 1)
  s_lshr_b32 s39, s10, 13
  s_xor_b32 s38, s38, s39
  v_mov_b32 v28, s38
  v_mov_b32 v29, 0
  s_cmp_eq_u32 s3, 0
  s_cselect_b64 exec, 1, 0
  global_store_dword v29, v28, s[84:85] offset:20 sc1
  s_mov_b64 exec, -1
  s_mov_b64 s[20:21], s[82:83]
  s_mov_b32 s22, 0xe00
  s_mov_b32 s23, 0x20000
  v_mov_b32 v10, 0x40000000
  v_bfe_u32 v6, v0, 0, 4
  v_lshlrev_b32 v6, 3, v6
  v_bfe_u32 v7, v0, 4, 1
  v_lshl_add_u32 v6, v7, 2, v6
  v_bfe_u32 v7, v0, 5, 1
  v_lshl_add_u32 v6, v7, 7, v6
  s_mul_i32 s38, s3, 224
  s_lshl_b32 s39, s3, 5
  s_add_u32 s39, s39, 672
  v_cmp_gt_u32 vcc, 224, v6
  v_add_u32 v15, s38, v6
  v_add_u32 v6, s39, v6
  v_cndmask_b32 v12, v10, v15, vcc
  v_cndmask_b32 v15, v6, v15, vcc
  s_lshl_b32 s38, s3, 9
  v_lshl_add_u32 v14, v0, 3, s38
  v_cndmask_b32 v14, v10, v14, vcc
  v_bfe_u32 v13, v0, 0, 4
  v_lshlrev_b32 v13, 4, v13
  v_bfe_u32 v6, v0, 4, 1
  v_lshl_add_u32 v13, v6, 12, v13
  v_bfe_u32 v6, v0, 5, 1
  v_lshl_add_u32 v13, v6, 14, v13
  s_lshl_b32 s38, s3, 8
  v_add_u32 v13, s38, v13
  v_lshl_add_u32 v39, v0, 2, s38
  v_cmp_gt_u32 vcc, 48, v0
  v_mov_b32 v18, 0
  v_mov_b32 v19, 0
  v_cndmask_b32 v8, v10, v13, vcc
  v_and_b32 v6, 8, v0
  v_cmp_eq_u32 vcc, 8, v6
  v_mov_b32 v6, 0x3c00
  v_mov_b32 v7, 0x3c000000
  v_cndmask_b32 v6, v6, v7, vcc
  v_and_b32 v7, 7, v0
  v_cmp_eq_u32 vcc, 0, v7
  s_nop 1
  v_cndmask_b32 v32, 0, v6, vcc
  v_cmp_eq_u32 vcc, 1, v7
  s_nop 1
  v_cndmask_b32 v33, 0, v6, vcc
  v_cmp_eq_u32 vcc, 4, v7
  s_nop 1
  v_cndmask_b32 v34, 0, v6, vcc
  v_cmp_eq_u32 vcc, 5, v7
  s_nop 1
  v_cndmask_b32 v35, 0, v6, vcc
  global_load_dwordx2 v[46:47], v18, s[84:85] offset:16 sc1
  s_waitcnt vmcnt(0)
  s_branch L_cntc_287
L_cnt_286:
  s_sub_u32 s52, s52, 1
  s_cbranch_scc1 L_bail
  global_load_dword v46, v18, s[84:85] offset:16 sc1
  s_waitcnt vmcnt(0)
L_cntc_287:
  v_and_b32 v22, 0xff, v46
  v_cmp_gt_u32 vcc, 32, v22
  s_cbranch_vccnz L_cnt_286
  s_mov_b32 s56, 0
  s_movk_i32 s57, 0x2000
  s_mov_b32 s49, 0
  s_add_u32 s47, s10, 0x94000
  s_add_u32 s48, s10, 0x70000
  s_mov_b32 s44, 0
L_Wtop:
  s_movk_i32 s38, 7
  s_bitcmp1_b32 s38, s49
  s_cbranch_scc0 L_g_288
L_gw_291:
  s_mov_b64 exec, -1
  s_sub_u32 s52, s52, 1
  s_cbranch_scc1 L_bail
  s_mov_b32 exec_lo, 0x10001
  s_mov_b32 exec_hi, 0x10001
  buffer_load_dword v20, v13, s[16:19], s48 offen sc1
  s_waitcnt vmcnt(0)
  v_cmp_ne_u32 vcc, -1, v20
  s_cbranch_vccz L_gw_291
  s_mov_b64 exec, -1
L_g_288:
  s_sub_u32 s52, s52, 1
  s_cbranch_scc1 L_bail
  buffer_load_dwordx2 v[16:17], v14, s[16:19], s47 offen sc1
  buffer_load_dwordx4 v[64:67], v13, s[16:19], s48 offen offset:0 sc1
  buffer_load_dwordx4 v[68:71], v13, s[16:19], s48 offen offset:1024 sc1
  buffer_load_dwordx4 v[72:75], v8, s[16:19], s48 offen offset:2048 sc1
  buffer_load_dwordx4 v[76:79], v8, s[16:19], s48 offen offset:3072 sc1
  s_waitcnt vmcnt(3)
  v_mfma_f32_16x16x32_f16 v[20:23], v[32:35], v[64:67], v[16:19]
  s_waitcnt vmcnt(2)
  v_mfma_f32_16x16x32_f16 v[20:23], v[32:35], v[68:71], v[20:23]
  s_waitcnt vmcnt(1)
  v_mfma_f32_16x16x32_f16 v[20:23], v[32:35], v[72:75], v[20:23]
  s_waitcnt vmcnt(0)
  v_mfma_f32_16x16x32_f16 v[20:23], v[32:35], v[76:79], v[20:23]
  s_nop 8
  v_cmp_u_f32 vcc, v20, v21
  v_cvt_pk_bf16_f32 v24, v20, v21
  s_cbranch_vccz L_gd_289
  v_max3_u32 v6, v64, v65, v66
  v_max3_u32 v6, v6, v67, v68
  v_max3_u32 v6, v6, v69, v70
  v_max3_u32 v6, v6, v71, v72
  v_max3_u32 v6, v6, v73, v74
  v_max3_u32 v6, v6, v75, v76
  v_max3_u32 v6, v6, v77, v78
  v_max3_u32 v6, v6, v79, v16
  v_max3_u32 v6, v6, v17, v17
  v_cmp_eq_u32 vcc, -1, v6
  s_cbranch_vccnz L_g_288
L_gd_289:
  buffer_store_dword v24, v12, s[20:23], s44 offen
  s_add_u32 s49, s49, 1
  s_add_u32 s47, s47, 2048
  s_add_u32 s48, s48, 32768
  s_add_u32 s44, s44, 896
  s_cmp_lt_u32 s49, 4
  s_cbranch_scc1 L_Wtop
  s_branch L_end
L_dmaQ:
  buffer_load_dwordx4 v44, s[20:23], s88 offen nt lds
  s_add_u32 m0, m0, s99
  s_nop 0
  buffer_load_dwordx4 v44, s[20:23], s89 offen nt lds
  s_add_u32 m0, m0, s99
  s_nop 0
  buffer_load_dwordx4 v44, s[20:23], s90 offen nt lds
  s_add_u32 m0, m0, s99
  s_nop 0
  buffer_load_dwordx4 v44, s[20:23], s91 offen nt lds
  s_add_u32 m0, m0, s99
  s_nop 0
  buffer_load_dwordx4 v44, s[20:23], s92 offen nt lds
  s_add_u32 m0, m0, s99
  s_nop 0
  buffer_load_dwordx4 v44, s[20:23], s93 offen nt lds
  s_add_u32 m0, m0, s99
  s_nop 0
  buffer_load_dwordx4 v44, s[20:23], s94 offen nt lds
  s_add_u32 m0, m0, s99
  s_nop 0
  buffer_load_dwordx4 v44, s[20:23], s95 offen nt lds
  v_add_u32 v44, 0x80000, v44
  s_setpc_b64 s[96:97]
L_dmaO:
  buffer_load_dwordx4 v11, s[24:27], 0 offen offset:0 nt lds
  s_add_u32 m0, m0, 896
  s_nop 0
  buffer_load_dwordx4 v11, s[24:27], 0 offen offset:128 nt lds
  s_add_u32 m0, m0, 896
  s_nop 0
  buffer_load_dwordx4 v11, s[24:27], 0 offen offset:256 nt lds
  s_add_u32 m0, m0, 896
  s_nop 0
  buffer_load_dwordx4 v11, s[24:27], 0 offen offset:384 nt lds
  s_add_u32 m0, m0, 896
  s_nop 0
  buffer_load_dwordx4 v11, s[24:27], 0 offen offset:512 nt lds
  s_add_u32 m0, m0, 896
  s_nop 0
  buffer_load_dwordx4 v11, s[24:27], 0 offen offset:640 nt lds
  s_add_u32 m0, m0, 896
  s_nop 0
  buffer_load_dwordx4 v11, s[24:27], 0 offen offset:768 nt lds
  v_add_u32 v11, 0x7000, v11
  s_setpc_b64 s[96:97]
L_Osub:
  s_lshl_b32 s38, s49, 2
  s_lshr_b32 s50, 0x76352410, s38
  s_and_b32 s50, s50, 7
  s_and_b32 s38, s50, 1
  s_lshl_b32 s38, s38, 20
  s_add_u32 s38, s38, 524288
  s_bitcmp1_b32 s50, 2
  s_cselect_b32 s44, s38, 0
  s_add_u32 s44, s44, s41
  s_add_u32 s46, s44, 4096
  s_lshl_b32 s48, s50, 15
  s_add_u32 s48, s48, s40
  s_add_u32 s51, s48, s56
  s_add_u32 s48, s48, s57
  v_mov_b64 v[48:49], 0
  v_mov_b64 v[50:51], 0
  v_mov_b64 v[52:53], 0
  v_mov_b64 v[54:55], 0
  v_mov_b64 v[56:57], 0
  v_mov_b64 v[58:59], 0
  v_mov_b64 v[60:61], 0
  v_mov_b64 v[62:63], 0
  v_mov_b64 v[64:65], 0
  v_mov_b64 v[66:67], 0
  v_mov_b64 v[68:69], 0
  v_mov_b64 v[70:71], 0
  v_mov_b64 v[72:73], 0
  v_mov_b64 v[74:75], 0
  s_cmp_lt_i32 s49, 0
  s_cbranch_scc1 L_Ook
L_Oheavy:
  s_sub_u32 s52, s52, 1
  s_cbranch_scc1 L_bail
  buffer_load_dwordx2 v[92:93], v42, s[16:19], s44 offen sc1
  buffer_load_dwordx2 v[76:77], v40, s[16:19], s44 offen offset:0 sc1
  buffer_load_dwordx2 v[78:79], v40, s[16:19], s44 offen offset:2048 sc1
  buffer_load_dwordx2 v[80:81], v40, s[16:19], s46 offen offset:0 sc1
  buffer_load_dwordx2 v[82:83], v41, s[16:19], s46 offen offset:2048 sc1
  s_cmp_eq_u32 s55, 1
  s_cbranch_scc1 L_Ocomp
  buffer_load_dwordx2 v[88:89], v42, s[16:19], s44 offen offset:128 sc1
  s_waitcnt vmcnt(0)
  v_and_b32 v92, v92, v88
  v_and_b32 v93, v93, v89
L_Ocomp:
  s_waitcnt vmcnt(4)
  v_max_f32_dpp v20, v92, v92 quad_perm:[1,0,3,2] row_mask:0xf bank_mask:0xf
  s_nop 1
  v_max_f32_dpp v20, v20, v20 quad_perm:[2,3,0,1] row_mask:0xf bank_mask:0xf
  s_nop 1
  v_max_f32_dpp v20, v20, v20 row_ror:4 row_mask:0xf bank_mask:0xf
  s_nop 1
  v_max_f32_dpp v20, v20, v20 row_ror:8 row_mask:0xf bank_mask:0xf
  v_sub_f32 v20, v92, v20
  v_exp_f32 v20, v20
  s_nop 0
  v_cndmask_b32 v20, 0, v20, s[42:43]
  v_mul_f32 v21, v20, abs(v93)
  s_nop 1
  v_mov_b32_dpp v84, v21 row_newbcast:0 row_mask:0xf bank_mask:0xf
  v_mov_b32_dpp v85, v21 row_newbcast:1 row_mask:0xf bank_mask:0xf
  v_mov_b32_dpp v86, v21 row_newbcast:2 row_mask:0xf bank_mask:0xf
  v_mov_b32_dpp v87, v21 row_newbcast:3 row_mask:0xf bank_mask:0xf
  s_waitcnt vmcnt(3)
  v_fma_mix_f32 v24, v84, v76, 0 op_sel:[0,0,0] op_sel_hi:[0,1,0]
  v_fma_mix_f32 v25, v84, v76, 0 op_sel:[0,1,0] op_sel_hi:[0,1,0]
  v_fma_mix_f32 v26, v84, v77, 0 op_sel:[0,0,0] op_sel_hi:[0,1,0]
  v_fma_mix_f32 v27, v84, v77, 0 op_sel:[0,1,0] op_sel_hi:[0,1,0]
  v_add_f32_dpp v21, v21, v21 quad_perm:[1,0,3,2] row_mask:0xf bank_mask:0xf
  s_waitcnt vmcnt(2)
  v_fma_mix_f32 v24, v85, v78, v24 op_sel:[0,0,0] op_sel_hi:[0,1,0]
  v_fma_mix_f32 v25, v85, v78, v25 op_sel:[0,1,0] op_sel_hi:[0,1,0]
  v_fma_mix_f32 v26, v85, v79, v26 op_sel:[0,0,0] op_sel_hi:[0,1,0]
  v_fma_mix_f32 v27, v85, v79, v27 op_sel:[0,1,0] op_sel_hi:[0,1,0]
  v_add_f32_dpp v21, v21, v21 quad_perm:[2,3,0,1] row_mask:0xf bank_mask:0xf
  s_waitcnt vmcnt(1)
  v_fma_mix_f32 v24, v86, v80, v24 op_sel:[0,0,0] op_sel_hi:[0,1,0]
  v_fma_mix_f32 v25, v86, v80, v25 op_sel:[0,1,0] op_sel_hi:[0,1,0]
  v_fma_mix_f32 v26, v86, v81, v26 op_sel:[0,0,0] op_sel_hi:[0,1,0]
  v_fma_mix_f32 v27, v86, v81, v27 op_sel:[0,1,0] op_sel_hi:[0,1,0]
  v_add_f32_dpp v21, v21, v21 row_ror:4 row_mask:0xf bank_mask:0xf
  s_waitcnt vmcnt(0)
  v_fma_mix_f32 v24, v87, v82, v24 op_sel:[0,0,0] op_sel_hi:[0,1,0]
  v_fma_mix_f32 v25, v87, v82, v25 op_sel:[0,1,0] op_sel_hi:[0,1,0]
  v_fma_mix_f32 v26, v87, v83, v26 op_sel:[0,0,0] op_sel_hi:[0,1,0]
  v_fma_mix_f32 v27, v87, v83, v27 op_sel:[0,1,0] op_sel_hi:[0,1,0]
  v_add_f32_dpp v21, v21, v21 row_ror:8 row_mask:0xf bank_mask:0xf
  v_permlane16_swap_b32 v24, v25
  v_permlane16_swap_b32 v26, v27
  v_rcp_f32 v21, v21
  v_add_f32 v24, v24, v25
  v_add_f32 v26, v26, v27
  s_nop 1
  v_permlane32_swap_b32 v24, v26
  v_add_f32 v24, v24, v26
  v_mul_f32 v24, v24, v21
  v_cmp_u_f32 vcc, v24, v24
  v_cvt_pk_bf16_f32 v24, v24, v24
  s_cbranch_vccz L_Ook0
  v_max3_u32 v6, v76, v77, v78
  v_max3_u32 v6, v6, v79, v80
  v_max3_u32 v6, v6, v81, v82
  v_max3_u32 v6, v6, v83, v92
  v_max3_u32 v6, v6, v93, v93
  v_cmp_eq_u32 vcc, -1, v6
  s_cbranch_vccnz L_Oheavy
L_Ook0:
  s_cmp_lg_u32 s49, 0
  s_cbranch_scc1 L_Ook
  s_setpc_b64 s[34:35]
L_Ook:
  ds_write_b16 v43, v24
  s_waitcnt lgkmcnt(0)
  s_barrier
  ds_read_b128 v[76:79], v2 offset:0
  ds_read_b128 v[80:83], v2 offset:128
  ds_read_b128 v[84:87], v2 offset:256
  ds_read_b128 v[88:91], v2 offset:384
  s_waitcnt lgkmcnt(3)
  v_smfmac_f32_16x16x64_bf16 v[48:51], v[76:79], a[64:71], v3
  v_xor_b32 v15, 0x400, v15
  v_xor_b32 v2, 0x400, v2
  v_smfmac_f32_16x16x64_bf16 v[52:55], v[76:79], a[88:95], v3
  v_xor_b32 v1, 0x400, v1
  v_xor_b32 v43, 0x400, v43
  v_smfmac_f32_16x16x64_bf16 v[56:59], v[76:79], a[112:119], v3
  v_mov_b32 v21, 0
  v_smfmac_f32_16x16x64_bf16 v[60:63], v[76:79], a[136:143], v3
  v_smfmac_f32_16x16x64_bf16 v[64:67], v[76:79], a[160:167], v3
  v_smfmac_f32_16x16x64_bf16 v[68:71], v[76:79], a[184:191], v3
  v_smfmac_f32_16x16x64_bf16 v[72:75], v[76:79], a[208:215], v3
  s_waitcnt lgkmcnt(2)
  v_smfmac_f32_16x16x64_bf16 v[48:51], v[80:83], a[72:79], v3
  v_smfmac_f32_16x16x64_bf16 v[52:55], v[80:83], a[96:103], v3
  v_smfmac_f32_16x16x64_bf16 v[56:59], v[80:83], a[120:127], v3
  v_smfmac_f32_16x16x64_bf16 v[60:63], v[80:83], a[144:151], v3
  v_smfmac_f32_16x16x64_bf16 v[64:67], v[80:83], a[168:175], v3
  v_smfmac_f32_16x16x64_bf16 v[68:71], v[80:83], a[192:199], v3
  v_smfmac_f32_16x16x64_bf16 v[72:75], v[80:83], a[216:223], v3
  s_waitcnt lgkmcnt(1)
  v_smfmac_f32_16x16x64_bf16 v[48:51], v[84:87], a[80:87], v3
  v_smfmac_f32_16x16x64_bf16 v[52:55], v[84:87], a[104:111], v3
  v_smfmac_f32_16x16x64_bf16 v[56:59], v[84:87], a[128:135], v3
  v_smfmac_f32_16x16x64_bf16 v[60:63], v[84:87], a[152:159], v3
  v_smfmac_f32_16x16x64_bf16 v[64:67], v[84:87], a[176:183], v3
  v_smfmac_f32_16x16x64_bf16 v[68:71], v[84:87], a[200:207], v3
  v_smfmac_f32_16x16x64_bf16 v[72:75], v[84:87], a[224:231], v3
  s_waitcnt lgkmcnt(0)
  v_smfmac_f32_16x16x64_bf16 v[48:51], v[88:91], a[32:39], v3
  v_smfmac_f32_16x16x64_bf16 v[52:55], v[88:91], a[40:47], v3
  v_smfmac_f32_16x16x64_bf16 v[56:59], v[88:91], a[48:55], v3
  v_smfmac_f32_16x16x64_bf16 v[60:63], v[88:91], a[56:63], v3
  v_smfmac_f32_16x16x64_bf16 v[64:67], v[88:91], a[232:239], v3
  v_smfmac_f32_16x16x64_bf16 v[68:71], v[88:91], a[240:247], v3
  v_smfmac_f32_16x16x64_bf16 v[72:75], v[88:91], a[248:255], v3
  s_nop 2
  v_add_f32_dpp v20, v48, v49 quad_perm:[0,1,2,3] row_mask:0x1 bank_mask:0xf
  v_add_f32_dpp v20, v52, v53 quad_perm:[0,1,2,3] row_mask:0x2 bank_mask:0xf
  v_add_f32_dpp v20, v56, v57 quad_perm:[0,1,2,3] row_mask:0x4 bank_mask:0xf
  v_add_f32_dpp v20, v60, v61 quad_perm:[0,1,2,3] row_mask:0x8 bank_mask:0xf
  v_add_f32_dpp v21, v64, v65 quad_perm:[0,1,2,3] row_mask:0x1 bank_mask:0xf
  v_add_f32_dpp v21, v68, v69 quad_perm:[0,1,2,3] row_mask:0x2 bank_mask:0xf
  v_add_f32_dpp v21, v72, v73 quad_perm:[0,1,2,3] row_mask:0x4 bank_mask:0xf
  v_cvt_pk_f16_f32 v20, v20, v21
  v_min_u32 v20, -2, v20
  buffer_store_dword v20, v39, s[16:19], s51 offen sc1
  buffer_store_dword v20, v39, s[16:19], s48 offen sc1
  s_add_u32 s49, s49, 1
  s_setpc_b64 s[34:35]
L_Qsub:
  v_mov_b64 v[48:49], 0
  v_mov_b64 v[50:51], 0
  v_mov_b64 v[52:53], 0
  v_mov_b64 v[54:55], 0
  v_mov_b64 v[56:57], 0
  v_mov_b64 v[58:59], 0
  v_mov_b64 v[60:61], 0
  v_mov_b64 v[62:63], 0
  s_lshl_b32 s44, s53, 13
  s_add_u32 s44, s44, s54
  s_lshl_b32 s38, s53, 11
  s_add_u32 s47, s38, 0x8e000
  s_add_u32 s47, s47, s10
  s_add_u32 s45, s38, s33
  s_add_u32 s46, s45, s56
  s_add_u32 s45, s45, s57
  s_lshl_b32 s48, s53, 15
  s_add_u32 s48, s48, 0x30000
  s_add_u32 s48, s48, s10
  s_cmp_lt_u32 s53, 4
  s_cbranch_scc1 L_Qx
  v_mov_b64 v[24:25], -1
  v_mov_b64 v[26:27], -1
  v_lshlrev_b32 v6, 4, v0
  s_and_b32 s38, s53, 1
  s_lshl_b32 s38, s38, 20
  s_add_u32 s38, s38, s11
  s_sub_u32 s39, s11, 524288
  s_cmp_eq_u32 s53, 7
  s_cselect_b32 s39, 0x40000000, s39
  s_cmp_eq_u32 s9, 1
  s_cbranch_scc1 L_Qal
  buffer_store_dwordx4 v[24:27], v6, s[16:19], s38 offen offset:0 sc1
  buffer_store_dwordx4 v[24:27], v6, s[16:19], s39 offen offset:0 sc1
  s_cmp_eq_u32 s3, 3
  s_cselect_b64 exec, 0xffff, -1
  buffer_store_dwordx4 v[24:27], v6, s[16:19], s38 offen offset:1024 sc1
  buffer_store_dwordx4 v[24:27], v6, s[16:19], s39 offen offset:1024 sc1
  s_branch L_Qam
L_Qal:
  buffer_store_dwordx4 v[24:27], v6, s[16:19], s38 offen offset:0
  buffer_store_dwordx4 v[24:27], v6, s[16:19], s39 offen offset:0
  s_cmp_eq_u32 s3, 3
  s_cselect_b64 exec, 0xffff, -1
  buffer_store_dwordx4 v[24:27], v6, s[16:19], s38 offen offset:1024
  buffer_store_dwordx4 v[24:27], v6, s[16:19], s39 offen offset:1024
L_Qam:
  s_mov_b64 exec, -1
  s_movk_i32 s38, 112
  s_bitcmp1_b32 s38, s53
  s_cbranch_scc0 L_g_292
L_gw_295:
  s_mov_b64 exec, -1
  s_sub_u32 s52, s52, 1
  s_cbranch_scc1 L_bail
  s_mov_b32 exec_lo, 0x10001
  s_mov_b32 exec_hi, 0x10001
  buffer_load_dword v20, v13, s[16:19], s48 offen sc1
  s_waitcnt vmcnt(0)
  v_cmp_ne_u32 vcc, -1, v20
  s_cbranch_vccz L_gw_295
  s_mov_b64 exec, -1
L_g_292:
  s_sub_u32 s52, s52, 1
  s_cbranch_scc1 L_bail
  buffer_load_dwordx2 v[16:17], v14, s[16:19], s47 offen sc1
  buffer_load_dwordx4 v[64:67], v13, s[16:19], s48 offen offset:0 sc1
  buffer_load_dwordx4 v[68:71], v13, s[16:19], s48 offen offset:1024 sc1
  buffer_load_dwordx4 v[72:75], v8, s[16:19], s48 offen offset:2048 sc1
  buffer_load_dwordx4 v[76:79], v8, s[16:19], s48 offen offset:3072 sc1
  s_waitcnt vmcnt(3)
  v_mfma_f32_16x16x32_f16 v[20:23], v[32:35], v[64:67], v[16:19]
  s_waitcnt vmcnt(2)
  v_mfma_f32_16x16x32_f16 v[20:23], v[32:35], v[68:71], v[20:23]
  s_waitcnt vmcnt(1)
  v_mfma_f32_16x16x32_f16 v[20:23], v[32:35], v[72:75], v[20:23]
  s_waitcnt vmcnt(0)
  v_mfma_f32_16x16x32_f16 v[20:23], v[32:35], v[76:79], v[20:23]
  s_nop 8
  v_cmp_u_f32 vcc, v20, v21
  v_cvt_pk_bf16_f32 v24, v20, v21
  s_cbranch_vccz L_gd_293
  v_max3_u32 v6, v64, v65, v66
  v_max3_u32 v6, v6, v67, v68
  v_max3_u32 v6, v6, v69, v70
  v_max3_u32 v6, v6, v71, v72
  v_max3_u32 v6, v6, v73, v74
  v_max3_u32 v6, v6, v75, v76
  v_max3_u32 v6, v6, v77, v78
  v_max3_u32 v6, v6, v79, v16
  v_max3_u32 v6, v6, v17, v17
  v_cmp_eq_u32 vcc, -1, v6
  s_cbranch_vccnz L_g_292
L_gd_293:
L_Qx:
  ds_write_b32 v15, v24
  s_waitcnt lgkmcnt(0)
  s_barrier
  ds_read_b128 v[64:67], v2 offset:0
  ds_read_b128 v[68:71], v2 offset:128
  ds_read_b128 v[72:75], v2 offset:256
  ds_read_b128 v[76:79], v2 offset:384
  ds_read_b128 v[80:83], v2 offset:512
  ds_read_b128 v[84:87], v2 offset:640
  ds_read_b128 v[88:91], v2 offset:768
  ds_read_b128 v[92:95], v1
  v_lshlrev_b32 v20, 16, v24
  v_and_b32 v21, 0xffff0000, v24
  buffer_store_dwordx2 v[20:21], v14, s[16:19], s46 offen sc1
  buffer_store_dwordx2 v[20:21], v14, s[16:19], s45 offen sc1
  s_waitcnt lgkmcnt(7)
  v_smfmac_f32_16x16x64_bf16 v[48:51], v[64:67], v[96:103], v3
  v_xor_b32 v15, 0x400, v15
  v_xor_b32 v2, 0x400, v2
  v_smfmac_f32_16x16x64_bf16 v[52:55], v[64:67], v[104:111], v3
  v_xor_b32 v1, 0x400, v1
  v_xor_b32 v43, 0x400, v43
  v_smfmac_f32_16x16x64_bf16 v[56:59], v[64:67], v[112:119], v3
  s_waitcnt lgkmcnt(0)
  v_smfmac_f32_16x16x64_bf16 v[60:63], v[64:67], v[120:127], v3
  v_lshlrev_b32 v26, 16, v92
  v_and_b32 v27, 0xffff0000, v92
  s_waitcnt lgkmcnt(6)
  v_smfmac_f32_16x16x64_bf16 v[48:51], v[68:71], v[128:135], v3
  v_add_f32 v28, v26, v27
  v_mul_f32 v30, v26, v26
  v_smfmac_f32_16x16x64_bf16 v[52:55], v[68:71], v[136:143], v3
  v_fmac_f32 v30, v27, v27
  v_lshlrev_b32 v26, 16, v93
  v_smfmac_f32_16x16x64_bf16 v[56:59], v[68:71], v[144:151], v3
  v_and_b32 v27, 0xffff0000, v93
  v_add_f32 v28, v28, v26
  v_smfmac_f32_16x16x64_bf16 v[60:63], v[68:71], v[152:159], v3
  v_fmac_f32 v30, v26, v26
  v_add_f32 v28, v28, v27
  s_waitcnt lgkmcnt(5)
  v_smfmac_f32_16x16x64_bf16 v[48:51], v[72:75], v[160:167], v3
  v_fmac_f32 v30, v27, v27
  v_lshlrev_b32 v26, 16, v94
  v_smfmac_f32_16x16x64_bf16 v[52:55], v[72:75], v[168:175], v3
  v_and_b32 v27, 0xffff0000, v94
  v_add_f32 v28, v28, v26
  v_smfmac_f32_16x16x64_bf16 v[56:59], v[72:75], v[176:183], v3
  v_fmac_f32 v30, v26, v26
  v_add_f32 v28, v28, v27
  v_smfmac_f32_16x16x64_bf16 v[60:63], v[72:75], v[184:191], v3
  v_fmac_f32 v30, v27, v27
  v_lshlrev_b32 v26, 16, v95
  s_waitcnt lgkmcnt(4)
  v_smfmac_f32_16x16x64_bf16 v[48:51], v[76:79], v[192:199], v3
  v_and_b32 v27, 0xffff0000, v95
  v_add_f32 v28, v28, v26
  v_smfmac_f32_16x16x64_bf16 v[52:55], v[76:79], v[200:207], v3
  v_fmac_f32 v30, v26, v26
  v_add_f32 v28, v28, v27
  v_smfmac_f32_16x16x64_bf16 v[56:59], v[76:79], v[208:215], v3
  v_fmac_f32 v30, v27, v27
  v_mov_b32 v26, 0x3b124925
  v_smfmac_f32_16x16x64_bf16 v[60:63], v[76:79], v[216:223], v3
  v_mov_b32 v27, 0x3727c5ac
  v_permlane16_swap_b32 v28, v30
  s_waitcnt lgkmcnt(3)
  v_smfmac_f32_16x16x64_bf16 v[48:51], v[80:83], v[224:231], v3
  v_add_f32 v28, v28, v30
  v_smfmac_f32_16x16x64_bf16 v[52:55], v[80:83], v[232:239], v3
  s_nop 0
  v_add_f32_dpp v28, v28, v28 quad_perm:[1,0,3,2] row_mask:0xf bank_mask:0xf
  v_smfmac_f32_16x16x64_bf16 v[56:59], v[80:83], v[240:247], v3
  s_nop 0
  v_add_f32_dpp v28, v28, v28 quad_perm:[2,3,0,1] row_mask:0xf bank_mask:0xf
  v_smfmac_f32_16x16x64_bf16 v[60:63], v[80:83], v[248:255], v3
  s_nop 0
  v_add_f32_dpp v28, v28, v28 row_ror:4 row_mask:0xf bank_mask:0xf
  s_waitcnt lgkmcnt(2)
  v_smfmac_f32_16x16x64_bf16 v[48:51], v[84:87], a[0:7], v3
  v_add_f32_dpp v29, v28, v28 row_ror:8 row_mask:0xf bank_mask:0xf
  v_add_f32_dpp v28, v28, v28 row_ror:8 row_mask:0xf bank_mask:0xf
  v_smfmac_f32_16x16x64_bf16 v[52:55], v[84:87], a[8:15], v3
  s_nop 0
  v_permlane32_swap_b32 v28, v29
  v_smfmac_f32_16x16x64_bf16 v[56:59], v[84:87], a[16:23], v3
  v_add_f32 v28, v28, v29
  v_smfmac_f32_16x16x64_bf16 v[60:63], v[84:87], a[24:31], v3
  v_readlane_b32 s58, v28, 0
  v_readlane_b32 s59, v28, 16
  s_waitcnt lgkmcnt(1)
  v_smfmac_f32_16x16x64_bf16 v[48:51], v[88:91], a[32:39], v3
  v_mul_f32 v24, s58, v26
  v_smfmac_f32_16x16x64_bf16 v[52:55], v[88:91], a[40:47], v3
  v_fmac_f32 v27, s59, v26
  v_fma_f32 v27, -v24, v24, v27
  v_smfmac_f32_16x16x64_bf16 v[56:59], v[88:91], a[48:55], v3
  v_rsq_f32 v25, v27
  v_smfmac_f32_16x16x64_bf16 v[60:63], v[88:91], a[56:63], v3
  v_mul_f32 v21, v24, v36
  s_cmp_eq_u32 s9, 1
  v_add_f32_dpp v20, v48, v49 quad_perm:[0,1,2,3] row_mask:0x1 bank_mask:0xf
  s_nop 0
  v_add_f32_dpp v20, v52, v53 quad_perm:[0,1,2,3] row_mask:0x2 bank_mask:0xf
  s_nop 1
  v_add_f32_dpp v20, v56, v57 quad_perm:[0,1,2,3] row_mask:0x4 bank_mask:0xf
  s_nop 0
  v_add_f32_dpp v20, v60, v61 quad_perm:[0,1,2,3] row_mask:0x8 bank_mask:0xf
  v_sub_f32 v20, v20, v21
  v_mul_f32 v20, v20, v25
  v_cvt_pk_bf16_f32 v20, v20, v20
  v_min_u32 v20, -2, v20
  s_cbranch_scc1 L_Qloc
  buffer_store_short v20, v38, s[16:19], s44 offen sc1
  s_branch L_Qst
L_Qloc:
  buffer_store_short v20, v38, s[16:19], s44 offen
L_Qst:
  s_add_u32 s53, s53, 1
  s_setpc_b64 s[34:35]
L_roleOQ:
  s_lshl_b32 s38, s2, 9
  s_mov_b64 s[20:21], s[70:71]
  s_mov_b32 s22, 0x380000
  s_mov_b32 s23, 0x20000
  s_lshl_b32 s39, s3, 7
  s_add_u32 s38, s38, s39
  v_lshl_add_u32 v44, v4, 13, s38
  v_add_u32 v44, v44, v2
  s_mov_b32 s88, 0x0
  s_mov_b32 s89, 0x20000
  s_mov_b32 s90, 0x4000
  s_mov_b32 s91, 0x24000
  s_mov_b32 s92, 0x40000
  s_mov_b32 s93, 0x60000
  s_mov_b32 s94, 0x44000
  s_mov_b32 s95, 0x64000
  s_add_u32 m0, s98, 0
  s_call_b64 s[96:97], L_dmaQ
  s_mov_b64 s[28:29], s[64:65]
  s_mov_b32 s30, 0xe00
  s_mov_b32 s31, 0x20000
  v_mov_b32 v10, 0x40000000
  v_cmp_gt_u32 vcc, 56, v0
  v_bfe_u32 v7, v0, 2, 2
  v_mul_u32_u24 v7, 896, v7
  v_cndmask_b32 v6, v10, v1, vcc
  buffer_load_dwordx4 v[48:51], v6, s[28:31], 0 offen offset:0
  buffer_load_dwordx4 v[52:55], v6, s[28:31], 0 offen offset:896
  buffer_load_dwordx4 v[56:59], v6, s[28:31], 0 offen offset:1792
  buffer_load_dwordx4 v[60:63], v6, s[28:31], 0 offen offset:2688
  v_add_u32 v7, v7, v2
  s_mov_b32 s38, 0x3f803f80
  s_mov_b32 s39, s38
  v_mov_b64 v[64:65], s[38:39]
  v_mov_b64 v[66:67], s[38:39]
  v_mov_b64 v[68:69], s[38:39]
  v_mov_b64 v[70:71], s[38:39]
  v_mov_b64 v[72:73], s[38:39]
  v_mov_b64 v[74:75], s[38:39]
  v_mov_b64 v[76:77], s[38:39]
  v_mov_b64 v[78:79], s[38:39]
  v_mov_b64 v[80:81], s[38:39]
  v_mov_b64 v[82:83], s[38:39]
  v_mov_b64 v[84:85], s[38:39]
  v_mov_b64 v[86:87], s[38:39]
  v_mov_b64 v[88:89], s[38:39]
  v_mov_b64 v[90:91], s[38:39]
  s_mov_b32 exec_lo, 0x33333333
  s_mov_b32 exec_hi, 0x33333333
  buffer_load_dwordx4 v[64:67], v7, s[28:31], 0 offen offset:0
  buffer_load_dwordx4 v[68:71], v7, s[28:31], 0 offen offset:128
  buffer_load_dwordx4 v[72:75], v7, s[28:31], 0 offen offset:256
  buffer_load_dwordx4 v[76:79], v7, s[28:31], 0 offen offset:384
  buffer_load_dwordx4 v[80:83], v7, s[28:31], 0 offen offset:512
  buffer_load_dwordx4 v[84:87], v7, s[28:31], 0 offen offset:640
  buffer_load_dwordx4 v[88:91], v7, s[28:31], 0 offen offset:768
  s_mov_b64 exec, -1
  s_mov_b64 s[24:25], s[72:73]
  s_mov_b32 s26, 0x380000
  s_mov_b32 s27, 0x20000
  s_lshl_b32 s39, s2, 8
  s_and_b32 s38, s3, 1
  s_lshl_b32 s38, s38, 4
  s_add_u32 s38, s38, s39
  s_and_b32 s39, s3, 2
  s_add_u32 s38, s38, s39
  v_add_u32 v6, s38, v4
  v_mad_u32_u24 v11, v6, s99, v2
  v_lshlrev_b32 v6, 7, v6
  v_sub_u32 v11, v11, v6
  v_and_b32 v6, 1, v0
  v_cmp_eq_u32 vcc, 1, v6
  v_mov_b32 v3, 0x44444444
  v_mov_b32 v6, 0xeeeeeeee
  v_cndmask_b32 v3, v3, v6, vcc
  v_bfe_u32 v9, v0, 0, 5
  v_lshlrev_b32 v9, 3, v9
  v_bfe_u32 v6, v0, 5, 1
  v_lshl_add_u32 v9, v6, 10, v9
  v_mul_u32_u24 v5, 6144, v6
  s_mul_i32 s38, s3, 1792
  v_add3_u32 v5, v5, v9, s38
  s_mov_b32 s57, 0x40000000
  s_mov_b32 s56, 0x40000000
  s_mov_b32 s49, -1
  s_lshl_b32 s38, s3, 13
  v_add_u32 v9, s38, v9
  s_waitcnt vmcnt(19)
  v_mov_b32 v28, 0
  s_cmp_lg_u32 s3, 0
  s_cbranch_scc1 L_rs_296
  s_movk_i32 s38, 0x100
  s_cmp_lg_u32 s7, 0
  s_cbranch_scc1 L_rw_297
  v_readfirstlane_b32 s39, v46
  s_bitcmp1_b32 s39, s101
  s_cbranch_scc0 L_rw_297
  s_call_b64 s[96:97], L_lost
L_rw_297:
  v_mov_b32 v29, s38
  ds_write_b32 v28, v29 offset:4096
  s_waitcnt lgkmcnt(0)
L_rs_296:
  s_barrier
  ds_read_b32 v29, v28 offset:4096
  s_waitcnt lgkmcnt(0)
  v_readfirstlane_b32 s38, v29
  s_cmp_lg_u32 s38, 0x100
  s_cbranch_scc1 L_redo
  v_mov_b32 v20, -1
  v_mov_b32 v21, -1
  v_mov_b32 v22, -1
  v_mov_b32 v23, -1
  s_lshl2_add_u32 s38, s8, s3
  s_mul_i32 s38, s38, 4608
  s_add_u32 s38, s38, 0x10000
  buffer_store_dwordx4 v[20:23], v1, s[16:19], s38 offen offset:0 sc1
  buffer_store_dwordx4 v[20:23], v1, s[16:19], s38 offen offset:1024 sc1
  buffer_store_dwordx4 v[20:23], v1, s[16:19], s38 offen offset:2048 sc1
  buffer_store_dwordx4 v[20:23], v1, s[16:19], s38 offen offset:3072 sc1
  buffer_store_dwordx4 v[20:23], v1, s[16:19], s38 offen offset:3584 sc1
  v_bfe_u32 v28, v0, 0, 5
  v_lshlrev_b32 v28, 4, v28
  v_bfe_u32 v29, v0, 5, 1
  v_lshl_add_u32 v28, v29, 13, v28
  s_lshl_b32 s38, s8, 9
  s_lshl_b32 s39, s3, 14
  s_add_u32 s39, s39, s38
  buffer_store_dwordx4 v[20:23], v28, s[16:19], s39 offen sc1
  s_add_u32 m0, s98, 32768
  s_call_b64 s[96:97], L_dmaQ
  s_waitcnt vmcnt(21)
  v_lshlrev_b32 v26, 16, v48
  v_and_b32 v27, 0xffff0000, v48
  v_add_f32 v28, v26, v27
  v_mul_f32 v30, v26, v26
  v_fmac_f32 v30, v27, v27
  v_lshlrev_b32 v26, 16, v49
  v_and_b32 v27, 0xffff0000, v49
  v_add_f32 v28, v28, v26
  v_fmac_f32 v30, v26, v26
  v_add_f32 v28, v28, v27
  v_fmac_f32 v30, v27, v27
  v_lshlrev_b32 v26, 16, v50
  v_and_b32 v27, 0xffff0000, v50
  v_add_f32 v28, v28, v26
  v_fmac_f32 v30, v26, v26
  v_add_f32 v28, v28, v27
  v_fmac_f32 v30, v27, v27
  v_lshlrev_b32 v26, 16, v51
  v_and_b32 v27, 0xffff0000, v51
  v_add_f32 v28, v28, v26
  v_fmac_f32 v30, v26, v26
  v_add_f32 v28, v28, v27
  v_fmac_f32 v30, v27, v27
  v_mov_b32 v26, 0x3b124925
  v_mov_b32 v27, 0x3727c5ac
  v_permlane16_swap_b32 v28, v30
  v_add_f32 v28, v28, v30
  s_nop 1
  v_add_f32_dpp v28, v28, v28 quad_perm:[1,0,3,2] row_mask:0xf bank_mask:0xf
  s_nop 1
  v_add_f32_dpp v28, v28, v28 quad_perm:[2,3,0,1] row_mask:0xf bank_mask:0xf
  s_nop 1
  v_add_f32_dpp v28, v28, v28 row_ror:4 row_mask:0xf bank_mask:0xf
  s_nop 1
  v_add_f32_dpp v29, v28, v28 row_ror:8 row_mask:0xf bank_mask:0xf
  v_add_f32_dpp v28, v28, v28 row_ror:8 row_mask:0xf bank_mask:0xf
  s_nop 1
  v_permlane32_swap_b32 v28, v29
  v_add_f32 v28, v28, v29
  s_nop 0
  v_readlane_b32 s58, v28, 0
  v_readlane_b32 s59, v28, 16
  s_nop 0
  v_mul_f32 v24, s58, v26
  v_fmac_f32 v27, s59, v26
  v_fma_f32 v27, -v24, v24, v27
  v_rsq_f32 v25, v27
  v_mov_b32_dpp v92, v24 quad_perm:[0,1,2,3] row_mask:0x1 bank_mask:0xf
  s_nop 0
  v_mov_b32_dpp v93, v25 quad_perm:[0,1,2,3] row_mask:0x1 bank_mask:0xf
  v_lshlrev_b32 v26, 16, v52
  v_and_b32 v27, 0xffff0000, v52
  v_add_f32 v28, v26, v27
  v_mul_f32 v30, v26, v26
  v_fmac_f32 v30, v27, v27
  v_lshlrev_b32 v26, 16, v53
  v_and_b32 v27, 0xffff0000, v53
  v_add_f32 v28, v28, v26
  v_fmac_f32 v30, v26, v26
  v_add_f32 v28, v28, v27
  v_fmac_f32 v30, v27, v27
  v_lshlrev_b32 v26, 16, v54
  v_and_b32 v27, 0xffff0000, v54
  v_add_f32 v28, v28, v26
  v_fmac_f32 v30, v26, v26
  v_add_f32 v28, v28, v27
  v_fmac_f32 v30, v27, v27
  v_lshlrev_b32 v26, 16, v55
  v_and_b32 v27, 0xffff0000, v55
  v_add_f32 v28, v28, v26
  v_fmac_f32 v30, v26, v26
  v_add_f32 v28, v28, v27
  v_fmac_f32 v30, v27, v27
  v_mov_b32 v26, 0x3b124925
  v_mov_b32 v27, 0x3727c5ac
  v_permlane16_swap_b32 v28, v30
  v_add_f32 v28, v28, v30
  s_nop 1
  v_add_f32_dpp v28, v28, v28 quad_perm:[1,0,3,2] row_mask:0xf bank_mask:0xf
  s_nop 1
  v_add_f32_dpp v28, v28, v28 quad_perm:[2,3,0,1] row_mask:0xf bank_mask:0xf
  s_nop 1
  v_add_f32_dpp v28, v28, v28 row_ror:4 row_mask:0xf bank_mask:0xf
  s_nop 1
  v_add_f32_dpp v29, v28, v28 row_ror:8 row_mask:0xf bank_mask:0xf
  v_add_f32_dpp v28, v28, v28 row_ror:8 row_mask:0xf bank_mask:0xf
  s_nop 1
  v_permlane32_swap_b32 v28, v29
  v_add_f32 v28, v28, v29
  s_nop 0
  v_readlane_b32 s58, v28, 0
  v_readlane_b32 s59, v28, 16
  s_nop 0
  v_mul_f32 v24, s58, v26
  v_fmac_f32 v27, s59, v26
  v_fma_f32 v27, -v24, v24, v27
  v_rsq_f32 v25, v27
  v_mov_b32_dpp v92, v24 quad_perm:[0,1,2,3] row_mask:0x2 bank_mask:0xf
  s_nop 0
  v_mov_b32_dpp v93, v25 quad_perm:[0,1,2,3] row_mask:0x2 bank_mask:0xf
  v_lshlrev_b32 v26, 16, v56
  v_and_b32 v27, 0xffff0000, v56
  v_add_f32 v28, v26, v27
  v_mul_f32 v30, v26, v26
  v_fmac_f32 v30, v27, v27
  v_lshlrev_b32 v26, 16, v57
  v_and_b32 v27, 0xffff0000, v57
  v_add_f32 v28, v28, v26
  v_fmac_f32 v30, v26, v26
  v_add_f32 v28, v28, v27
  v_fmac_f32 v30, v27, v27
  v_lshlrev_b32 v26, 16, v58
  v_and_b32 v27, 0xffff0000, v58
  v_add_f32 v28, v28, v26
  v_fmac_f32 v30, v26, v26
  v_add_f32 v28, v28, v27
  v_fmac_f32 v30, v27, v27
  v_lshlrev_b32 v26, 16, v59
  v_and_b32 v27, 0xffff0000, v59
  v_add_f32 v28, v28, v26
  v_fmac_f32 v30, v26, v26
  v_add_f32 v28, v28, v27
  v_fmac_f32 v30, v27, v27
  v_mov_b32 v26, 0x3b124925
  v_mov_b32 v27, 0x3727c5ac
  v_permlane16_swap_b32 v28, v30
  v_add_f32 v28, v28, v30
  s_nop 1
  v_add_f32_dpp v28, v28, v28 quad_perm:[1,0,3,2] row_mask:0xf bank_mask:0xf
  s_nop 1
  v_add_f32_dpp v28, v28, v28 quad_perm:[2,3,0,1] row_mask:0xf bank_mask:0xf
  s_nop 1
  v_add_f32_dpp v28, v28, v28 row_ror:4 row_mask:0xf bank_mask:0xf
  s_nop 1
  v_add_f32_dpp v29, v28, v28 row_ror:8 row_mask:0xf bank_mask:0xf
  v_add_f32_dpp v28, v28, v28 row_ror:8 row_mask:0xf bank_mask:0xf
  s_nop 1
  v_permlane32_swap_b32 v28, v29
  v_add_f32 v28, v28, v29
  s_nop 0
  v_readlane_b32 s58, v28, 0
  v_readlane_b32 s59, v28, 16
  s_nop 0
  v_mul_f32 v24, s58, v26
  v_fmac_f32 v27, s59, v26
  v_fma_f32 v27, -v24, v24, v27
  v_rsq_f32 v25, v27
  v_mov_b32_dpp v92, v24 quad_perm:[0,1,2,3] row_mask:0x4 bank_mask:0xf
  s_nop 0
  v_mov_b32_dpp v93, v25 quad_perm:[0,1,2,3] row_mask:0x4 bank_mask:0xf
  v_lshlrev_b32 v26, 16, v60
  v_and_b32 v27, 0xffff0000, v60
  v_add_f32 v28, v26, v27
  v_mul_f32 v30, v26, v26
  v_fmac_f32 v30, v27, v27
  v_lshlrev_b32 v26, 16, v61
  v_and_b32 v27, 0xffff0000, v61
  v_add_f32 v28, v28, v26
  v_fmac_f32 v30, v26, v26
  v_add_f32 v28, v28, v27
  v_fmac_f32 v30, v27, v27
  v_lshlrev_b32 v26, 16, v62
  v_and_b32 v27, 0xffff0000, v62
  v_add_f32 v28, v28, v26
  v_fmac_f32 v30, v26, v26
  v_add_f32 v28, v28, v27
  v_fmac_f32 v30, v27, v27
  v_lshlrev_b32 v26, 16, v63
  v_and_b32 v27, 0xffff0000, v63
  v_add_f32 v28, v28, v26
  v_fmac_f32 v30, v26, v26
  v_add_f32 v28, v28, v27
  v_fmac_f32 v30, v27, v27
  v_mov_b32 v26, 0x3b124925
  v_mov_b32 v27, 0x3727c5ac
  v_permlane16_swap_b32 v28, v30
  v_add_f32 v28, v28, v30
  s_nop 1
  v_add_f32_dpp v28, v28, v28 quad_perm:[1,0,3,2] row_mask:0xf bank_mask:0xf
  s_nop 1
  v_add_f32_dpp v28, v28, v28 quad_perm:[2,3,0,1] row_mask:0xf bank_mask:0xf
  s_nop 1
  v_add_f32_dpp v28, v28, v28 row_ror:4 row_mask:0xf bank_mask:0xf
  s_nop 1
  v_add_f32_dpp v29, v28, v28 row_ror:8 row_mask:0xf bank_mask:0xf
  v_add_f32_dpp v28, v28, v28 row_ror:8 row_mask:0xf bank_mask:0xf
  s_nop 1
  v_permlane32_swap_b32 v28, v29
  v_add_f32 v28, v28, v29
  s_nop 0
  v_readlane_b32 s58, v28, 0
  v_readlane_b32 s59, v28, 16
  s_nop 0
  v_mul_f32 v24, s58, v26
  v_fmac_f32 v27, s59, v26
  v_fma_f32 v27, -v24, v24, v27
  v_rsq_f32 v25, v27
  v_mov_b32_dpp v92, v24 quad_perm:[0,1,2,3] row_mask:0x8 bank_mask:0xf
  s_nop 0
  v_mov_b32_dpp v93, v25 quad_perm:[0,1,2,3] row_mask:0x8 bank_mask:0xf
  s_waitcnt vmcnt(8)
  s_barrier
  s_cmp_lg_u32 s3, 0
  s_cbranch_scc1 L_sg_298
  s_mov_b64 exec, 1
  v_mov_b32 v28, 0
  v_mov_b32 v29, s9
  global_atomic_add v28, v29, s[84:85] offset:16 sc1
  s_mov_b64 exec, -1
L_sg_298:
  s_add_u32 m0, s98, 65536
  s_call_b64 s[96:97], L_dmaQ
  s_add_u32 m0, s98, 98304
  s_call_b64 s[96:97], L_dmaQ
  v_mov_b64 v[48:49], 0
  v_mov_b64 v[50:51], 0
  v_mov_b64 v[52:53], 0
  v_mov_b64 v[54:55], 0
  v_mov_b64 v[56:57], 0
  v_mov_b64 v[58:59], 0
  v_mov_b64 v[60:61], 0
  v_mov_b64 v[62:63], 0
  v_bfe_u32 v94, v0, 0, 1
  v_lshlrev_b32 v94, 1, v94
  v_bfe_u32 v6, v0, 2, 1
  v_lshl_add_u32 v94, v6, 2, v94
  v_bfe_u32 v6, v0, 3, 1
  v_lshl_add_u32 v94, v6, 4, v94
  v_bfe_u32 v6, v0, 1, 1
  v_lshl_add_u32 v94, v6, 5, v94
  v_bfe_u32 v6, v0, 4, 2
  v_lshl_add_u32 v94, v6, 13, v94
  s_lshl_b32 s38, s3, 7
  s_lshl_b32 s44, s2, 9
  s_add_u32 s44, s38, s44
  s_waitcnt lgkmcnt(0)
  s_barrier
  v_add_u32 v6, 8192, v9
  ds_read_b64_tr_b16 v[96:97], v6 offset:0
  ds_read_b64_tr_b16 v[98:99], v6 offset:2048
  ds_read_b64_tr_b16 v[100:101], v6 offset:4096
  ds_read_b64_tr_b16 v[102:103], v6 offset:6144
  ds_read_b64_tr_b16 v[104:105], v6 offset:256
  ds_read_b64_tr_b16 v[106:107], v6 offset:2304
  ds_read_b64_tr_b16 v[108:109], v6 offset:4352
  ds_read_b64_tr_b16 v[110:111], v6 offset:6400
  ds_read_b64_tr_b16 v[112:113], v6 offset:512
  ds_read_b64_tr_b16 v[114:115], v6 offset:2560
  ds_read_b64_tr_b16 v[116:117], v6 offset:4608
  ds_read_b64_tr_b16 v[118:119], v6 offset:6656
  ds_read_b64_tr_b16 v[120:121], v6 offset:768
  ds_read_b64_tr_b16 v[122:123], v6 offset:2816
  ds_read_b64_tr_b16 v[124:125], v6 offset:4864
  ds_read_b64_tr_b16 v[126:127], v6 offset:6912
  s_waitcnt vmcnt(16)
  s_waitcnt lgkmcnt(0)
  s_barrier
  s_add_u32 m0, s98, 0
  s_call_b64 s[96:97], L_dmaQ
  v_add_u32 v6, 40960, v9
  ds_read_b64_tr_b16 v[128:129], v6 offset:0
  ds_read_b64_tr_b16 v[130:131], v6 offset:2048
  ds_read_b64_tr_b16 v[132:133], v6 offset:4096
  ds_read_b64_tr_b16 v[134:135], v6 offset:6144
  ds_read_b64_tr_b16 v[136:137], v6 offset:256
  ds_read_b64_tr_b16 v[138:139], v6 offset:2304
  ds_read_b64_tr_b16 v[140:141], v6 offset:4352
  ds_read_b64_tr_b16 v[142:143], v6 offset:6400
  ds_read_b64_tr_b16 v[144:145], v6 offset:512
  ds_read_b64_tr_b16 v[146:147], v6 offset:2560
  ds_read_b64_tr_b16 v[148:149], v6 offset:4608
  ds_read_b64_tr_b16 v[150:151], v6 offset:6656
  ds_read_b64_tr_b16 v[152:153], v6 offset:768
  ds_read_b64_tr_b16 v[154:155], v6 offset:2816
  ds_read_b64_tr_b16 v[156:157], v6 offset:4864
  ds_read_b64_tr_b16 v[158:159], v6 offset:6912
  v_smfmac_f32_16x16x64_bf16 v[48:51], v[64:67], v[96:103], v3
  v_smfmac_f32_16x16x64_bf16 v[52:55], v[64:67], v[104:111], v3
  v_smfmac_f32_16x16x64_bf16 v[56:59], v[64:67], v[112:119], v3
  v_smfmac_f32_16x16x64_bf16 v[60:63], v[64:67], v[120:127], v3
  s_waitcnt vmcnt(16)
  s_waitcnt lgkmcnt(0)
  s_barrier
  s_add_u32 m0, s98, 32768
  s_call_b64 s[96:97], L_dmaQ
  v_add_u32 v6, 73728, v9
  ds_read_b64_tr_b16 v[160:161], v6 offset:0
  ds_read_b64_tr_b16 v[162:163], v6 offset:2048
  ds_read_b64_tr_b16 v[164:165], v6 offset:4096
  ds_read_b64_tr_b16 v[166:167], v6 offset:6144
  ds_read_b64_tr_b16 v[168:169], v6 offset:256
  ds_read_b64_tr_b16 v[170:171], v6 offset:2304
  ds_read_b64_tr_b16 v[172:173], v6 offset:4352
  ds_read_b64_tr_b16 v[174:175], v6 offset:6400
  ds_read_b64_tr_b16 v[176:177], v6 offset:512
  ds_read_b64_tr_b16 v[178:179], v6 offset:2560
  ds_read_b64_tr_b16 v[180:181], v6 offset:4608
  ds_read_b64_tr_b16 v[182:183], v6 offset:6656
  ds_read_b64_tr_b16 v[184:185], v6 offset:768
  ds_read_b64_tr_b16 v[186:187], v6 offset:2816
  ds_read_b64_tr_b16 v[188:189], v6 offset:4864
  ds_read_b64_tr_b16 v[190:191], v6 offset:6912
  v_smfmac_f32_16x16x64_bf16 v[48:51], v[68:71], v[128:135], v3
  v_smfmac_f32_16x16x64_bf16 v[52:55], v[68:71], v[136:143], v3
  v_smfmac_f32_16x16x64_bf16 v[56:59], v[68:71], v[144:151], v3
  v_smfmac_f32_16x16x64_bf16 v[60:63], v[68:71], v[152:159], v3
  s_waitcnt vmcnt(16)
  s_waitcnt lgkmcnt(0)
  s_barrier
  s_add_u32 m0, s98, 65536
  s_call_b64 s[96:97], L_dmaQ
  v_add_u32 v6, 106496, v9
  ds_read_b64_tr_b16 v[192:193], v6 offset:0
  ds_read_b64_tr_b16 v[194:195], v6 offset:2048
  ds_read_b64_tr_b16 v[196:197], v6 offset:4096
  ds_read_b64_tr_b16 v[198:199], v6 offset:6144
  ds_read_b64_tr_b16 v[200:201], v6 offset:256
  ds_read_b64_tr_b16 v[202:203], v6 offset:2304
  ds_read_b64_tr_b16 v[204:205], v6 offset:4352
  ds_read_b64_tr_b16 v[206:207], v6 offset:6400
  ds_read_b64_tr_b16 v[208:209], v6 offset:512
  ds_read_b64_tr_b16 v[210:211], v6 offset:2560
  ds_read_b64_tr_b16 v[212:213], v6 offset:4608
  ds_read_b64_tr_b16 v[214:215], v6 offset:6656
  ds_read_b64_tr_b16 v[216:217], v6 offset:768
  ds_read_b64_tr_b16 v[218:219], v6 offset:2816
  ds_read_b64_tr_b16 v[220:221], v6 offset:4864
  ds_read_b64_tr_b16 v[222:223], v6 offset:6912
  v_smfmac_f32_16x16x64_bf16 v[48:51], v[72:75], v[160:167], v3
  v_smfmac_f32_16x16x64_bf16 v[52:55], v[72:75], v[168:175], v3
  v_smfmac_f32_16x16x64_bf16 v[56:59], v[72:75], v[176:183], v3
  v_smfmac_f32_16x16x64_bf16 v[60:63], v[72:75], v[184:191], v3
  s_waitcnt vmcnt(16)
  s_waitcnt lgkmcnt(0)
  s_barrier
  s_add_u32 m0, s32, 98304
  s_call_b64 s[96:97], L_dmaO
  v_add_u32 v6, 8192, v9
  ds_read_b64_tr_b16 v[224:225], v6 offset:0
  ds_read_b64_tr_b16 v[226:227], v6 offset:2048
  ds_read_b64_tr_b16 v[228:229], v6 offset:4096
  ds_read_b64_tr_b16 v[230:231], v6 offset:6144
  ds_read_b64_tr_b16 v[232:233], v6 offset:256
  ds_read_b64_tr_b16 v[234:235], v6 offset:2304
  ds_read_b64_tr_b16 v[236:237], v6 offset:4352
  ds_read_b64_tr_b16 v[238:239], v6 offset:6400
  ds_read_b64_tr_b16 v[240:241], v6 offset:512
  ds_read_b64_tr_b16 v[242:243], v6 offset:2560
  ds_read_b64_tr_b16 v[244:245], v6 offset:4608
  ds_read_b64_tr_b16 v[246:247], v6 offset:6656
  ds_read_b64_tr_b16 v[248:249], v6 offset:768
  ds_read_b64_tr_b16 v[250:251], v6 offset:2816
  ds_read_b64_tr_b16 v[252:253], v6 offset:4864
  ds_read_b64_tr_b16 v[254:255], v6 offset:6912
  v_smfmac_f32_16x16x64_bf16 v[48:51], v[76:79], v[192:199], v3
  v_smfmac_f32_16x16x64_bf16 v[52:55], v[76:79], v[200:207], v3
  v_smfmac_f32_16x16x64_bf16 v[56:59], v[76:79], v[208:215], v3
  v_smfmac_f32_16x16x64_bf16 v[60:63], v[76:79], v[216:223], v3
  s_waitcnt vmcnt(15)
  s_waitcnt lgkmcnt(0)
  s_barrier
  v_add_u32 v6, 40960, v9
  ds_read_b64_tr_b16 a[0:1], v6 offset:0
  ds_read_b64_tr_b16 a[2:3], v6 offset:2048
  ds_read_b64_tr_b16 a[4:5], v6 offset:4096
  ds_read_b64_tr_b16 a[6:7], v6 offset:6144
  ds_read_b64_tr_b16 a[8:9], v6 offset:256
  ds_read_b64_tr_b16 a[10:11], v6 offset:2304
  ds_read_b64_tr_b16 a[12:13], v6 offset:4352
  ds_read_b64_tr_b16 a[14:15], v6 offset:6400
  ds_read_b64_tr_b16 a[16:17], v6 offset:512
  ds_read_b64_tr_b16 a[18:19], v6 offset:2560
  ds_read_b64_tr_b16 a[20:21], v6 offset:4608
  ds_read_b64_tr_b16 a[22:23], v6 offset:6656
  ds_read_b64_tr_b16 a[24:25], v6 offset:768
  ds_read_b64_tr_b16 a[26:27], v6 offset:2816
  ds_read_b64_tr_b16 a[28:29], v6 offset:4864
  ds_read_b64_tr_b16 a[30:31], v6 offset:6912
  v_smfmac_f32_16x16x64_bf16 v[48:51], v[80:83], v[224:231], v3
  v_smfmac_f32_16x16x64_bf16 v[52:55], v[80:83], v[232:239], v3
  v_smfmac_f32_16x16x64_bf16 v[56:59], v[80:83], v[240:247], v3
  v_smfmac_f32_16x16x64_bf16 v[60:63], v[80:83], v[248:255], v3
  s_waitcnt vmcnt(7)
  s_waitcnt lgkmcnt(0)
  s_barrier
  v_add_u32 v6, 73728, v9
  ds_read_b64_tr_b16 a[32:33], v6 offset:0
  ds_read_b64_tr_b16 a[34:35], v6 offset:2048
  ds_read_b64_tr_b16 a[36:37], v6 offset:4096
  ds_read_b64_tr_b16 a[38:39], v6 offset:6144
  ds_read_b64_tr_b16 a[40:41], v6 offset:256
  ds_read_b64_tr_b16 a[42:43], v6 offset:2304
  ds_read_b64_tr_b16 a[44:45], v6 offset:4352
  ds_read_b64_tr_b16 a[46:47], v6 offset:6400
  ds_read_b64_tr_b16 a[48:49], v6 offset:512
  ds_read_b64_tr_b16 a[50:51], v6 offset:2560
  ds_read_b64_tr_b16 a[52:53], v6 offset:4608
  ds_read_b64_tr_b16 a[54:55], v6 offset:6656
  ds_read_b64_tr_b16 a[56:57], v6 offset:768
  ds_read_b64_tr_b16 a[58:59], v6 offset:2816
  ds_read_b64_tr_b16 a[60:61], v6 offset:4864
  ds_read_b64_tr_b16 a[62:63], v6 offset:6912
  v_smfmac_f32_16x16x64_bf16 v[48:51], v[84:87], a[0:7], v3
  v_smfmac_f32_16x16x64_bf16 v[52:55], v[84:87], a[8:15], v3
  v_smfmac_f32_16x16x64_bf16 v[56:59], v[84:87], a[16:23], v3
  v_smfmac_f32_16x16x64_bf16 v[60:63], v[84:87], a[24:31], v3
  s_waitcnt lgkmcnt(0)
  v_smfmac_f32_16x16x64_bf16 v[48:51], v[88:91], a[32:39], v3
  v_smfmac_f32_16x16x64_bf16 v[52:55], v[88:91], a[40:47], v3
  v_smfmac_f32_16x16x64_bf16 v[56:59], v[88:91], a[48:55], v3
  v_smfmac_f32_16x16x64_bf16 v[60:63], v[88:91], a[56:63], v3
  s_nop 5
  v_add_f32 v20, v48, v49
  v_add_f32 v24, v50, v51
  v_add_f32 v21, v52, v53
  v_add_f32 v25, v54, v55
  v_add_f32 v22, v56, v57
  v_add_f32 v26, v58, v59
  v_add_f32 v23, v60, v61
  v_add_f32 v27, v62, v63
  v_fma_f32 v20, -v92, v24, v20
  v_fma_f32 v21, -v92, v25, v21
  v_fma_f32 v22, -v92, v26, v22
  v_fma_f32 v23, -v92, v27, v23
  v_mul_f32 v20, v20, v93
  v_mul_f32 v21, v21, v93
  v_mul_f32 v22, v22, v93
  v_mul_f32 v23, v23, v93
  v_cvt_pk_bf16_f32 v20, v20, v20
  v_cvt_pk_bf16_f32 v21, v21, v21
  v_cvt_pk_bf16_f32 v22, v22, v22
  v_cvt_pk_bf16_f32 v23, v23, v23
  v_min_u32 v20, -2, v20
  v_min_u32 v21, -2, v21
  v_min_u32 v22, -2, v22
  v_min_u32 v23, -2, v23
  buffer_store_short v20, v94, s[16:19], s44 offen offset:0 sc1
  buffer_store_short v21, v94, s[16:19], s44 offen offset:8 sc1
  buffer_store_short v22, v94, s[16:19], s44 offen offset:64 sc1
  buffer_store_short v23, v94, s[16:19], s44 offen offset:72 sc1
  v_mov_b32_dpp v36, v24 quad_perm:[0,1,2,3] row_mask:0x1 bank_mask:0xf
  v_mov_b32_dpp v36, v25 quad_perm:[0,1,2,3] row_mask:0x2 bank_mask:0xf
  v_mov_b32_dpp v36, v26 quad_perm:[0,1,2,3] row_mask:0x4 bank_mask:0xf
  v_mov_b32_dpp v36, v27 quad_perm:[0,1,2,3] row_mask:0x8 bank_mask:0xf
  s_add_u32 m0, s32, 0
  s_call_b64 s[96:97], L_dmaO
  s_add_u32 m0, s32, 32768
  s_call_b64 s[96:97], L_dmaO
  s_mov_b32 s55, 0
  s_lshl_b32 s41, s2, 15
  s_add_u32 s41, s41, 0x800000
  s_lshl_b32 s11, s3, 11
  s_add_u32 s11, s11, s41
  s_add_u32 s11, s11, 524288
  v_mov_b32 v10, 0x40000000
  v_bfe_u32 v6, v0, 0, 4
  v_lshlrev_b32 v6, 3, v6
  v_bfe_u32 v7, v0, 4, 1
  v_lshl_add_u32 v6, v7, 2, v6
  v_bfe_u32 v7, v0, 5, 1
  v_lshl_add_u32 v6, v7, 7, v6
  s_mul_i32 s38, s3, 224
  s_lshl_b32 s39, s3, 5
  s_add_u32 s39, s39, 672
  v_cmp_gt_u32 vcc, 224, v6
  v_add_u32 v15, s38, v6
  v_add_u32 v6, s39, v6
  v_cndmask_b32 v12, v10, v15, vcc
  v_cndmask_b32 v15, v6, v15, vcc
  s_lshl_b32 s38, s3, 9
  v_lshl_add_u32 v14, v0, 3, s38
  v_cndmask_b32 v14, v10, v14, vcc
  v_bfe_u32 v13, v0, 0, 4
  v_lshlrev_b32 v13, 4, v13
  v_bfe_u32 v6, v0, 4, 1
  v_lshl_add_u32 v13, v6, 12, v13
  v_bfe_u32 v6, v0, 5, 1
  v_lshl_add_u32 v13, v6, 14, v13
  s_lshl_b32 s38, s3, 8
  v_add_u32 v13, s38, v13
  v_lshl_add_u32 v39, v0, 2, s38
  v_cmp_gt_u32 vcc, 48, v0
  v_mov_b32 v18, 0
  v_mov_b32 v19, 0
  v_cndmask_b32 v8, v10, v13, vcc
  v_and_b32 v6, 8, v0
  v_cmp_eq_u32 vcc, 8, v6
  v_mov_b32 v6, 0x3c00
  v_mov_b32 v7, 0x3c000000
  v_cndmask_b32 v6, v6, v7, vcc
  v_and_b32 v7, 7, v0
  v_cmp_eq_u32 vcc, 0, v7
  s_nop 1
  v_cndmask_b32 v32, 0, v6, vcc
  v_cmp_eq_u32 vcc, 1, v7
  s_nop 1
  v_cndmask_b32 v33, 0, v6, vcc
  v_cmp_eq_u32 vcc, 4, v7
  s_nop 1
  v_cndmask_b32 v34, 0, v6, vcc
  v_cmp_eq_u32 vcc, 5, v7
  s_nop 1
  v_cndmask_b32 v35, 0, v6, vcc
  s_lshl_b32 s40, s2, 10
  s_and_b32 s38, s40, 0x2000
  s_add_u32 s40, s40, s38
  s_add_u32 s40, s40, 0x10000
  v_bfe_u32 v40, v0, 0, 4
  v_lshlrev_b32 v40, 3, v40
  v_bfe_u32 v6, v0, 4, 2
  v_lshl_add_u32 v40, v6, 9, v40
  s_lshl_b32 s38, s3, 7
  v_add_u32 v40, s38, v40
  v_cmp_gt_u32 vcc, 32, v0
  v_lshrrev_b32 v6, 4, v0
  v_bfe_u32 v7, v0, 2, 2
  v_cndmask_b32 v41, v10, v40, vcc
  v_add_u32 v6, v6, v7
  v_and_b32 v6, 3, v6
  v_and_b32 v7, 3, v0
  v_lshl_add_u32 v6, v7, 2, v6
  v_cmp_gt_u32 s[42:43], 14, v6
  v_min_u32 v6, 13, v6
  v_mul_u32_u24 v42, 8, v6
  v_add_u32 v42, 7168, v42
  v_bfe_u32 v43, v0, 4, 2
  v_lshlrev_b32 v43, 1, v43
  v_bfe_u32 v6, v0, 0, 3
  v_lshl_add_u32 v43, v6, 4, v43
  v_bfe_u32 v6, v0, 3, 1
  v_lshl_add_u32 v43, v6, 8, v43
  s_lshr_b32 s38, s3, 1
  s_lshl_b32 s38, s38, 7
  s_and_b32 s39, s3, 1
  s_lshl_b32 s39, s39, 3
  s_add_u32 s38, s38, s39
  v_add_u32 v43, s38, v43
  v_bfe_u32 v38, v0, 0, 1
  v_lshlrev_b32 v38, 1, v38
  v_bfe_u32 v6, v0, 2, 1
  v_lshl_add_u32 v38, v6, 2, v38
  v_bfe_u32 v6, v0, 4, 1
  v_lshl_add_u32 v38, v6, 3, v38
  v_bfe_u32 v6, v0, 3, 1
  v_lshl_add_u32 v38, v6, 4, v38
  v_bfe_u32 v6, v0, 1, 1
  v_lshl_add_u32 v38, v6, 5, v38
  v_bfe_u32 v6, v0, 5, 1
  v_lshl_add_u32 v38, v6, 6, v38
  s_lshl_b32 s38, s3, 7
  v_add_u32 v38, s38, v38
  s_cmp_eq_u32 s2, 0
  s_cselect_b32 s33, 0x96000, s57
  s_mov_b32 s53, 3
  s_mov_b32 s54, 0x40000000
  s_waitcnt vmcnt(18)
  s_waitcnt lgkmcnt(0)
  s_barrier
  v_add_u32 v6, 106496, v5
  ds_read_b64_tr_b16 a[64:65], v6 offset:0
  ds_read_b64_tr_b16 a[66:67], v6 offset:14336
  ds_read_b64_tr_b16 a[88:89], v6 offset:256
  ds_read_b64_tr_b16 a[90:91], v6 offset:14592
  ds_read_b64_tr_b16 a[112:113], v6 offset:512
  ds_read_b64_tr_b16 a[114:115], v6 offset:14848
  ds_read_b64_tr_b16 a[136:137], v6 offset:768
  ds_read_b64_tr_b16 a[138:139], v6 offset:15104
  ds_read_b64_tr_b16 a[160:161], v6 offset:1024
  ds_read_b64_tr_b16 a[162:163], v6 offset:15360
  ds_read_b64_tr_b16 a[184:185], v6 offset:1280
  ds_read_b64_tr_b16 a[186:187], v6 offset:15616
  ds_read_b64_tr_b16 a[208:209], v6 offset:1536
  ds_read_b64_tr_b16 a[210:211], v6 offset:15872
  s_waitcnt vmcnt(7)
  s_waitcnt lgkmcnt(0)
  s_barrier
  s_add_u32 m0, s32, 98304
  s_call_b64 s[96:97], L_dmaO
  v_add_u32 v6, 8192, v5
  ds_read_b64_tr_b16 a[68:69], v6 offset:0
  ds_read_b64_tr_b16 a[70:71], v6 offset:14336
  ds_read_b64_tr_b16 a[92:93], v6 offset:256
  ds_read_b64_tr_b16 a[94:95], v6 offset:14592
  ds_read_b64_tr_b16 a[116:117], v6 offset:512
  ds_read_b64_tr_b16 a[118:119], v6 offset:14848
  ds_read_b64_tr_b16 a[140:141], v6 offset:768
  ds_read_b64_tr_b16 a[142:143], v6 offset:15104
  ds_read_b64_tr_b16 a[164:165], v6 offset:1024
  ds_read_b64_tr_b16 a[166:167], v6 offset:15360
  ds_read_b64_tr_b16 a[188:189], v6 offset:1280
  ds_read_b64_tr_b16 a[190:191], v6 offset:15616
  ds_read_b64_tr_b16 a[212:213], v6 offset:1536
  ds_read_b64_tr_b16 a[214:215], v6 offset:15872
  s_call_b64 s[34:35], L_Osub
  s_waitcnt vmcnt(7)
  s_waitcnt lgkmcnt(0)
  s_barrier
  s_add_u32 m0, s32, 0
  s_call_b64 s[96:97], L_dmaO
  v_add_u32 v6, 40960, v5
  ds_read_b64_tr_b16 a[72:73], v6 offset:0
  ds_read_b64_tr_b16 a[74:75], v6 offset:14336
  ds_read_b64_tr_b16 a[96:97], v6 offset:256
  ds_read_b64_tr_b16 a[98:99], v6 offset:14592
  ds_read_b64_tr_b16 a[120:121], v6 offset:512
  ds_read_b64_tr_b16 a[122:123], v6 offset:14848
  ds_read_b64_tr_b16 a[144:145], v6 offset:768
  ds_read_b64_tr_b16 a[146:147], v6 offset:15104
  ds_read_b64_tr_b16 a[168:169], v6 offset:1024
  ds_read_b64_tr_b16 a[170:171], v6 offset:15360
  ds_read_b64_tr_b16 a[192:193], v6 offset:1280
  ds_read_b64_tr_b16 a[194:195], v6 offset:15616
  ds_read_b64_tr_b16 a[216:217], v6 offset:1536
  ds_read_b64_tr_b16 a[218:219], v6 offset:15872
  s_call_b64 s[34:35], L_Qsub
  s_lshl_b32 s54, s2, 9
  s_waitcnt vmcnt(7)
  s_waitcnt lgkmcnt(0)
  s_barrier
  s_add_u32 m0, s32, 32768
  s_call_b64 s[96:97], L_dmaO
  v_add_u32 v6, 106496, v5
  ds_read_b64_tr_b16 a[76:77], v6 offset:0
  ds_read_b64_tr_b16 a[78:79], v6 offset:14336
  ds_read_b64_tr_b16 a[100:101], v6 offset:256
  ds_read_b64_tr_b16 a[102:103], v6 offset:14592
  ds_read_b64_tr_b16 a[124:125], v6 offset:512
  ds_read_b64_tr_b16 a[126:127], v6 offset:14848
  ds_read_b64_tr_b16 a[148:149], v6 offset:768
  ds_read_b64_tr_b16 a[150:151], v6 offset:15104
  ds_read_b64_tr_b16 a[172:173], v6 offset:1024
  ds_read_b64_tr_b16 a[174:175], v6 offset:15360
  ds_read_b64_tr_b16 a[196:197], v6 offset:1280
  ds_read_b64_tr_b16 a[198:199], v6 offset:15616
  ds_read_b64_tr_b16 a[220:221], v6 offset:1536
  ds_read_b64_tr_b16 a[222:223], v6 offset:15872
  s_waitcnt vmcnt(7)
  s_waitcnt lgkmcnt(0)
  s_barrier
  global_load_dwordx2 v[46:47], v18, s[84:85] offset:16 sc1
  s_add_u32 m0, s32, 98304
  s_call_b64 s[96:97], L_dmaO
  v_add_u32 v6, 8192, v5
  ds_read_b64_tr_b16 a[80:81], v6 offset:0
  ds_read_b64_tr_b16 a[82:83], v6 offset:14336
  ds_read_b64_tr_b16 a[104:105], v6 offset:256
  ds_read_b64_tr_b16 a[106:107], v6 offset:14592
  ds_read_b64_tr_b16 a[128:129], v6 offset:512
  ds_read_b64_tr_b16 a[130:131], v6 offset:14848
  ds_read_b64_tr_b16 a[152:153], v6 offset:768
  ds_read_b64_tr_b16 a[154:155], v6 offset:15104
  ds_read_b64_tr_b16 a[176:177], v6 offset:1024
  ds_read_b64_tr_b16 a[178:179], v6 offset:15360
  ds_read_b64_tr_b16 a[200:201], v6 offset:1280
  ds_read_b64_tr_b16 a[202:203], v6 offset:15616
  ds_read_b64_tr_b16 a[224:225], v6 offset:1536
  ds_read_b64_tr_b16 a[226:227], v6 offset:15872
  s_waitcnt vmcnt(8)
  s_waitcnt lgkmcnt(0)
  s_barrier
  s_add_u32 m0, s32, 0
  s_call_b64 s[96:97], L_dmaO
  v_add_u32 v6, 40960, v5
  ds_read_b64_tr_b16 a[84:85], v6 offset:0
  ds_read_b64_tr_b16 a[86:87], v6 offset:14336
  ds_read_b64_tr_b16 a[108:109], v6 offset:256
  ds_read_b64_tr_b16 a[110:111], v6 offset:14592
  ds_read_b64_tr_b16 a[132:133], v6 offset:512
  ds_read_b64_tr_b16 a[134:135], v6 offset:14848
  ds_read_b64_tr_b16 a[156:157], v6 offset:768
  ds_read_b64_tr_b16 a[158:159], v6 offset:15104
  ds_read_b64_tr_b16 a[180:181], v6 offset:1024
  ds_read_b64_tr_b16 a[182:183], v6 offset:15360
  ds_read_b64_tr_b16 a[204:205], v6 offset:1280
  ds_read_b64_tr_b16 a[206:207], v6 offset:15616
  ds_read_b64_tr_b16 a[228:229], v6 offset:1536
  ds_read_b64_tr_b16 a[230:231], v6 offset:15872
  s_waitcnt vmcnt(14)
  s_branch L_cntc_300
L_cnt_299:
  s_sub_u32 s52, s52, 1
  s_cbranch_scc1 L_bail
  global_load_dword v46, v18, s[84:85] offset:16 sc1
  s_waitcnt vmcnt(0)
L_cntc_300:
  v_and_b32 v22, 0xff, v46
  v_cmp_gt_u32 vcc, 32, v22
  s_cbranch_vccnz L_cnt_299
  s_mov_b32 s56, 0
  s_movk_i32 s57, 0x2000
  v_readfirstlane_b32 s38, v47
  s_getreg_b32 s10, hwreg(HW_REG_XCC_ID, 2, 1)
  s_xor_b32 s10, s10, s38
  s_and_b32 s10, s10, 1
  s_lshl_b32 s10, s10, 13
  s_call_b64 s[34:35], L_Osub
  v_cmp_gt_i32 vcc, 0, v93
  s_cmp_lg_u64 vcc, 0
  s_addc_u32 s9, s9, 0
  s_mov_b32 s55, s9
  s_waitcnt lgkmcnt(0)
  s_barrier
  v_add_u32 v6, 106496, v5
  ds_read_b64_tr_b16 a[32:33], v6 offset:0
  ds_read_b64_tr_b16 a[34:35], v6 offset:14336
  ds_read_b64_tr_b16 a[40:41], v6 offset:256
  ds_read_b64_tr_b16 a[42:43], v6 offset:14592
  ds_read_b64_tr_b16 a[48:49], v6 offset:512
  ds_read_b64_tr_b16 a[50:51], v6 offset:14848
  ds_read_b64_tr_b16 a[56:57], v6 offset:768
  ds_read_b64_tr_b16 a[58:59], v6 offset:15104
  ds_read_b64_tr_b16 a[232:233], v6 offset:1024
  ds_read_b64_tr_b16 a[234:235], v6 offset:15360
  ds_read_b64_tr_b16 a[240:241], v6 offset:1280
  ds_read_b64_tr_b16 a[242:243], v6 offset:15616
  ds_read_b64_tr_b16 a[248:249], v6 offset:1536
  ds_read_b64_tr_b16 a[250:251], v6 offset:15872
  s_waitcnt lgkmcnt(0)
  s_barrier
  v_add_u32 v6, 8192, v5
  ds_read_b64_tr_b16 a[36:37], v6 offset:0
  ds_read_b64_tr_b16 a[38:39], v6 offset:14336
  ds_read_b64_tr_b16 a[44:45], v6 offset:256
  ds_read_b64_tr_b16 a[46:47], v6 offset:14592
  ds_read_b64_tr_b16 a[52:53], v6 offset:512
  ds_read_b64_tr_b16 a[54:55], v6 offset:14848
  ds_read_b64_tr_b16 a[60:61], v6 offset:768
  ds_read_b64_tr_b16 a[62:63], v6 offset:15104
  ds_read_b64_tr_b16 a[236:237], v6 offset:1024
  ds_read_b64_tr_b16 a[238:239], v6 offset:15360
  ds_read_b64_tr_b16 a[244:245], v6 offset:1280
  ds_read_b64_tr_b16 a[246:247], v6 offset:15616
  ds_read_b64_tr_b16 a[252:253], v6 offset:1536
  ds_read_b64_tr_b16 a[254:255], v6 offset:15872
  s_call_b64 s[34:35], L_Ook
L_OQloop:
  s_movk_i32 s38, 0x96
  s_bitcmp1_b32 s38, s49
  s_cbranch_scc0 L_OQin
  v_add_u32 v6, 73728, v9
  ds_read_b64_tr_b16 a[32:33], v6 offset:0
  ds_read_b64_tr_b16 a[34:35], v6 offset:2048
  ds_read_b64_tr_b16 a[36:37], v6 offset:4096
  ds_read_b64_tr_b16 a[38:39], v6 offset:6144
  ds_read_b64_tr_b16 a[40:41], v6 offset:256
  ds_read_b64_tr_b16 a[42:43], v6 offset:2304
  ds_read_b64_tr_b16 a[44:45], v6 offset:4352
  ds_read_b64_tr_b16 a[46:47], v6 offset:6400
  ds_read_b64_tr_b16 a[48:49], v6 offset:512
  ds_read_b64_tr_b16 a[50:51], v6 offset:2560
  ds_read_b64_tr_b16 a[52:53], v6 offset:4608
  ds_read_b64_tr_b16 a[54:55], v6 offset:6656
  ds_read_b64_tr_b16 a[56:57], v6 offset:768
  ds_read_b64_tr_b16 a[58:59], v6 offset:2816
  ds_read_b64_tr_b16 a[60:61], v6 offset:4864
  ds_read_b64_tr_b16 a[62:63], v6 offset:6912
  s_call_b64 s[34:35], L_Qsub
  v_add_u32 v6, 106496, v5
  ds_read_b64_tr_b16 a[32:33], v6 offset:0
  ds_read_b64_tr_b16 a[34:35], v6 offset:14336
  ds_read_b64_tr_b16 a[40:41], v6 offset:256
  ds_read_b64_tr_b16 a[42:43], v6 offset:14592
  ds_read_b64_tr_b16 a[48:49], v6 offset:512
  ds_read_b64_tr_b16 a[50:51], v6 offset:14848
  ds_read_b64_tr_b16 a[56:57], v6 offset:768
  ds_read_b64_tr_b16 a[58:59], v6 offset:15104
  v_add_u32 v6, 8192, v5
  ds_read_b64_tr_b16 a[36:37], v6 offset:0
  ds_read_b64_tr_b16 a[38:39], v6 offset:14336
  ds_read_b64_tr_b16 a[44:45], v6 offset:256
  ds_read_b64_tr_b16 a[46:47], v6 offset:14592
  ds_read_b64_tr_b16 a[52:53], v6 offset:512
  ds_read_b64_tr_b16 a[54:55], v6 offset:14848
  ds_read_b64_tr_b16 a[60:61], v6 offset:768
  ds_read_b64_tr_b16 a[62:63], v6 offset:15104
L_OQin:
  s_call_b64 s[34:35], L_Osub
  s_cmp_lt_u32 s49, 8
  s_cbranch_scc1 L_OQloop
  s_branch L_end
L_dmaG:
  buffer_load_dwordx4 v44, s[20:23], s88 offen nt lds
  s_add_u32 m0, m0, s99
  s_nop 0
  buffer_load_dwordx4 v44, s[20:23], s89 offen nt lds
  s_add_u32 m0, m0, s99
  s_nop 0
  buffer_load_dwordx4 v44, s[20:23], s90 offen nt lds
  s_add_u32 m0, m0, s99
  s_nop 0
  buffer_load_dwordx4 v44, s[20:23], s91 offen nt lds
  s_add_u32 m0, m0, s99
  s_nop 0
  buffer_load_dwordx4 v44, s[20:23], s92 offen nt lds
  s_add_u32 m0, m0, s99
  s_nop 0
  buffer_load_dwordx4 v44, s[20:23], s93 offen nt lds
  s_add_u32 m0, m0, s99
  s_nop 0
  buffer_load_dwordx4 v44, s[20:23], s94 offen nt lds
  s_add_u32 m0, m0, s99
  s_nop 0
  buffer_load_dwordx4 v44, s[20:23], s95 offen nt lds
  v_add_u32 v44, 0x38000, v44
  s_setpc_b64 s[96:97]
L_dmaD:
  buffer_load_dwordx4 v11, s[28:31], 0 offen offset:0 nt lds
  s_add_u32 m0, m0, 896
  s_nop 0
  buffer_load_dwordx4 v11, s[28:31], 0 offen offset:128 nt lds
  s_add_u32 m0, m0, 896
  s_nop 0
  buffer_load_dwordx4 v11, s[28:31], 0 offen offset:256 nt lds
  s_add_u32 m0, m0, 896
  s_nop 0
  buffer_load_dwordx4 v11, s[28:31], 0 offen offset:384 nt lds
  s_add_u32 m0, m0, 896
  s_nop 0
  buffer_load_dwordx4 v11, s[28:31], 0 offen offset:512 nt lds
  s_add_u32 m0, m0, 896
  s_nop 0
  buffer_load_dwordx4 v11, s[28:31], 0 offen offset:640 nt lds
  s_add_u32 m0, m0, 896
  s_nop 0
  buffer_load_dwordx4 v11, s[28:31], 0 offen offset:768 nt lds
  v_add_u32 v11, 0x7000, v11
  s_setpc_b64 s[96:97]
L_Fsub:
  s_lshl_b32 s38, s49, 2
  s_lshr_b32 s50, 0x76352410, s38
  s_and_b32 s50, s50, 7
  v_mov_b64 v[48:49], 0
  v_mov_b64 v[50:51], 0
  v_mov_b64 v[52:53], 0
  v_mov_b64 v[54:55], 0
  v_mov_b64 v[56:57], 0
  v_mov_b64 v[58:59], 0
  v_mov_b64 v[60:61], 0
  v_mov_b64 v[62:63], 0
  v_mov_b64 v[128:129], 0
  v_mov_b64 v[130:131], 0
  v_mov_b64 v[132:133], 0
  v_mov_b64 v[134:135], 0
  v_mov_b64 v[136:137], 0
  v_mov_b64 v[138:139], 0
  v_mov_b64 v[140:141], 0
  v_mov_b64 v[142:143], 0
  v_mov_b64 v[144:145], 0
  v_mov_b64 v[146:147], 0
  v_mov_b64 v[148:149], 0
  v_mov_b64 v[150:151], 0
  v_mov_b64 v[152:153], 0
  v_mov_b64 v[154:155], 0
  s_lshl_b32 s38, s50, 15
  s_add_u32 s48, s38, 0x10000
  s_add_u32 s48, s48, s10
  s_add_u32 s44, s38, s40
  s_add_u32 s51, s44, s56
  s_add_u32 s44, s44, s57
  s_lshl_b32 s38, s50, 11
  s_add_u32 s47, s38, 0x96000
  s_add_u32 s47, s47, s10
  s_and_b32 s39, s38, 0x2000
  s_add_u32 s38, s38, s39
  s_add_u32 s45, s38, s41
  s_add_u32 s46, s45, s56
  s_add_u32 s45, s45, s57
  s_cmp_lt_i32 s49, 0
  s_cbranch_scc1 L_Fx
  s_bitcmp1_b32 s50, 2
  s_cbranch_scc1 L_Fr
  v_lshlrev_b32 v16, 16, v160
  v_and_b32 v17, 0xffff0000, v160
  v_mov_b32 v160, v161
  v_mov_b32 v161, v162
  v_mov_b32 v162, v163
  s_branch L_Fg
L_Fr:
L_rp_301:
  s_sub_u32 s52, s52, 1
  s_cbranch_scc1 L_bail
  buffer_load_dwordx2 v[16:17], v14, s[16:19], s47 offen sc1
  s_waitcnt vmcnt(0)
  v_max_u32 v6, v16, v17
  v_cmp_eq_u32 vcc, -1, v6
  s_cbranch_vccnz L_rp_301
L_Fg:
  s_movk_i32 s38, 127
  s_bitcmp1_b32 s38, s49
  s_cbranch_scc0 L_g_302
L_gw_305:
  s_mov_b64 exec, -1
  s_sub_u32 s52, s52, 1
  s_cbranch_scc1 L_bail
  s_mov_b32 exec_lo, 0x10001
  s_mov_b32 exec_hi, 0x10001
  buffer_load_dword v20, v13, s[16:19], s48 offen sc1
  s_waitcnt vmcnt(0)
  v_cmp_ne_u32 vcc, -1, v20
  s_cbranch_vccz L_gw_305
  s_mov_b64 exec, -1
L_g_302:
  s_sub_u32 s52, s52, 1
  s_cbranch_scc1 L_bail
  buffer_load_dwordx4 v[64:67], v13, s[16:19], s48 offen offset:0 sc1
  buffer_load_dwordx4 v[68:71], v13, s[16:19], s48 offen offset:1024 sc1
  buffer_load_dwordx4 v[72:75], v13, s[16:19], s48 offen offset:2048 sc1
  buffer_load_dwordx4 v[76:79], v13, s[16:19], s48 offen offset:3072 sc1
  s_waitcnt vmcnt(3)
  v_mfma_f32_16x16x32_f16 v[20:23], v[32:35], v[64:67], v[16:19]
  s_waitcnt vmcnt(2)
  v_mfma_f32_16x16x32_f16 v[20:23], v[32:35], v[68:71], v[20:23]
  s_waitcnt vmcnt(1)
  v_mfma_f32_16x16x32_f16 v[20:23], v[32:35], v[72:75], v[20:23]
  s_waitcnt vmcnt(0)
  v_mfma_f32_16x16x32_f16 v[20:23], v[32:35], v[76:79], v[20:23]
  s_nop 8
  v_cmp_u_f32 vcc, v20, v21
  v_cvt_pk_bf16_f32 v24, v20, v21
  s_cbranch_vccz L_gd_303
  v_max3_u32 v6, v64, v65, v66
  v_max3_u32 v6, v6, v67, v68
  v_max3_u32 v6, v6, v69, v70
  v_max3_u32 v6, v6, v71, v72
  v_max3_u32 v6, v6, v73, v74
  v_max3_u32 v6, v6, v75, v76
  v_max3_u32 v6, v6, v77, v78
  v_max3_u32 v6, v6, v79, v79
  v_cmp_eq_u32 vcc, -1, v6
  s_cbranch_vccnz L_g_302
L_gd_303:
L_Fx:
  ds_write_b32 v15, v24
  s_waitcnt lgkmcnt(0)
  s_barrier
  ds_read_b128 v[96:99], v2 offset:0
  ds_read_b128 v[100:103], v2 offset:128
  ds_read_b128 v[104:107], v2 offset:256
  ds_read_b128 v[108:111], v2 offset:384
  ds_read_b128 v[112:115], v2 offset:512
  ds_read_b128 v[116:119], v2 offset:640
  ds_read_b128 v[120:123], v2 offset:768
  ds_read_b128 v[124:127], v1
  v_lshlrev_b32 v20, 16, v24
  v_and_b32 v21, 0xffff0000, v24
  buffer_store_dwordx2 v[20:21], v14, s[16:19], s46 offen sc1
  buffer_store_dwordx2 v[20:21], v14, s[16:19], s45 offen sc1
  s_waitcnt lgkmcnt(7)
  v_smfmac_f32_16x16x64_bf16 v[48:51], v[96:99], a[0:7], v3
  v_smfmac_f32_16x16x64_bf16 v[52:55], v[96:99], a[56:63], v3
  v_smfmac_f32_16x16x64_bf16 v[56:59], v[96:99], a[112:119], v3
  s_waitcnt lgkmcnt(0)
  v_smfmac_f32_16x16x64_bf16 v[60:63], v[96:99], a[168:175], v3
  v_lshlrev_b32 v26, 16, v124
  v_and_b32 v27, 0xffff0000, v124
  s_waitcnt lgkmcnt(6)
  v_smfmac_f32_16x16x64_bf16 v[48:51], v[100:103], a[8:15], v3
  v_add_f32 v28, v26, v27
  v_mul_f32 v30, v26, v26
  v_smfmac_f32_16x16x64_bf16 v[52:55], v[100:103], a[64:71], v3
  v_fmac_f32 v30, v27, v27
  v_lshlrev_b32 v26, 16, v125
  v_smfmac_f32_16x16x64_bf16 v[56:59], v[100:103], a[120:127], v3
  v_and_b32 v27, 0xffff0000, v125
  v_add_f32 v28, v28, v26
  v_smfmac_f32_16x16x64_bf16 v[60:63], v[100:103], a[176:183], v3
  v_fmac_f32 v30, v26, v26
  v_add_f32 v28, v28, v27
  s_waitcnt lgkmcnt(5)
  v_smfmac_f32_16x16x64_bf16 v[48:51], v[104:107], a[16:23], v3
  v_fmac_f32 v30, v27, v27
  v_lshlrev_b32 v26, 16, v126
  v_smfmac_f32_16x16x64_bf16 v[52:55], v[104:107], a[72:79], v3
  v_and_b32 v27, 0xffff0000, v126
  v_add_f32 v28, v28, v26
  v_smfmac_f32_16x16x64_bf16 v[56:59], v[104:107], a[128:135], v3
  v_fmac_f32 v30, v26, v26
  v_add_f32 v28, v28, v27
  v_smfmac_f32_16x16x64_bf16 v[60:63], v[104:107], a[184:191], v3
  v_fmac_f32 v30, v27, v27
  v_lshlrev_b32 v26, 16, v127
  s_waitcnt lgkmcnt(4)
  v_smfmac_f32_16x16x64_bf16 v[48:51], v[108:111], a[24:31], v3
  v_and_b32 v27, 0xffff0000, v127
  v_add_f32 v28, v28, v26
  v_smfmac_f32_16x16x64_bf16 v[52:55], v[108:111], a[80:87], v3
  v_fmac_f32 v30, v26, v26
  v_add_f32 v28, v28, v27
  v_smfmac_f32_16x16x64_bf16 v[56:59], v[108:111], a[136:143], v3
  v_fmac_f32 v30, v27, v27
  v_mov_b32 v26, 0x3b124925
  v_smfmac_f32_16x16x64_bf16 v[60:63], v[108:111], a[192:199], v3
  v_mov_b32 v27, 0x3727c5ac
  v_permlane16_swap_b32 v28, v30
  s_waitcnt lgkmcnt(3)
  v_smfmac_f32_16x16x64_bf16 v[48:51], v[112:115], a[32:39], v3
  v_add_f32 v28, v28, v30
  v_smfmac_f32_16x16x64_bf16 v[52:55], v[112:115], a[88:95], v3
  s_nop 0
  v_add_f32_dpp v28, v28, v28 quad_perm:[1,0,3,2] row_mask:0xf bank_mask:0xf
  v_smfmac_f32_16x16x64_bf16 v[56:59], v[112:115], a[144:151], v3
  s_nop 0
  v_add_f32_dpp v28, v28, v28 quad_perm:[2,3,0,1] row_mask:0xf bank_mask:0xf
  v_smfmac_f32_16x16x64_bf16 v[60:63], v[112:115], a[200:207], v3
  s_nop 0
  v_add_f32_dpp v28, v28, v28 row_ror:4 row_mask:0xf bank_mask:0xf
  s_waitcnt lgkmcnt(2)
  v_smfmac_f32_16x16x64_bf16 v[48:51], v[116:119], a[40:47], v3
  v_add_f32_dpp v29, v28, v28 row_ror:8 row_mask:0xf bank_mask:0xf
  v_add_f32_dpp v28, v28, v28 row_ror:8 row_mask:0xf bank_mask:0xf
  v_smfmac_f32_16x16x64_bf16 v[52:55], v[116:119], a[96:103], v3
  s_nop 0
  v_permlane32_swap_b32 v28, v29
  v_smfmac_f32_16x16x64_bf16 v[56:59], v[116:119], a[152:159], v3
  v_add_f32 v28, v28, v29
  v_smfmac_f32_16x16x64_bf16 v[60:63], v[116:119], a[208:215], v3
  v_readlane_b32 s58, v28, 0
  v_readlane_b32 s59, v28, 16
  s_waitcnt lgkmcnt(1)
  v_smfmac_f32_16x16x64_bf16 v[48:51], v[120:123], a[48:55], v3
  v_mul_f32 v24, s58, v26
  v_smfmac_f32_16x16x64_bf16 v[52:55], v[120:123], a[104:111], v3
  v_fmac_f32 v27, s59, v26
  v_fma_f32 v27, -v24, v24, v27
  v_smfmac_f32_16x16x64_bf16 v[56:59], v[120:123], a[160:167], v3
  v_rsq_f32 v25, v27
  v_smfmac_f32_16x16x64_bf16 v[60:63], v[120:123], a[216:223], v3
  v_mul_f32 v22, v24, v36
  v_mul_f32 v23, v24, v37
  v_mul_f32 v25, v25, v25
  v_add_f32_dpp v20, v48, v49 quad_perm:[0,1,2,3] row_mask:0x5 bank_mask:0xf
  s_nop 2
  v_add_f32_dpp v21, v56, v57 quad_perm:[0,1,2,3] row_mask:0x5 bank_mask:0xf
  v_add_f32_dpp v20, v52, v53 quad_perm:[0,1,2,3] row_mask:0xa bank_mask:0xf
  v_add_f32_dpp v21, v60, v61 quad_perm:[0,1,2,3] row_mask:0xa bank_mask:0xf
  v_sub_f32 v20, v20, v22
  v_sub_f32 v21, v21, v23
  v_max_f32 v20, 0, v20
  v_mul_f32 v21, v21, v25
  v_mul_f32 v20, v20, v21
  v_cvt_pk_bf16_f32 v20, v20, v20
  ds_write_b16 v40, v20
  s_waitcnt lgkmcnt(0)
  s_barrier
  ds_read_b128 v[96:99], v2 offset:2048
  ds_read_b128 v[100:103], v2 offset:2176
  v_mov_b32 v21, 0
  s_waitcnt lgkmcnt(1)
  v_smfmac_f32_16x16x64_bf16 v[128:131], v[96:99], a[224:231], v3
  v_smfmac_f32_16x16x64_bf16 v[132:135], v[96:99], a[240:247], v3
  v_smfmac_f32_16x16x64_bf16 v[136:139], v[96:99], v[176:183], v3
  v_smfmac_f32_16x16x64_bf16 v[140:143], v[96:99], v[192:199], v3
  v_smfmac_f32_16x16x64_bf16 v[144:147], v[96:99], v[208:215], v3
  v_smfmac_f32_16x16x64_bf16 v[148:151], v[96:99], v[224:231], v3
  v_smfmac_f32_16x16x64_bf16 v[152:155], v[96:99], v[240:247], v3
  s_waitcnt lgkmcnt(0)
  v_smfmac_f32_16x16x64_bf16 v[128:131], v[100:103], a[232:239], v3
  v_smfmac_f32_16x16x64_bf16 v[132:135], v[100:103], a[248:255], v3
  v_smfmac_f32_16x16x64_bf16 v[136:139], v[100:103], v[184:191], v3
  v_smfmac_f32_16x16x64_bf16 v[140:143], v[100:103], v[200:207], v3
  v_smfmac_f32_16x16x64_bf16 v[144:147], v[100:103], v[216:223], v3
  v_smfmac_f32_16x16x64_bf16 v[148:151], v[100:103], v[232:239], v3
  v_smfmac_f32_16x16x64_bf16 v[152:155], v[100:103], v[248:255], v3
  s_nop 2
  v_add_f32_dpp v20, v128, v129 quad_perm:[0,1,2,3] row_mask:0x1 bank_mask:0xf
  v_add_f32_dpp v20, v132, v133 quad_perm:[0,1,2,3] row_mask:0x2 bank_mask:0xf
  v_add_f32_dpp v20, v136, v137 quad_perm:[0,1,2,3] row_mask:0x4 bank_mask:0xf
  v_add_f32_dpp v20, v140, v141 quad_perm:[0,1,2,3] row_mask:0x8 bank_mask:0xf
  v_add_f32_dpp v21, v144, v145 quad_perm:[0,1,2,3] row_mask:0x1 bank_mask:0xf
  v_add_f32_dpp v21, v148, v149 quad_perm:[0,1,2,3] row_mask:0x2 bank_mask:0xf
  v_add_f32_dpp v21, v152, v153 quad_perm:[0,1,2,3] row_mask:0x4 bank_mask:0xf
  v_cvt_pk_f16_f32 v20, v20, v21
  v_min_u32 v20, -2, v20
  buffer_store_dword v20, v39, s[16:19], s51 offen sc1
  buffer_store_dword v20, v39, s[16:19], s44 offen sc1
  s_add_u32 s49, s49, 1
  s_cmp_eq_u32 s49, 0
  s_cbranch_scc1 L_Fret
  s_cmp_lt_u32 s49, 8
  s_cbranch_scc1 L_Fsub
  s_branch L_end
L_roleF:
  s_cmp_lt_u32 s3, 2
  s_cselect_b64 s[20:21], s[76:77], s[78:79]
  s_mov_b32 s22, 0x188000
  s_mov_b32 s23, 0x20000
  s_sub_u32 s2, s2, 16
  v_mul_u32_u24 v6, 3584, v4
  s_lshl_b32 s38, s2, 8
  s_and_b32 s39, s3, 1
  s_lshl_b32 s39, s39, 7
  s_add_u32 s38, s38, s39
  v_add3_u32 v44, v6, v2, s38
  s_mov_b32 s88, 0x0
  s_mov_b32 s89, 0xe000
  s_mov_b32 s90, 0x1c00
  s_mov_b32 s91, 0xfc00
  s_mov_b32 s92, 0x1c000
  s_mov_b32 s93, 0x2a000
  s_mov_b32 s94, 0x1dc00
  s_mov_b32 s95, 0x2bc00
  s_add_u32 m0, s98, 0
  s_call_b64 s[96:97], L_dmaG
  s_mov_b64 s[28:29], s[80:81]
  s_mov_b32 s30, 0x188000
  s_mov_b32 s31, 0x20000
  s_mov_b64 s[68:69], s[64:65]
  s_mov_b32 s70, 0xe00
  s_mov_b32 s71, 0x20000
  s_lshl_b32 s39, s2, 7
  s_and_b32 s38, s3, 1
  s_lshl_b32 s38, s38, 4
  s_add_u32 s38, s38, s39
  s_and_b32 s39, s3, 2
  s_add_u32 s38, s38, s39
  v_add_u32 v6, s38, v4
  v_mad_u32_u24 v11, v6, s99, v2
  v_lshlrev_b32 v6, 7, v6
  v_sub_u32 v11, v11, v6
  v_and_b32 v6, 1, v0
  v_cmp_eq_u32 vcc, 1, v6
  v_mov_b32 v3, 0x44444444
  v_mov_b32 v6, 0xeeeeeeee
  v_cndmask_b32 v3, v3, v6, vcc
  v_bfe_u32 v9, v0, 0, 5
  v_lshlrev_b32 v9, 3, v9
  v_bfe_u32 v6, v0, 5, 1
  v_lshl_add_u32 v9, v6, 10, v9
  v_mul_u32_u24 v5, 6144, v6
  s_mul_i32 s38, s3, 1792
  v_add3_u32 v5, v5, v9, s38
  s_mov_b32 s57, 0x40000000
  s_mov_b32 s56, 0x40000000
  s_mov_b32 s49, -1
  s_lshr_b32 s38, s3, 1
  s_lshl_b32 s38, s38, 13
  s_and_b32 s39, s3, 1
  s_lshl_b32 s39, s39, 9
  s_add_u32 s38, s38, s39
  v_add_u32 v9, s38, v9
  v_mov_b32 v10, 0x40000000
  v_bfe_u32 v6, v0, 0, 4
  v_lshlrev_b32 v6, 3, v6
  v_bfe_u32 v7, v0, 4, 1
  v_lshl_add_u32 v6, v7, 2, v6
  v_bfe_u32 v7, v0, 5, 1
  v_lshl_add_u32 v6, v7, 7, v6
  s_mul_i32 s38, s3, 224
  s_lshl_b32 s39, s3, 5
  s_add_u32 s39, s39, 672
  v_cmp_gt_u32 vcc, 224, v6
  v_add_u32 v15, s38, v6
  v_add_u32 v6, s39, v6
  v_cndmask_b32 v12, v10, v15, vcc
  v_cndmask_b32 v15, v6, v15, vcc
  s_lshl_b32 s38, s3, 9
  v_lshl_add_u32 v14, v0, 3, s38
  v_cndmask_b32 v14, v10, v14, vcc
  v_bfe_u32 v13, v0, 0, 4
  v_lshlrev_b32 v13, 4, v13
  v_bfe_u32 v6, v0, 4, 1
  v_lshl_add_u32 v13, v6, 12, v13
  v_bfe_u32 v6, v0, 5, 1
  v_lshl_add_u32 v13, v6, 14, v13
  s_lshl_b32 s38, s3, 8
  v_add_u32 v13, s38, v13
  v_lshl_add_u32 v39, v0, 2, s38
  v_cmp_gt_u32 vcc, 48, v0
  v_mov_b32 v18, 0
  v_mov_b32 v19, 0
  v_cndmask_b32 v8, v10, v13, vcc
  v_and_b32 v6, 8, v0
  v_cmp_eq_u32 vcc, 8, v6
  v_mov_b32 v6, 0x3c00
  v_mov_b32 v7, 0x3c000000
  v_cndmask_b32 v6, v6, v7, vcc
  v_and_b32 v7, 7, v0
  v_cmp_eq_u32 vcc, 0, v7
  s_nop 1
  v_cndmask_b32 v32, 0, v6, vcc
  v_cmp_eq_u32 vcc, 1, v7
  s_nop 1
  v_cndmask_b32 v33, 0, v6, vcc
  v_cmp_eq_u32 vcc, 4, v7
  s_nop 1
  v_cndmask_b32 v34, 0, v6, vcc
  v_cmp_eq_u32 vcc, 5, v7
  s_nop 1
  v_cndmask_b32 v35, 0, v6, vcc
  buffer_load_dword v160, v12, s[68:71], 0 offen offset:0
  buffer_load_dword v161, v12, s[68:71], 0 offen offset:896
  buffer_load_dword v162, v12, s[68:71], 0 offen offset:1792
  buffer_load_dword v163, v12, s[68:71], 0 offen offset:2688
  v_and_b32 v6, 31, v0
  s_lshl_b32 s38, s3, 6
  s_add_u32 s38, s38, 2048
  v_lshl_add_u32 v40, v6, 1, s38
  s_lshl_b32 s40, s2, 10
  s_and_b32 s38, s40, 0x2000
  s_add_u32 s40, s40, s38
  s_add_u32 s40, s40, 0x50000
  s_cmp_eq_u32 s2, 0
  s_cselect_b32 s41, 0x90000, s57
  s_waitcnt vmcnt(12)
  v_mov_b32 v28, 0
  s_cmp_lg_u32 s3, 0
  s_cbranch_scc1 L_rs_306
  s_movk_i32 s38, 0x100
  s_cmp_lg_u32 s7, 0
  s_cbranch_scc1 L_rw_307
  v_readfirstlane_b32 s39, v46
  s_bitcmp1_b32 s39, s101
  s_cbranch_scc0 L_rw_307
  s_call_b64 s[96:97], L_lost
L_rw_307:
  v_mov_b32 v29, s38
  ds_write_b32 v28, v29 offset:4096
  s_waitcnt lgkmcnt(0)
L_rs_306:
  s_barrier
  ds_read_b32 v29, v28 offset:4096
  s_waitcnt lgkmcnt(0)
  v_readfirstlane_b32 s38, v29
  s_cmp_lg_u32 s38, 0x100
  s_cbranch_scc1 L_redo
  v_mov_b32 v20, -1
  v_mov_b32 v21, -1
  v_mov_b32 v22, -1
  v_mov_b32 v23, -1
  s_lshl2_add_u32 s38, s8, s3
  s_mul_i32 s38, s38, 4608
  s_add_u32 s38, s38, 0x10000
  buffer_store_dwordx4 v[20:23], v1, s[16:19], s38 offen offset:0 sc1
  buffer_store_dwordx4 v[20:23], v1, s[16:19], s38 offen offset:1024 sc1
  buffer_store_dwordx4 v[20:23], v1, s[16:19], s38 offen offset:2048 sc1
  buffer_store_dwordx4 v[20:23], v1, s[16:19], s38 offen offset:3072 sc1
  buffer_store_dwordx4 v[20:23], v1, s[16:19], s38 offen offset:3584 sc1
  s_lshl_b32 s38, s3, 11
  s_lshl_b32 s39, s8, 15
  s_add_u32 s38, s38, s39
  s_add_u32 s38, s38, 0x780000
  buffer_store_dwordx4 v[20:23], v1, s[16:19], s38 offen offset:0 sc1
  buffer_store_dwordx4 v[20:23], v1, s[16:19], s38 offen offset:1024 sc1
  s_add_u32 m0, s98, 32768
  s_call_b64 s[96:97], L_dmaG
  s_waitcnt vmcnt(8)
  s_barrier
  s_cmp_lg_u32 s3, 0
  s_cbranch_scc1 L_sg_308
  s_mov_b64 exec, 1
  v_mov_b32 v28, 0
  v_mov_b32 v29, s9
  global_atomic_add v28, v29, s[84:85] offset:16 sc1
  s_mov_b64 exec, -1
L_sg_308:
  s_add_u32 m0, s98, 65536
  s_call_b64 s[96:97], L_dmaG
  s_branch L_Fsub
L_Fret:
  s_add_u32 m0, s98, 98304
  s_call_b64 s[96:97], L_dmaG
  s_waitcnt lgkmcnt(0)
  s_barrier
  v_add_u32 v6, 8192, v9
  ds_read_b64_tr_b16 a[0:1], v6 offset:0
  ds_read_b64_tr_b16 a[2:3], v6 offset:2048
  ds_read_b64_tr_b16 a[4:5], v6 offset:4096
  ds_read_b64_tr_b16 a[6:7], v6 offset:6144
  ds_read_b64_tr_b16 a[56:57], v6 offset:256
  ds_read_b64_tr_b16 a[58:59], v6 offset:2304
  ds_read_b64_tr_b16 a[60:61], v6 offset:4352
  ds_read_b64_tr_b16 a[62:63], v6 offset:6400
  ds_read_b64_tr_b16 a[112:113], v6 offset:16384
  ds_read_b64_tr_b16 a[114:115], v6 offset:18432
  ds_read_b64_tr_b16 a[116:117], v6 offset:20480
  ds_read_b64_tr_b16 a[118:119], v6 offset:22528
  ds_read_b64_tr_b16 a[168:169], v6 offset:16640
  ds_read_b64_tr_b16 a[170:171], v6 offset:18688
  ds_read_b64_tr_b16 a[172:173], v6 offset:20736
  ds_read_b64_tr_b16 a[174:175], v6 offset:22784
  s_waitcnt vmcnt(16)
  s_waitcnt lgkmcnt(0)
  s_barrier
  s_add_u32 m0, s98, 0
  s_call_b64 s[96:97], L_dmaG
  v_add_u32 v6, 40960, v9
  ds_read_b64_tr_b16 a[8:9], v6 offset:0
  ds_read_b64_tr_b16 a[10:11], v6 offset:2048
  ds_read_b64_tr_b16 a[12:13], v6 offset:4096
  ds_read_b64_tr_b16 a[14:15], v6 offset:6144
  ds_read_b64_tr_b16 a[64:65], v6 offset:256
  ds_read_b64_tr_b16 a[66:67], v6 offset:2304
  ds_read_b64_tr_b16 a[68:69], v6 offset:4352
  ds_read_b64_tr_b16 a[70:71], v6 offset:6400
  ds_read_b64_tr_b16 a[120:121], v6 offset:16384
  ds_read_b64_tr_b16 a[122:123], v6 offset:18432
  ds_read_b64_tr_b16 a[124:125], v6 offset:20480
  ds_read_b64_tr_b16 a[126:127], v6 offset:22528
  ds_read_b64_tr_b16 a[176:177], v6 offset:16640
  ds_read_b64_tr_b16 a[178:179], v6 offset:18688
  ds_read_b64_tr_b16 a[180:181], v6 offset:20736
  ds_read_b64_tr_b16 a[182:183], v6 offset:22784
  s_waitcnt vmcnt(16)
  s_waitcnt lgkmcnt(0)
  s_barrier
  s_add_u32 m0, s98, 32768
  s_call_b64 s[96:97], L_dmaG
  v_add_u32 v6, 73728, v9
  ds_read_b64_tr_b16 a[16:17], v6 offset:0
  ds_read_b64_tr_b16 a[18:19], v6 offset:2048
  ds_read_b64_tr_b16 a[20:21], v6 offset:4096
  ds_read_b64_tr_b16 a[22:23], v6 offset:6144
  ds_read_b64_tr_b16 a[72:73], v6 offset:256
  ds_read_b64_tr_b16 a[74:75], v6 offset:2304
  ds_read_b64_tr_b16 a[76:77], v6 offset:4352
  ds_read_b64_tr_b16 a[78:79], v6 offset:6400
  ds_read_b64_tr_b16 a[128:129], v6 offset:16384
  ds_read_b64_tr_b16 a[130:131], v6 offset:18432
  ds_read_b64_tr_b16 a[132:133], v6 offset:20480
  ds_read_b64_tr_b16 a[134:135], v6 offset:22528
  ds_read_b64_tr_b16 a[184:185], v6 offset:16640
  ds_read_b64_tr_b16 a[186:187], v6 offset:18688
  ds_read_b64_tr_b16 a[188:189], v6 offset:20736
  ds_read_b64_tr_b16 a[190:191], v6 offset:22784
  s_waitcnt vmcnt(16)
  s_waitcnt lgkmcnt(0)
  s_barrier
  s_add_u32 m0, s98, 65536
  s_call_b64 s[96:97], L_dmaG
  v_add_u32 v6, 106496, v9
  ds_read_b64_tr_b16 a[24:25], v6 offset:0
  ds_read_b64_tr_b16 a[26:27], v6 offset:2048
  ds_read_b64_tr_b16 a[28:29], v6 offset:4096
  ds_read_b64_tr_b16 a[30:31], v6 offset:6144
  ds_read_b64_tr_b16 a[80:81], v6 offset:256
  ds_read_b64_tr_b16 a[82:83], v6 offset:2304
  ds_read_b64_tr_b16 a[84:85], v6 offset:4352
  ds_read_b64_tr_b16 a[86:87], v6 offset:6400
  ds_read_b64_tr_b16 a[136:137], v6 offset:16384
  ds_read_b64_tr_b16 a[138:139], v6 offset:18432
  ds_read_b64_tr_b16 a[140:141], v6 offset:20480
  ds_read_b64_tr_b16 a[142:143], v6 offset:22528
  ds_read_b64_tr_b16 a[192:193], v6 offset:16640
  ds_read_b64_tr_b16 a[194:195], v6 offset:18688
  ds_read_b64_tr_b16 a[196:197], v6 offset:20736
  ds_read_b64_tr_b16 a[198:199], v6 offset:22784
  s_waitcnt vmcnt(16)
  s_waitcnt lgkmcnt(0)
  s_barrier
  s_add_u32 m0, s32, 98304
  s_call_b64 s[96:97], L_dmaD
  v_add_u32 v6, 8192, v9
  ds_read_b64_tr_b16 a[32:33], v6 offset:0
  ds_read_b64_tr_b16 a[34:35], v6 offset:2048
  ds_read_b64_tr_b16 a[36:37], v6 offset:4096
  ds_read_b64_tr_b16 a[38:39], v6 offset:6144
  ds_read_b64_tr_b16 a[88:89], v6 offset:256
  ds_read_b64_tr_b16 a[90:91], v6 offset:2304
  ds_read_b64_tr_b16 a[92:93], v6 offset:4352
  ds_read_b64_tr_b16 a[94:95], v6 offset:6400
  ds_read_b64_tr_b16 a[144:145], v6 offset:16384
  ds_read_b64_tr_b16 a[146:147], v6 offset:18432
  ds_read_b64_tr_b16 a[148:149], v6 offset:20480
  ds_read_b64_tr_b16 a[150:151], v6 offset:22528
  ds_read_b64_tr_b16 a[200:201], v6 offset:16640
  ds_read_b64_tr_b16 a[202:203], v6 offset:18688
  ds_read_b64_tr_b16 a[204:205], v6 offset:20736
  ds_read_b64_tr_b16 a[206:207], v6 offset:22784
  s_waitcnt vmcnt(15)
  s_waitcnt lgkmcnt(0)
  s_barrier
  s_add_u32 m0, s32, 0
  s_call_b64 s[96:97], L_dmaD
  v_add_u32 v6, 40960, v9
  ds_read_b64_tr_b16 a[40:41], v6 offset:0
  ds_read_b64_tr_b16 a[42:43], v6 offset:2048
  ds_read_b64_tr_b16 a[44:45], v6 offset:4096
  ds_read_b64_tr_b16 a[46:47], v6 offset:6144
  ds_read_b64_tr_b16 a[96:97], v6 offset:256
  ds_read_b64_tr_b16 a[98:99], v6 offset:2304
  ds_read_b64_tr_b16 a[100:101], v6 offset:4352
  ds_read_b64_tr_b16 a[102:103], v6 offset:6400
  ds_read_b64_tr_b16 a[152:153], v6 offset:16384
  ds_read_b64_tr_b16 a[154:155], v6 offset:18432
  ds_read_b64_tr_b16 a[156:157], v6 offset:20480
  ds_read_b64_tr_b16 a[158:159], v6 offset:22528
  ds_read_b64_tr_b16 a[208:209], v6 offset:16640
  ds_read_b64_tr_b16 a[210:211], v6 offset:18688
  ds_read_b64_tr_b16 a[212:213], v6 offset:20736
  ds_read_b64_tr_b16 a[214:215], v6 offset:22784
  s_waitcnt vmcnt(14)
  s_waitcnt lgkmcnt(0)
  s_barrier
  s_add_u32 m0, s32, 32768
  s_call_b64 s[96:97], L_dmaD
  v_add_u32 v6, 73728, v9
  ds_read_b64_tr_b16 a[48:49], v6 offset:0
  ds_read_b64_tr_b16 a[50:51], v6 offset:2048
  ds_read_b64_tr_b16 a[52:53], v6 offset:4096
  ds_read_b64_tr_b16 a[54:55], v6 offset:6144
  ds_read_b64_tr_b16 a[104:105], v6 offset:256
  ds_read_b64_tr_b16 a[106:107], v6 offset:2304
  ds_read_b64_tr_b16 a[108:109], v6 offset:4352
  ds_read_b64_tr_b16 a[110:111], v6 offset:6400
  ds_read_b64_tr_b16 a[160:161], v6 offset:16384
  ds_read_b64_tr_b16 a[162:163], v6 offset:18432
  ds_read_b64_tr_b16 a[164:165], v6 offset:20480
  ds_read_b64_tr_b16 a[166:167], v6 offset:22528
  ds_read_b64_tr_b16 a[216:217], v6 offset:16640
  ds_read_b64_tr_b16 a[218:219], v6 offset:18688
  ds_read_b64_tr_b16 a[220:221], v6 offset:20736
  ds_read_b64_tr_b16 a[222:223], v6 offset:22784
  s_waitcnt vmcnt(14)
  s_waitcnt lgkmcnt(0)
  s_barrier
  global_load_dwordx2 v[46:47], v18, s[84:85] offset:16 sc1
  s_add_u32 m0, s32, 65536
  s_call_b64 s[96:97], L_dmaD
  v_add_u32 v6, 106496, v5
  ds_read_b64_tr_b16 a[224:225], v6 offset:0
  ds_read_b64_tr_b16 a[226:227], v6 offset:14336
  ds_read_b64_tr_b16 a[240:241], v6 offset:256
  ds_read_b64_tr_b16 a[242:243], v6 offset:14592
  ds_read_b64_tr_b16 v[176:177], v6 offset:512
  ds_read_b64_tr_b16 v[178:179], v6 offset:14848
  ds_read_b64_tr_b16 v[192:193], v6 offset:768
  ds_read_b64_tr_b16 v[194:195], v6 offset:15104
  ds_read_b64_tr_b16 v[208:209], v6 offset:1024
  ds_read_b64_tr_b16 v[210:211], v6 offset:15360
  ds_read_b64_tr_b16 v[224:225], v6 offset:1280
  ds_read_b64_tr_b16 v[226:227], v6 offset:15616
  ds_read_b64_tr_b16 v[240:241], v6 offset:1536
  ds_read_b64_tr_b16 v[242:243], v6 offset:15872
  v_mov_b32 v20, 0x3f803f80
  v_mov_b32 v21, 0x3f803f80
  v_mov_b32 v22, 0x3f803f80
  v_mov_b32 v23, 0x3f803f80
  v_mov_b64 v[48:49], 0
  v_mov_b64 v[50:51], 0
  v_mov_b64 v[52:53], 0
  v_mov_b64 v[54:55], 0
  v_mov_b64 v[56:57], 0
  v_mov_b64 v[58:59], 0
  v_mov_b64 v[60:61], 0
  v_mov_b64 v[62:63], 0
  v_smfmac_f32_16x16x64_bf16 v[48:51], v[20:23], a[0:7], v3
  v_smfmac_f32_16x16x64_bf16 v[52:55], v[20:23], a[56:63], v3
  v_smfmac_f32_16x16x64_bf16 v[56:59], v[20:23], a[112:119], v3
  v_smfmac_f32_16x16x64_bf16 v[60:63], v[20:23], a[168:175], v3
  v_smfmac_f32_16x16x64_bf16 v[48:51], v[20:23], a[8:15], v3
  v_smfmac_f32_16x16x64_bf16 v[52:55], v[20:23], a[64:71], v3
  v_smfmac_f32_16x16x64_bf16 v[56:59], v[20:23], a[120:127], v3
  v_smfmac_f32_16x16x64_bf16 v[60:63], v[20:23], a[176:183], v3
  v_smfmac_f32_16x16x64_bf16 v[48:51], v[20:23], a[16:23], v3
  v_smfmac_f32_16x16x64_bf16 v[52:55], v[20:23], a[72:79], v3
  v_smfmac_f32_16x16x64_bf16 v[56:59], v[20:23], a[128:135], v3
  v_smfmac_f32_16x16x64_bf16 v[60:63], v[20:23], a[184:191], v3
  v_smfmac_f32_16x16x64_bf16 v[48:51], v[20:23], a[24:31], v3
  v_smfmac_f32_16x16x64_bf16 v[52:55], v[20:23], a[80:87], v3
  v_smfmac_f32_16x16x64_bf16 v[56:59], v[20:23], a[136:143], v3
  v_smfmac_f32_16x16x64_bf16 v[60:63], v[20:23], a[192:199], v3
  v_smfmac_f32_16x16x64_bf16 v[48:51], v[20:23], a[32:39], v3
  v_smfmac_f32_16x16x64_bf16 v[52:55], v[20:23], a[88:95], v3
  v_smfmac_f32_16x16x64_bf16 v[56:59], v[20:23], a[144:151], v3
  v_smfmac_f32_16x16x64_bf16 v[60:63], v[20:23], a[200:207], v3
  v_smfmac_f32_16x16x64_bf16 v[48:51], v[20:23], a[40:47], v3
  v_smfmac_f32_16x16x64_bf16 v[52:55], v[20:23], a[96:103], v3
  v_smfmac_f32_16x16x64_bf16 v[56:59], v[20:23], a[152:159], v3
  v_smfmac_f32_16x16x64_bf16 v[60:63], v[20:23], a[208:215], v3
  v_smfmac_f32_16x16x64_bf16 v[48:51], v[20:23], a[48:55], v3
  v_smfmac_f32_16x16x64_bf16 v[52:55], v[20:23], a[104:111], v3
  v_smfmac_f32_16x16x64_bf16 v[56:59], v[20:23], a[160:167], v3
  v_smfmac_f32_16x16x64_bf16 v[60:63], v[20:23], a[216:223], v3
  s_nop 5
  v_add_f32_dpp v36, v48, v49 quad_perm:[0,1,2,3] row_mask:0x5 bank_mask:0xf
  v_add_f32_dpp v36, v52, v53 quad_perm:[0,1,2,3] row_mask:0xa bank_mask:0xf
  v_add_f32_dpp v37, v56, v57 quad_perm:[0,1,2,3] row_mask:0x5 bank_mask:0xf
  v_add_f32_dpp v37, v60, v61 quad_perm:[0,1,2,3] row_mask:0xa bank_mask:0xf
  s_waitcnt vmcnt(15)
  s_waitcnt lgkmcnt(0)
  s_barrier
  v_add_u32 v6, 8192, v5
  ds_read_b64_tr_b16 a[228:229], v6 offset:0
  ds_read_b64_tr_b16 a[230:231], v6 offset:14336
  ds_read_b64_tr_b16 a[244:245], v6 offset:256
  ds_read_b64_tr_b16 a[246:247], v6 offset:14592
  ds_read_b64_tr_b16 v[180:181], v6 offset:512
  ds_read_b64_tr_b16 v[182:183], v6 offset:14848
  ds_read_b64_tr_b16 v[196:197], v6 offset:768
  ds_read_b64_tr_b16 v[198:199], v6 offset:15104
  ds_read_b64_tr_b16 v[212:213], v6 offset:1024
  ds_read_b64_tr_b16 v[214:215], v6 offset:15360
  ds_read_b64_tr_b16 v[228:229], v6 offset:1280
  ds_read_b64_tr_b16 v[230:231], v6 offset:15616
  ds_read_b64_tr_b16 v[244:245], v6 offset:1536
  ds_read_b64_tr_b16 v[246:247], v6 offset:15872
  s_waitcnt vmcnt(8)
  s_waitcnt lgkmcnt(0)
  s_barrier
  v_add_u32 v6, 40960, v5
  ds_read_b64_tr_b16 a[232:233], v6 offset:0
  ds_read_b64_tr_b16 a[234:235], v6 offset:14336
  ds_read_b64_tr_b16 a[248:249], v6 offset:256
  ds_read_b64_tr_b16 a[250:251], v6 offset:14592
  ds_read_b64_tr_b16 v[184:185], v6 offset:512
  ds_read_b64_tr_b16 v[186:187], v6 offset:14848
  ds_read_b64_tr_b16 v[200:201], v6 offset:768
  ds_read_b64_tr_b16 v[202:203], v6 offset:15104
  ds_read_b64_tr_b16 v[216:217], v6 offset:1024
  ds_read_b64_tr_b16 v[218:219], v6 offset:15360
  ds_read_b64_tr_b16 v[232:233], v6 offset:1280
  ds_read_b64_tr_b16 v[234:235], v6 offset:15616
  ds_read_b64_tr_b16 v[248:249], v6 offset:1536
  ds_read_b64_tr_b16 v[250:251], v6 offset:15872
  s_waitcnt vmcnt(0)
  s_waitcnt lgkmcnt(0)
  s_barrier
  v_add_u32 v6, 73728, v5
  ds_read_b64_tr_b16 a[236:237], v6 offset:0
  ds_read_b64_tr_b16 a[238:239], v6 offset:14336
  ds_read_b64_tr_b16 a[252:253], v6 offset:256
  ds_read_b64_tr_b16 a[254:255], v6 offset:14592
  ds_read_b64_tr_b16 v[188:189], v6 offset:512
  ds_read_b64_tr_b16 v[190:191], v6 offset:14848
  ds_read_b64_tr_b16 v[204:205], v6 offset:768
  ds_read_b64_tr_b16 v[206:207], v6 offset:15104
  ds_read_b64_tr_b16 v[220:221], v6 offset:1024
  ds_read_b64_tr_b16 v[222:223], v6 offset:15360
  ds_read_b64_tr_b16 v[236:237], v6 offset:1280
  ds_read_b64_tr_b16 v[238:239], v6 offset:15616
  ds_read_b64_tr_b16 v[252:253], v6 offset:1536
  ds_read_b64_tr_b16 v[254:255], v6 offset:15872
  s_branch L_cntc_310
L_cnt_309:
  s_sub_u32 s52, s52, 1
  s_cbranch_scc1 L_bail
  global_load_dword v46, v18, s[84:85] offset:16 sc1
  s_waitcnt vmcnt(0)
L_cntc_310:
  v_and_b32 v22, 0xff, v46
  v_cmp_gt_u32 vcc, 32, v22
  s_cbranch_vccnz L_cnt_309
  s_mov_b32 s56, 0
  s_movk_i32 s57, 0x2000
  v_readfirstlane_b32 s38, v47
  s_getreg_b32 s10, hwreg(HW_REG_XCC_ID, 2, 1)
  s_xor_b32 s10, s10, s38
  s_and_b32 s10, s10, 1
  s_lshl_b32 s10, s10, 13
  s_branch L_Fsub
L_odd:
  s_waitcnt lgkmcnt(0)
  v_mov_b32 v1, 0
  s_cmp_lg_u32 s3, 0
  s_cbranch_scc1 L_odd2
  s_and_b32 s38, s36, 3
  s_lshl_b32 s38, s38, 6
  s_lshr_b32 s39, s36, 2
  s_lshl3_add_u32 s38, s39, s38
  v_mov_b32 v2, s38
  s_lshl_b32 s39, s37, 3
  s_movk_i32 s41, 24
L_odd1:
  global_load_dword v3, v2, s[84:85] sc1
  s_waitcnt vmcnt(0)
  v_readfirstlane_b32 s38, v3
  s_lshr_b32 s38, s38, s39
  s_and_b32 s38, s38, 0xff
  s_bcnt1_i32_b32 s40, s38
  s_cmp_ge_u32 s40, 7
  s_cselect_b32 s41, 0, s41
  s_sub_u32 s41, s41, 1
  s_cbranch_scc0 L_odd1
  s_ff0_i32_b32 s38, s38
  v_mov_b32 v2, s38
  ds_write_b32 v1, v2 offset:4100
  s_waitcnt lgkmcnt(0)
L_odd2:
  s_barrier
  ds_read_b32 v2, v1 offset:4100
  s_waitcnt lgkmcnt(0)
  v_readfirstlane_b32 s38, v2
  s_mov_b32 s6, 1
  s_branch L_even
L_lost:
  s_waitcnt vmcnt(0)
  v_bfe_u32 v62, v0, 0, 2
  v_lshlrev_b32 v62, 6, v62
  v_bfe_u32 v63, v0, 2, 1
  v_lshl_add_u32 v62, v63, 3, v62
L_lost1:
  global_load_dword v60, v62, s[84:85] sc1
  s_waitcnt vmcnt(0)
  v_cmp_ne_u32 vcc, -1, v60
  s_movk_i32 s38, 0x300
  s_cbranch_vccz L_lost2
  s_getreg_b32 s39, hwreg(HW_REG_XCC_ID, 0, 3)
  s_ff1_i32_b32 s38, vcc_lo
  s_bitcmp1_b32 vcc_lo, s39
  s_cselect_b32 s38, s39, s38
  s_nop 3
  v_readlane_b32 s39, v60, s38
  v_readlane_b32 s40, v62, s38
  s_ff0_i32_b32 s39, s39
  s_lshl_b32 s41, 1, s39
  v_mov_b32 v61, s41
  v_mov_b32 v63, s40
  s_mov_b64 exec, 1
  global_atomic_or v60, v63, v61, s[84:85] sc0 sc1
  s_mov_b64 exec, -1
  s_waitcnt vmcnt(0)
  v_readfirstlane_b32 s40, v60
  s_bitcmp1_b32 s40, s39
  s_cbranch_scc1 L_lost1
  s_lshl_b32 s38, s38, 5
  s_add_u32 s38, s38, s39
  s_bitset1_b32 s38, 9
L_lost2:
  s_setpc_b64 s[96:97]
L_redo:
  s_bitcmp1_b32 s38, 8
  s_cbranch_scc1 L_bail
  s_waitcnt vmcnt(0) lgkmcnt(0)
  s_barrier
  s_load_dwordx16 s[64:79], s[0:1], 0
  s_load_dwordx8 s[80:87], s[0:1], 64
  s_bfe_u32 s36, s38, 0x30005
  s_and_b32 s2, s38, 31
  s_mov_b32 s7, 1
  s_branch L_role
L_bail:
  s_mov_b64 exec, 1
  v_mov_b32 v0, 32
  v_mov_b32 v1, 1
  global_atomic_add v0, v1, s[84:85] sc1
  v_mov_b32 v0, 36
  v_mov_b32 v1, s2
  global_store_dword v0, v1, s[84:85] sc1
L_end:
L_end2:
s_endpgm
.section .rodata,"a"
.p2align 6
.amdhsa_kernel interleave_layers__mha_block_cached__glu_gated_reglu__decode_kernel
  .amdhsa_next_free_vgpr 512
  .amdhsa_next_free_sgpr 102
  .amdhsa_accum_offset 256
  .amdhsa_group_segment_fixed_size 0
  .amdhsa_kernarg_size 96
  .amdhsa_user_sgpr_count 2
  .amdhsa_user_sgpr_kernarg_segment_ptr 1
  .amdhsa_system_sgpr_workgroup_id_x 1
.end_amdhsa_kernel
```
